```python
import torch

def _softmax(x, axis=-1):
    return torch.softmax(x, dim=axis)
def _gelu(x):
    return torch.nn.functional.gelu(x, approximate="tanh")
def _silu(x):
    return torch.nn.functional.silu(x)
def _sigmoid(x):
    return torch.sigmoid(x)
def _layernorm(x, axis=-1, eps=1e-5):
    m = x.mean(dim=axis, keepdim=True)
    v = x.var(dim=axis, keepdim=True, unbiased=False)
    return (x - m) / torch.sqrt(v + eps)
def _scatter_add(tgt, idx, src, axis=0):
    return tgt.clone().index_add_(axis, idx, src)
def _segment_sum(src, seg, n):
    out = torch.zeros((n,) + src.shape[1:], dtype=src.dtype)
    return out.index_add_(0, seg, src)
def _pad(x, pw):
    flat = tuple(v for pair in reversed(pw) for v in pair)
    return torch.nn.functional.pad(x, flat)

kernel_name = 'concat_heads__gqa_block_cached__mha_block_cached__near_ridge'

def setup_inputs():

    _w = (lambda a: (lambda t: t.to(torch.bfloat16) if t.is_floating_point() else t)(torch.as_tensor(a)))
    def _A_setup():
        B, Sq, D = 8, 192, 640
        Hq, Hkv, Sk, Dh = 32, 32, 512, 128
        assert Hq % Hkv == 0, (Hq, Hkv)
        return {
            "x": _w((lambda *s: torch.randn(*s, dtype=torch.bfloat16) * 0.8)(B, Sq, D)),
            "k_cache": _w((lambda *s: torch.randn(*s, dtype=torch.bfloat16) * 0.8)(B, Hkv, Sk, Dh)),
            "v_cache": _w((lambda *s: torch.randn(*s, dtype=torch.bfloat16) * 0.05)(B, Hkv, Sk, Dh)),
            "wq": _w((lambda *s: torch.randn(*s, dtype=torch.bfloat16) * 0.8)(D, Hq * Dh) * (D ** -0.5)),
            "wo": _w((lambda *s: torch.randn(*s, dtype=torch.bfloat16) * 0.05)(Hq * Dh, D) * ((Hq * Dh) ** -0.5)),
        }
    _A_in = _A_setup()

    def _B_setup():
        B, Sq, D = 8, 192, 640
        H, Sk, Dh = 32, 512, 128
        return {
            "x": _w((lambda *s: torch.randn(*s, dtype=torch.bfloat16) * 0.8)(B, Sq, D)),
            "k_cache": _w((lambda *s: torch.randn(*s, dtype=torch.bfloat16) * 0.8)(B, H, Sk, Dh)),
            "v_cache": _w((lambda *s: torch.randn(*s, dtype=torch.bfloat16) * 0.05)(B, H, Sk, Dh)),
            "wq": _w((lambda *s: torch.randn(*s, dtype=torch.bfloat16) * 0.8)(D, H * Dh) * (D ** -0.5)),
            "wo": _w((lambda *s: torch.randn(*s, dtype=torch.bfloat16) * 0.05)(H * Dh, D) * ((H * Dh) ** -0.5)),
        }
    _B_in = _B_setup()

    return {
        "A_x": _A_in["x"],
        "A_k_cache": _A_in["k_cache"],
        "A_v_cache": _A_in["v_cache"],
        "A_wq": _A_in["wq"],
        "A_wo": _A_in["wo"],
        "B_x": _B_in["x"],
        "B_k_cache": _B_in["k_cache"],
        "B_v_cache": _B_in["v_cache"],
        "B_wq": _B_in["wq"],
        "B_wo": _B_in["wo"],
    }

def reference(A_x, A_k_cache, A_v_cache, A_wq, A_wo, B_x, B_k_cache, B_v_cache, B_wq, B_wo):
    def _A_ref(x, k_cache, v_cache, wq, wo):
        B, Sq, D = x.shape
        Hq, Dh = 32, 128
        Hkv = k_cache.shape[1]
        rep = Hq // Hkv
        q = (lambda x, *d: x.permute(*d))((x @ wq).reshape(B, Sq, Hq, Dh), 0, 2, 1, 3)
        k = (lambda x, n, axis: torch.repeat_interleave(x, n, dim=axis))(k_cache, rep, axis=1)
        v = (lambda x, n, axis: torch.repeat_interleave(x, n, dim=axis))(v_cache, rep, axis=1)
        scores = torch.einsum("bhqd,bhkd->bhqk", q, k) * (Dh ** -0.5)
        p = _softmax(scores, axis=-1)
        o = torch.einsum("bhqk,bhkd->bhqd", p, v)
        return (lambda x, *d: x.permute(*d))(o, 0, 2, 1, 3).reshape(B, Sq, Hq * Dh) @ wo

    def _B_ref(x, k_cache, v_cache, wq, wo):
        B, Sq, D = x.shape
        H, Dh = 32, 128
        q = (lambda x, *d: x.permute(*d))((x @ wq).reshape(B, Sq, H, Dh), 0, 2, 1, 3)
        scores = torch.einsum("bhqd,bhkd->bhqk", q, k_cache) * (Dh ** -0.5)
        p = _softmax(scores, axis=-1)
        o = torch.einsum("bhqk,bhkd->bhqd", p, v_cache)
        return (lambda x, *d: x.permute(*d))(o, 0, 2, 1, 3).reshape(B, Sq, H * Dh) @ wo

    a = _A_ref(A_x, A_k_cache, A_v_cache, A_wq, A_wo)
    b = _B_ref(B_x, B_k_cache, B_v_cache, B_wq, B_wo)
    return torch.concatenate([a, b], axis=-1)
```

```asm
; @launch kernel=concat_heads__gqa_block_cached__mha_block_cached__near_ridge_kernel grid=(256,1,1) block=(768,1,1) lds=163840
; @launch kernel=outproj_kernel grid=(256,1,1) block=(256,1,1) lds=122880
.amdgcn_target "amdgcn-amd-amdhsa--gfx950"
.text
.globl concat_heads__gqa_block_cached__mha_block_cached__near_ridge_kernel
.p2align 8
.type concat_heads__gqa_block_cached__mha_block_cached__near_ridge_kernel,@function
concat_heads__gqa_block_cached__mha_block_cached__near_ridge_kernel:
  s_cmp_ge_u32 s2, 256
  s_cbranch_scc1 K1_END
  s_load_dwordx16 s[48:63], s[0:1], 0
  s_load_dwordx8 s[64:71], s[0:1], 64
  s_load_dwordx2 s[72:73], s[0:1], 96
  v_and_b32 v1, 63, v0
  v_lshrrev_b32 v156, 6, v0
  s_nop 0
  v_readfirstlane_b32 s28, v156
  s_and_b32 s34, s2, 7
  s_lshr_b32 s35, s2, 3
  s_lshr_b32 s29, s34, 2
  s_and_b32 s34, s34, 3
  s_and_b32 s30, s35, 7
  s_lshr_b32 s35, s35, 3
  s_lshl_b32 s34, s34, 2
  s_add_u32 s31, s34, s35
  s_cmp_ge_u32 s28, 6
  s_cselect_b32 s32, 1, 0
  s_mul_i32 s34, s32, 6
  s_sub_u32 s33, s28, s34
  s_mov_b32 s38, 0x3e0293ee
  s_waitcnt lgkmcnt(0)
  s_cmp_lg_u32 s28, 11
  s_cbranch_scc1 K1_NOIPF
  s_getpc_b64 s[90:91]
K1_PCREF:
  s_lshr_b32 s34, s2, 3
  s_lshl_b32 s34, s34, 13
  v_lshlrev_b32 v156, 7, v1
  v_add_u32 v156, s34, v156
  s_mov_b32 s35, CODE_END-K1_PCREF-4
  v_cmp_gt_u32 vcc, s35, v156
  s_nop 0
  s_and_saveexec_b64 s[92:93], vcc
  s_cbranch_execz K1_IPF2
  global_load_dword v167, v156, s[90:91]
K1_IPF2:
  s_mov_b64 exec, s[92:93]
K1_NOIPF:
  s_cmp_eq_u32 s29, 0
  s_cselect_b32 s48, s48, s58
  s_cselect_b32 s49, s49, s59
  s_cselect_b32 s50, s50, s60
  s_cselect_b32 s51, s51, s61
  s_cselect_b32 s52, s52, s62
  s_cselect_b32 s53, s53, s63
  s_cselect_b32 s54, s54, s64
  s_cselect_b32 s55, s55, s65
  s_cselect_b32 s56, s56, s66
  s_cselect_b32 s57, s57, s67
  s_mul_i32 s34, s30, 245760
  s_add_u32 s34, s48, s34
  s_addc_u32 s35, s49, 0
  s_lshl_b32 s36, s31, 9
  s_add_u32 s54, s54, s36
  s_addc_u32 s55, s55, 0
  s_sub_u32 s36, 5242880, s36
  s_cmp_lt_u32 s28, 4
  s_cselect_b32 s8, s54, s34
  s_cselect_b32 s9, s55, s35
  s_cselect_b32 s10, s36, 245760
  s_mov_b32 s11, 0x00020000
  s_mov_b32 s16, s56
  s_mov_b32 s17, s57
  s_mov_b32 s18, 5242880
  s_mov_b32 s19, 0x00020000
  s_mov_b32 s20, s72
  s_mov_b32 s21, s73
  s_mov_b32 s22, 0x10000000
  s_mov_b32 s23, 0x00020000
  s_lshl_b32 s34, s30, 5
  s_lshl_b32 s35, s31, 1
  s_add_u32 s34, s34, s35
  s_lshl_b32 s34, s34, 17
  s_cmp_lt_u32 s28, 4
  s_cselect_b32 s35, s50, s52
  s_cselect_b32 s36, s51, s53
  s_add_u32 s12, s35, s34
  s_addc_u32 s13, s36, 0
  s_mov_b32 s14, 262144
  s_mov_b32 s15, 0x00020000
  s_bitcmp0_b32 s28, 1
  s_cselect_b32 s35, s50, s52
  s_cselect_b32 s36, s51, s53
  s_add_u32 s4, s35, s34
  s_addc_u32 s5, s36, 0
  s_mov_b32 s6, 262144
  s_mov_b32 s7, 0x00020000
  s_add_u32 s64, s50, s34
  s_addc_u32 s65, s51, 0
  s_add_u32 s66, s52, s34
  s_addc_u32 s67, s53, 0
  s_mov_b32 s56, s64
  s_mov_b32 s57, s65
  s_mov_b32 s58, 262144
  s_mov_b32 s59, 0x00020000
  s_lshl_b32 s34, s28, 16
  s_sub_u32 s35, s28, 4
  s_mul_i32 s35, s35, 81920
  s_cmp_lt_u32 s28, 4
  s_cselect_b32 s39, s34, s35
  s_cselect_b32 s40, 262144, 64
  s_mov_b32 s41, 20480
  s_mov_b32 s42, 40960
  s_mov_b32 s43, 61440
  s_cselect_b32 s41, 256, s41
  s_cselect_b32 s42, 32768, s42
  s_cselect_b32 s43, 33024, s43
  s_cselect_b64 vcc, -1, 0
  s_lshl_b32 s44, s28, 12
  v_lshrrev_b32 v156, 4, v1
  v_bfe_u32 v157, v1, 2, 2
  v_and_b32 v158, 3, v1
  v_lshlrev_b32 v159, 6, v156
  v_lshl_add_u32 v159, v158, 4, v159
  v_lshl_add_u32 v163, v157, 13, v159
  v_lshl_add_u32 v160, v157, 8, v159
  v_lshrrev_b32 v161, 2, v1
  v_mul_u32_u24 v161, 1280, v161
  v_xor_b32 v162, v158, v156
  v_lshl_add_u32 v161, v162, 4, v161
  v_cndmask_b32 v2, v161, v163, vcc
  s_cmp_ge_u32 s28, 7
  s_cbranch_scc1 K1_NOQ0
  s_add_u32 m0, s44, 0
  s_nop 0
  buffer_load_dwordx4 v2, s[8:11], s39 offen lds
  s_add_u32 m0, s44, 1024
  s_add_u32 s35, s39, s41
  buffer_load_dwordx4 v2, s[8:11], s35 offen lds
  s_add_u32 m0, s44, 2048
  s_add_u32 s35, s39, s42
  buffer_load_dwordx4 v2, s[8:11], s35 offen lds
  s_add_u32 m0, s44, 3072
  s_add_u32 s35, s39, s43
  buffer_load_dwordx4 v2, s[8:11], s35 offen lds
  s_add_u32 s39, s39, s40
  s_add_u32 m0, s44, 28672
  s_nop 0
  buffer_load_dwordx4 v2, s[8:11], s39 offen lds
  s_add_u32 m0, s44, 29696
  s_add_u32 s35, s39, s41
  buffer_load_dwordx4 v2, s[8:11], s35 offen lds
  s_add_u32 m0, s44, 30720
  s_add_u32 s35, s39, s42
  buffer_load_dwordx4 v2, s[8:11], s35 offen lds
  s_add_u32 m0, s44, 31744
  s_add_u32 s35, s39, s43
  buffer_load_dwordx4 v2, s[8:11], s35 offen lds
  s_add_u32 s39, s39, s40
  s_add_u32 m0, s44, 57344
  s_nop 0
  buffer_load_dwordx4 v2, s[8:11], s39 offen lds
  s_add_u32 m0, s44, 58368
  s_add_u32 s35, s39, s41
  buffer_load_dwordx4 v2, s[8:11], s35 offen lds
  s_add_u32 m0, s44, 59392
  s_add_u32 s35, s39, s42
  buffer_load_dwordx4 v2, s[8:11], s35 offen lds
  s_add_u32 m0, s44, 60416
  s_add_u32 s35, s39, s43
  buffer_load_dwordx4 v2, s[8:11], s35 offen lds
  s_add_u32 s39, s39, s40
  s_add_u32 m0, s44, 86016
  s_nop 0
  buffer_load_dwordx4 v2, s[8:11], s39 offen lds
  s_add_u32 m0, s44, 87040
  s_add_u32 s35, s39, s41
  buffer_load_dwordx4 v2, s[8:11], s35 offen lds
  s_add_u32 m0, s44, 88064
  s_add_u32 s35, s39, s42
  buffer_load_dwordx4 v2, s[8:11], s35 offen lds
  s_add_u32 m0, s44, 89088
  s_add_u32 s35, s39, s43
  buffer_load_dwordx4 v2, s[8:11], s35 offen lds
  s_add_u32 s39, s39, s40
  s_add_u32 m0, s44, 114688
  s_nop 0
  buffer_load_dwordx4 v2, s[8:11], s39 offen lds
  s_add_u32 m0, s44, 115712
  s_add_u32 s35, s39, s41
  buffer_load_dwordx4 v2, s[8:11], s35 offen lds
  s_add_u32 m0, s44, 116736
  s_add_u32 s35, s39, s42
  buffer_load_dwordx4 v2, s[8:11], s35 offen lds
  s_add_u32 m0, s44, 117760
  s_add_u32 s35, s39, s43
  buffer_load_dwordx4 v2, s[8:11], s35 offen lds
  s_add_u32 s39, s39, s40
K1_NOQ0:
  v_and_b32 v161, 15, v1
  v_xor_b32 v161, v161, v156
  v_lshlrev_b32 v161, 4, v161
  v_lshl_add_u32 v161, v156, 8, v161
  v_xor_b32 v162, 0, v161
  v_cndmask_b32 v6, v160, v162, vcc
  v_xor_b32 v162, 64, v161
  v_cndmask_b32 v7, v160, v162, vcc
  v_xor_b32 v162, 128, v161
  v_cndmask_b32 v8, v160, v162, vcc
  v_xor_b32 v162, 192, v161
  v_cndmask_b32 v9, v160, v162, vcc
  s_bitcmp0_b32 s28, 1
  s_cselect_b64 vcc, -1, 0
  v_xor_b32 v162, 0, v161
  v_cndmask_b32 v12, v160, v162, vcc
  v_xor_b32 v162, 64, v161
  v_cndmask_b32 v13, v160, v162, vcc
  v_xor_b32 v162, 128, v161
  v_cndmask_b32 v14, v160, v162, vcc
  v_xor_b32 v162, 192, v161
  v_cndmask_b32 v15, v160, v162, vcc
  v_and_b32 v157, 31, v1
  v_lshrrev_b32 v158, 5, v1
  v_bfe_u32 v159, v1, 2, 2
  v_xor_b32 v159, v159, v158
  v_lshlrev_b32 v159, 4, v159
  v_lshl_add_u32 v159, v157, 6, v159
  s_lshl_b32 s34, s33, 11
  s_add_u32 s34, s34, 16384
  v_add_u32 v3, s34, v159
  v_xor_b32 v4, 32, v3
  v_bfe_u32 v159, v1, 2, 2
  v_lshlrev_b32 v159, 6, v159
  v_lshl_add_u32 v159, v158, 12, v159
  v_bfe_u32 v160, v1, 4, 1
  v_lshl_add_u32 v159, v160, 5, v159
  v_and_b32 v160, 1, v1
  v_lshl_add_u32 v161, v160, 4, v159
  v_bfe_u32 v160, v1, 1, 1
  v_lshl_add_u32 v161, v160, 3, v161
  s_lshl_b32 s34, s32, 10
  v_add_u32 v5, s34, v161
  v_bfe_u32 v160, v1, 2, 2
  v_lshlrev_b32 v160, 6, v160
  v_lshl_add_u32 v160, v158, 10, v160
  v_bfe_u32 v161, v1, 4, 1
  v_lshl_add_u32 v160, v161, 5, v160
  v_and_b32 v161, 3, v1
  v_lshl_add_u32 v160, v161, 3, v160
  s_lshl_b32 s34, s32, 13
  s_add_u32 s35, s34, 16384
  v_add_u32 v11, s35, v160
  v_and_b32 v160, 15, v1
  v_xor_b32 v160, v160, v158
  v_lshlrev_b32 v160, 4, v160
  v_lshl_add_u32 v160, v157, 8, v160
  v_add_u32 v10, s34, v160
  v_bfe_u32 v159, v1, 4, 1
  v_lshlrev_b32 v159, 4, v159
  v_lshl_add_u32 v159, v158, 2, v159
  v_bfe_u32 v160, v1, 2, 2
  v_add_u32 v159, v159, v160
  v_mul_u32_u24 v159, 160, v159
  v_and_b32 v160, 3, v1
  v_lshl_add_u32 v164, v160, 3, v159
  v_lshlrev_b32 v165, 4, v1
  s_bfe_u32 s34, s28, 0x10001
  s_and_b32 s35, s28, 1
  s_lshl_b32 s46, s34, 17
  s_lshl_b32 s36, s35, 12
  s_add_u32 s46, s46, s36
  s_lshr_b32 s37, s28, 2
  s_lshl_b32 s47, s37, 14
  s_lshl_b32 s34, s34, 13
  s_add_u32 s47, s47, s34
  s_add_u32 s47, s47, s36
  s_lshr_b32 s26, s2, 4
  s_xor_b32 s26, s26, s2
  s_and_b32 s73, s26, 15
  s_lshr_b32 s34, s28, 2
  s_add_u32 s35, s26, s34
  s_bitcmp0_b32 s28, 1
  s_addc_u32 s35, s35, 0
  s_and_b32 s35, s35, 15
  s_lshl_b32 s35, s35, 13
  s_and_b32 s36, s28, 1
  s_lshl_b32 s37, s36, 17
  s_add_u32 s27, s35, s37
  s_lshl_b32 s72, s34, 15
  s_lshl_b32 s36, s36, 13
  s_add_u32 s72, s72, s36
  s_bfe_u32 s36, s28, 0x10001
  s_lshl_b32 s36, s36, 14
  s_add_u32 s72, s72, s36
  s_add_u32 s26, s26, 3
  s_cmp_lt_u32 s28, 4
  s_addc_u32 s26, s26, 0
  s_cmp_ge_u32 s28, 4
  s_cbranch_scc1 K1_NOK0
  s_lshl_b32 s74, s73, 13
  s_add_u32 s74, s74, s46
  s_add_u32 s75, s47, 147456
  s_add_u32 m0, s75, 0
  s_add_u32 s35, s74, 0
  buffer_load_dwordx4 v6, s[12:15], s35 offen nt lds
  s_add_u32 m0, s75, 1024
  s_add_u32 s35, s74, 1024
  buffer_load_dwordx4 v7, s[12:15], s35 offen nt lds
  s_add_u32 m0, s75, 2048
  s_add_u32 s35, s74, 2048
  buffer_load_dwordx4 v8, s[12:15], s35 offen nt lds
  s_add_u32 m0, s75, 3072
  s_add_u32 s35, s74, 3072
  buffer_load_dwordx4 v9, s[12:15], s35 offen nt lds
K1_NOK0:
  v_mov_b32 v48, 0
  v_mov_b32 v49, 0
  v_mov_b32 v50, 0
  v_mov_b32 v51, 0
  v_mov_b32 v52, 0
  v_mov_b32 v53, 0
  v_mov_b32 v54, 0
  v_mov_b32 v55, 0
  v_mov_b32 v56, 0
  v_mov_b32 v57, 0
  v_mov_b32 v58, 0
  v_mov_b32 v59, 0
  v_mov_b32 v60, 0
  v_mov_b32 v61, 0
  v_mov_b32 v62, 0
  v_mov_b32 v63, 0
  v_mov_b32 v64, 0
  v_mov_b32 v65, 0
  v_mov_b32 v66, 0
  v_mov_b32 v67, 0
  v_mov_b32 v68, 0
  v_mov_b32 v69, 0
  v_mov_b32 v70, 0
  v_mov_b32 v71, 0
  v_mov_b32 v72, 0
  v_mov_b32 v73, 0
  v_mov_b32 v74, 0
  v_mov_b32 v75, 0
  v_mov_b32 v76, 0
  v_mov_b32 v77, 0
  v_mov_b32 v78, 0
  v_mov_b32 v79, 0
  v_mov_b32 v80, 0
  v_mov_b32 v81, 0
  v_mov_b32 v82, 0
  v_mov_b32 v83, 0
  v_mov_b32 v84, 0
  v_mov_b32 v85, 0
  v_mov_b32 v86, 0
  v_mov_b32 v87, 0
  v_mov_b32 v88, 0
  v_mov_b32 v89, 0
  v_mov_b32 v90, 0
  v_mov_b32 v91, 0
  v_mov_b32 v92, 0
  v_mov_b32 v93, 0
  v_mov_b32 v94, 0
  v_mov_b32 v95, 0
  v_mov_b32 v96, 0
  v_mov_b32 v97, 0
  v_mov_b32 v98, 0
  v_mov_b32 v99, 0
  v_mov_b32 v100, 0
  v_mov_b32 v101, 0
  v_mov_b32 v102, 0
  v_mov_b32 v103, 0
  v_mov_b32 v104, 0
  v_mov_b32 v105, 0
  v_mov_b32 v106, 0
  v_mov_b32 v107, 0
  v_mov_b32 v108, 0
  v_mov_b32 v109, 0
  v_mov_b32 v110, 0
  v_mov_b32 v111, 0
  s_cmp_ge_u32 s28, 7
  s_cbranch_scc1 K1_QB
  s_waitcnt vmcnt(12)
  s_barrier
  v_add_u32 v152, 0, v3
  v_add_u32 v153, 0, v4
  v_add_u32 v154, 0, v5
  ds_read_b128 v[128:131], v152
  ds_read_b64_tr_b16 v[112:113], v154 offset:0
  ds_read_b64_tr_b16 v[114:115], v154 offset:2048
  ds_read_b64_tr_b16 v[116:117], v154 offset:256
  ds_read_b64_tr_b16 v[118:119], v154 offset:2304
  ds_read_b64_tr_b16 v[120:121], v154 offset:512
  ds_read_b64_tr_b16 v[122:123], v154 offset:2560
  ds_read_b64_tr_b16 v[124:125], v154 offset:768
  ds_read_b64_tr_b16 v[126:127], v154 offset:2816
  ds_read_b128 v[148:151], v153
  ds_read_b64_tr_b16 v[132:133], v154 offset:8192
  ds_read_b64_tr_b16 v[134:135], v154 offset:10240
  ds_read_b64_tr_b16 v[136:137], v154 offset:8448
  ds_read_b64_tr_b16 v[138:139], v154 offset:10496
  ds_read_b64_tr_b16 v[140:141], v154 offset:8704
  ds_read_b64_tr_b16 v[142:143], v154 offset:10752
  ds_read_b64_tr_b16 v[144:145], v154 offset:8960
  ds_read_b64_tr_b16 v[146:147], v154 offset:11008
  s_waitcnt lgkmcnt(9)
  v_mfma_f32_32x32x16_bf16 v[48:63], v[112:115], v[128:131], v[48:63]
  v_mfma_f32_32x32x16_bf16 v[64:79], v[116:119], v[128:131], v[64:79]
  v_mfma_f32_32x32x16_bf16 v[80:95], v[120:123], v[128:131], v[80:95]
  v_mfma_f32_32x32x16_bf16 v[96:111], v[124:127], v[128:131], v[96:111]
  v_add_u32 v152, 28672, v3
  v_add_u32 v153, 28672, v4
  v_add_u32 v154, 28672, v5
  ds_read_b128 v[128:131], v152
  ds_read_b64_tr_b16 v[112:113], v154 offset:0
  ds_read_b64_tr_b16 v[114:115], v154 offset:2048
  ds_read_b64_tr_b16 v[116:117], v154 offset:256
  ds_read_b64_tr_b16 v[118:119], v154 offset:2304
  ds_read_b64_tr_b16 v[120:121], v154 offset:512
  ds_read_b64_tr_b16 v[122:123], v154 offset:2560
  ds_read_b64_tr_b16 v[124:125], v154 offset:768
  ds_read_b64_tr_b16 v[126:127], v154 offset:2816
  s_waitcnt lgkmcnt(9)
  v_mfma_f32_32x32x16_bf16 v[48:63], v[132:135], v[148:151], v[48:63]
  v_mfma_f32_32x32x16_bf16 v[64:79], v[136:139], v[148:151], v[64:79]
  v_mfma_f32_32x32x16_bf16 v[80:95], v[140:143], v[148:151], v[80:95]
  v_mfma_f32_32x32x16_bf16 v[96:111], v[144:147], v[148:151], v[96:111]
  s_waitcnt vmcnt(8)
  s_barrier
  ds_read_b128 v[148:151], v153
  ds_read_b64_tr_b16 v[132:133], v154 offset:8192
  ds_read_b64_tr_b16 v[134:135], v154 offset:10240
  ds_read_b64_tr_b16 v[136:137], v154 offset:8448
  ds_read_b64_tr_b16 v[138:139], v154 offset:10496
  ds_read_b64_tr_b16 v[140:141], v154 offset:8704
  ds_read_b64_tr_b16 v[142:143], v154 offset:10752
  ds_read_b64_tr_b16 v[144:145], v154 offset:8960
  ds_read_b64_tr_b16 v[146:147], v154 offset:11008
  s_waitcnt lgkmcnt(9)
  v_mfma_f32_32x32x16_bf16 v[48:63], v[112:115], v[128:131], v[48:63]
  s_add_u32 m0, s44, 0
  s_nop 0
  buffer_load_dwordx4 v2, s[8:11], s39 offen lds
  v_mfma_f32_32x32x16_bf16 v[64:79], v[116:119], v[128:131], v[64:79]
  v_mfma_f32_32x32x16_bf16 v[80:95], v[120:123], v[128:131], v[80:95]
  s_add_u32 m0, s44, 1024
  s_add_u32 s35, s39, s41
  buffer_load_dwordx4 v2, s[8:11], s35 offen lds
  v_mfma_f32_32x32x16_bf16 v[96:111], v[124:127], v[128:131], v[96:111]
  v_add_u32 v152, 57344, v3
  v_add_u32 v153, 57344, v4
  v_add_u32 v154, 57344, v5
  ds_read_b128 v[128:131], v152
  ds_read_b64_tr_b16 v[112:113], v154 offset:0
  ds_read_b64_tr_b16 v[114:115], v154 offset:2048
  ds_read_b64_tr_b16 v[116:117], v154 offset:256
  ds_read_b64_tr_b16 v[118:119], v154 offset:2304
  ds_read_b64_tr_b16 v[120:121], v154 offset:512
  ds_read_b64_tr_b16 v[122:123], v154 offset:2560
  ds_read_b64_tr_b16 v[124:125], v154 offset:768
  ds_read_b64_tr_b16 v[126:127], v154 offset:2816
  s_waitcnt lgkmcnt(9)
  v_mfma_f32_32x32x16_bf16 v[48:63], v[132:135], v[148:151], v[48:63]
  s_add_u32 m0, s44, 2048
  s_add_u32 s35, s39, s42
  buffer_load_dwordx4 v2, s[8:11], s35 offen lds
  v_mfma_f32_32x32x16_bf16 v[64:79], v[136:139], v[148:151], v[64:79]
  v_mfma_f32_32x32x16_bf16 v[80:95], v[140:143], v[148:151], v[80:95]
  s_add_u32 m0, s44, 3072
  s_add_u32 s35, s39, s43
  buffer_load_dwordx4 v2, s[8:11], s35 offen lds
  s_add_u32 s39, s39, s40
  v_mfma_f32_32x32x16_bf16 v[96:111], v[144:147], v[148:151], v[96:111]
  s_waitcnt vmcnt(8)
  s_barrier
  ds_read_b128 v[148:151], v153
  ds_read_b64_tr_b16 v[132:133], v154 offset:8192
  ds_read_b64_tr_b16 v[134:135], v154 offset:10240
  ds_read_b64_tr_b16 v[136:137], v154 offset:8448
  ds_read_b64_tr_b16 v[138:139], v154 offset:10496
  ds_read_b64_tr_b16 v[140:141], v154 offset:8704
  ds_read_b64_tr_b16 v[142:143], v154 offset:10752
  ds_read_b64_tr_b16 v[144:145], v154 offset:8960
  ds_read_b64_tr_b16 v[146:147], v154 offset:11008
  s_waitcnt lgkmcnt(9)
  v_mfma_f32_32x32x16_bf16 v[48:63], v[112:115], v[128:131], v[48:63]
  s_add_u32 m0, s44, 28672
  s_nop 0
  buffer_load_dwordx4 v2, s[8:11], s39 offen lds
  v_mfma_f32_32x32x16_bf16 v[64:79], v[116:119], v[128:131], v[64:79]
  v_mfma_f32_32x32x16_bf16 v[80:95], v[120:123], v[128:131], v[80:95]
  s_add_u32 m0, s44, 29696
  s_add_u32 s35, s39, s41
  buffer_load_dwordx4 v2, s[8:11], s35 offen lds
  v_mfma_f32_32x32x16_bf16 v[96:111], v[124:127], v[128:131], v[96:111]
  v_add_u32 v152, 86016, v3
  v_add_u32 v153, 86016, v4
  v_add_u32 v154, 86016, v5
  ds_read_b128 v[128:131], v152
  ds_read_b64_tr_b16 v[112:113], v154 offset:0
  ds_read_b64_tr_b16 v[114:115], v154 offset:2048
  ds_read_b64_tr_b16 v[116:117], v154 offset:256
  ds_read_b64_tr_b16 v[118:119], v154 offset:2304
  ds_read_b64_tr_b16 v[120:121], v154 offset:512
  ds_read_b64_tr_b16 v[122:123], v154 offset:2560
  ds_read_b64_tr_b16 v[124:125], v154 offset:768
  ds_read_b64_tr_b16 v[126:127], v154 offset:2816
  s_waitcnt lgkmcnt(9)
  v_mfma_f32_32x32x16_bf16 v[48:63], v[132:135], v[148:151], v[48:63]
  s_add_u32 m0, s44, 30720
  s_add_u32 s35, s39, s42
  buffer_load_dwordx4 v2, s[8:11], s35 offen lds
  v_mfma_f32_32x32x16_bf16 v[64:79], v[136:139], v[148:151], v[64:79]
  v_mfma_f32_32x32x16_bf16 v[80:95], v[140:143], v[148:151], v[80:95]
  s_add_u32 m0, s44, 31744
  s_add_u32 s35, s39, s43
  buffer_load_dwordx4 v2, s[8:11], s35 offen lds
  s_add_u32 s39, s39, s40
  v_mfma_f32_32x32x16_bf16 v[96:111], v[144:147], v[148:151], v[96:111]
  s_waitcnt vmcnt(8)
  s_barrier
  ds_read_b128 v[148:151], v153
  ds_read_b64_tr_b16 v[132:133], v154 offset:8192
  ds_read_b64_tr_b16 v[134:135], v154 offset:10240
  ds_read_b64_tr_b16 v[136:137], v154 offset:8448
  ds_read_b64_tr_b16 v[138:139], v154 offset:10496
  ds_read_b64_tr_b16 v[140:141], v154 offset:8704
  ds_read_b64_tr_b16 v[142:143], v154 offset:10752
  ds_read_b64_tr_b16 v[144:145], v154 offset:8960
  ds_read_b64_tr_b16 v[146:147], v154 offset:11008
  s_waitcnt lgkmcnt(9)
  v_mfma_f32_32x32x16_bf16 v[48:63], v[112:115], v[128:131], v[48:63]
  s_add_u32 m0, s44, 57344
  s_nop 0
  buffer_load_dwordx4 v2, s[8:11], s39 offen lds
  v_mfma_f32_32x32x16_bf16 v[64:79], v[116:119], v[128:131], v[64:79]
  v_mfma_f32_32x32x16_bf16 v[80:95], v[120:123], v[128:131], v[80:95]
  s_add_u32 m0, s44, 58368
  s_add_u32 s35, s39, s41
  buffer_load_dwordx4 v2, s[8:11], s35 offen lds
  v_mfma_f32_32x32x16_bf16 v[96:111], v[124:127], v[128:131], v[96:111]
  v_add_u32 v152, 114688, v3
  v_add_u32 v153, 114688, v4
  v_add_u32 v154, 114688, v5
  ds_read_b128 v[128:131], v152
  ds_read_b64_tr_b16 v[112:113], v154 offset:0
  ds_read_b64_tr_b16 v[114:115], v154 offset:2048
  ds_read_b64_tr_b16 v[116:117], v154 offset:256
  ds_read_b64_tr_b16 v[118:119], v154 offset:2304
  ds_read_b64_tr_b16 v[120:121], v154 offset:512
  ds_read_b64_tr_b16 v[122:123], v154 offset:2560
  ds_read_b64_tr_b16 v[124:125], v154 offset:768
  ds_read_b64_tr_b16 v[126:127], v154 offset:2816
  s_waitcnt lgkmcnt(9)
  v_mfma_f32_32x32x16_bf16 v[48:63], v[132:135], v[148:151], v[48:63]
  s_add_u32 m0, s44, 59392
  s_add_u32 s35, s39, s42
  buffer_load_dwordx4 v2, s[8:11], s35 offen lds
  v_mfma_f32_32x32x16_bf16 v[64:79], v[136:139], v[148:151], v[64:79]
  v_mfma_f32_32x32x16_bf16 v[80:95], v[140:143], v[148:151], v[80:95]
  s_add_u32 m0, s44, 60416
  s_add_u32 s35, s39, s43
  buffer_load_dwordx4 v2, s[8:11], s35 offen lds
  s_add_u32 s39, s39, s40
  v_mfma_f32_32x32x16_bf16 v[96:111], v[144:147], v[148:151], v[96:111]
  s_waitcnt vmcnt(8)
  s_barrier
  ds_read_b128 v[148:151], v153
  ds_read_b64_tr_b16 v[132:133], v154 offset:8192
  ds_read_b64_tr_b16 v[134:135], v154 offset:10240
  ds_read_b64_tr_b16 v[136:137], v154 offset:8448
  ds_read_b64_tr_b16 v[138:139], v154 offset:10496
  ds_read_b64_tr_b16 v[140:141], v154 offset:8704
  ds_read_b64_tr_b16 v[142:143], v154 offset:10752
  ds_read_b64_tr_b16 v[144:145], v154 offset:8960
  ds_read_b64_tr_b16 v[146:147], v154 offset:11008
  s_waitcnt lgkmcnt(9)
  v_mfma_f32_32x32x16_bf16 v[48:63], v[112:115], v[128:131], v[48:63]
  s_add_u32 m0, s44, 86016
  s_nop 0
  buffer_load_dwordx4 v2, s[8:11], s39 offen lds
  v_mfma_f32_32x32x16_bf16 v[64:79], v[116:119], v[128:131], v[64:79]
  v_mfma_f32_32x32x16_bf16 v[80:95], v[120:123], v[128:131], v[80:95]
  s_add_u32 m0, s44, 87040
  s_add_u32 s35, s39, s41
  buffer_load_dwordx4 v2, s[8:11], s35 offen lds
  v_mfma_f32_32x32x16_bf16 v[96:111], v[124:127], v[128:131], v[96:111]
  v_add_u32 v152, 0, v3
  v_add_u32 v153, 0, v4
  v_add_u32 v154, 0, v5
  ds_read_b128 v[128:131], v152
  ds_read_b64_tr_b16 v[112:113], v154 offset:0
  ds_read_b64_tr_b16 v[114:115], v154 offset:2048
  ds_read_b64_tr_b16 v[116:117], v154 offset:256
  ds_read_b64_tr_b16 v[118:119], v154 offset:2304
  ds_read_b64_tr_b16 v[120:121], v154 offset:512
  ds_read_b64_tr_b16 v[122:123], v154 offset:2560
  ds_read_b64_tr_b16 v[124:125], v154 offset:768
  ds_read_b64_tr_b16 v[126:127], v154 offset:2816
  s_waitcnt lgkmcnt(9)
  v_mfma_f32_32x32x16_bf16 v[48:63], v[132:135], v[148:151], v[48:63]
  s_add_u32 m0, s44, 88064
  s_add_u32 s35, s39, s42
  buffer_load_dwordx4 v2, s[8:11], s35 offen lds
  v_mfma_f32_32x32x16_bf16 v[64:79], v[136:139], v[148:151], v[64:79]
  v_mfma_f32_32x32x16_bf16 v[80:95], v[140:143], v[148:151], v[80:95]
  s_add_u32 m0, s44, 89088
  s_add_u32 s35, s39, s43
  buffer_load_dwordx4 v2, s[8:11], s35 offen lds
  s_add_u32 s39, s39, s40
  v_mfma_f32_32x32x16_bf16 v[96:111], v[144:147], v[148:151], v[96:111]
  s_waitcnt vmcnt(8)
  s_barrier
  ds_read_b128 v[148:151], v153
  ds_read_b64_tr_b16 v[132:133], v154 offset:8192
  ds_read_b64_tr_b16 v[134:135], v154 offset:10240
  ds_read_b64_tr_b16 v[136:137], v154 offset:8448
  ds_read_b64_tr_b16 v[138:139], v154 offset:10496
  ds_read_b64_tr_b16 v[140:141], v154 offset:8704
  ds_read_b64_tr_b16 v[142:143], v154 offset:10752
  ds_read_b64_tr_b16 v[144:145], v154 offset:8960
  ds_read_b64_tr_b16 v[146:147], v154 offset:11008
  s_waitcnt lgkmcnt(9)
  v_mfma_f32_32x32x16_bf16 v[48:63], v[112:115], v[128:131], v[48:63]
  s_add_u32 m0, s44, 114688
  s_nop 0
  buffer_load_dwordx4 v2, s[8:11], s39 offen lds
  v_mfma_f32_32x32x16_bf16 v[64:79], v[116:119], v[128:131], v[64:79]
  v_mfma_f32_32x32x16_bf16 v[80:95], v[120:123], v[128:131], v[80:95]
  s_add_u32 m0, s44, 115712
  s_add_u32 s35, s39, s41
  buffer_load_dwordx4 v2, s[8:11], s35 offen lds
  v_mfma_f32_32x32x16_bf16 v[96:111], v[124:127], v[128:131], v[96:111]
  v_add_u32 v152, 28672, v3
  v_add_u32 v153, 28672, v4
  v_add_u32 v154, 28672, v5
  ds_read_b128 v[128:131], v152
  ds_read_b64_tr_b16 v[112:113], v154 offset:0
  ds_read_b64_tr_b16 v[114:115], v154 offset:2048
  ds_read_b64_tr_b16 v[116:117], v154 offset:256
  ds_read_b64_tr_b16 v[118:119], v154 offset:2304
  ds_read_b64_tr_b16 v[120:121], v154 offset:512
  ds_read_b64_tr_b16 v[122:123], v154 offset:2560
  ds_read_b64_tr_b16 v[124:125], v154 offset:768
  ds_read_b64_tr_b16 v[126:127], v154 offset:2816
  s_waitcnt lgkmcnt(9)
  v_mfma_f32_32x32x16_bf16 v[48:63], v[132:135], v[148:151], v[48:63]
  s_add_u32 m0, s44, 116736
  s_add_u32 s35, s39, s42
  buffer_load_dwordx4 v2, s[8:11], s35 offen lds
  v_mfma_f32_32x32x16_bf16 v[64:79], v[136:139], v[148:151], v[64:79]
  v_mfma_f32_32x32x16_bf16 v[80:95], v[140:143], v[148:151], v[80:95]
  s_add_u32 m0, s44, 117760
  s_add_u32 s35, s39, s43
  buffer_load_dwordx4 v2, s[8:11], s35 offen lds
  s_add_u32 s39, s39, s40
  v_mfma_f32_32x32x16_bf16 v[96:111], v[144:147], v[148:151], v[96:111]
  s_waitcnt vmcnt(8)
  s_barrier
  ds_read_b128 v[148:151], v153
  ds_read_b64_tr_b16 v[132:133], v154 offset:8192
  ds_read_b64_tr_b16 v[134:135], v154 offset:10240
  ds_read_b64_tr_b16 v[136:137], v154 offset:8448
  ds_read_b64_tr_b16 v[138:139], v154 offset:10496
  ds_read_b64_tr_b16 v[140:141], v154 offset:8704
  ds_read_b64_tr_b16 v[142:143], v154 offset:10752
  ds_read_b64_tr_b16 v[144:145], v154 offset:8960
  ds_read_b64_tr_b16 v[146:147], v154 offset:11008
  s_waitcnt lgkmcnt(9)
  v_mfma_f32_32x32x16_bf16 v[48:63], v[112:115], v[128:131], v[48:63]
  s_add_u32 m0, s44, 0
  s_nop 0
  buffer_load_dwordx4 v2, s[8:11], s39 offen lds
  v_mfma_f32_32x32x16_bf16 v[64:79], v[116:119], v[128:131], v[64:79]
  v_mfma_f32_32x32x16_bf16 v[80:95], v[120:123], v[128:131], v[80:95]
  s_add_u32 m0, s44, 1024
  s_add_u32 s35, s39, s41
  buffer_load_dwordx4 v2, s[8:11], s35 offen lds
  v_mfma_f32_32x32x16_bf16 v[96:111], v[124:127], v[128:131], v[96:111]
  v_add_u32 v152, 57344, v3
  v_add_u32 v153, 57344, v4
  v_add_u32 v154, 57344, v5
  ds_read_b128 v[128:131], v152
  ds_read_b64_tr_b16 v[112:113], v154 offset:0
  ds_read_b64_tr_b16 v[114:115], v154 offset:2048
  ds_read_b64_tr_b16 v[116:117], v154 offset:256
  ds_read_b64_tr_b16 v[118:119], v154 offset:2304
  ds_read_b64_tr_b16 v[120:121], v154 offset:512
  ds_read_b64_tr_b16 v[122:123], v154 offset:2560
  ds_read_b64_tr_b16 v[124:125], v154 offset:768
  ds_read_b64_tr_b16 v[126:127], v154 offset:2816
  s_waitcnt lgkmcnt(9)
  v_mfma_f32_32x32x16_bf16 v[48:63], v[132:135], v[148:151], v[48:63]
  s_add_u32 m0, s44, 2048
  s_add_u32 s35, s39, s42
  buffer_load_dwordx4 v2, s[8:11], s35 offen lds
  v_mfma_f32_32x32x16_bf16 v[64:79], v[136:139], v[148:151], v[64:79]
  v_mfma_f32_32x32x16_bf16 v[80:95], v[140:143], v[148:151], v[80:95]
  s_add_u32 m0, s44, 3072
  s_add_u32 s35, s39, s43
  buffer_load_dwordx4 v2, s[8:11], s35 offen lds
  s_add_u32 s39, s39, s40
  v_mfma_f32_32x32x16_bf16 v[96:111], v[144:147], v[148:151], v[96:111]
  s_waitcnt vmcnt(8)
  s_barrier
  ds_read_b128 v[148:151], v153
  ds_read_b64_tr_b16 v[132:133], v154 offset:8192
  ds_read_b64_tr_b16 v[134:135], v154 offset:10240
  ds_read_b64_tr_b16 v[136:137], v154 offset:8448
  ds_read_b64_tr_b16 v[138:139], v154 offset:10496
  ds_read_b64_tr_b16 v[140:141], v154 offset:8704
  ds_read_b64_tr_b16 v[142:143], v154 offset:10752
  ds_read_b64_tr_b16 v[144:145], v154 offset:8960
  ds_read_b64_tr_b16 v[146:147], v154 offset:11008
  s_waitcnt lgkmcnt(9)
  v_mfma_f32_32x32x16_bf16 v[48:63], v[112:115], v[128:131], v[48:63]
  s_add_u32 m0, s44, 28672
  s_nop 0
  buffer_load_dwordx4 v2, s[8:11], s39 offen lds
  v_mfma_f32_32x32x16_bf16 v[64:79], v[116:119], v[128:131], v[64:79]
  v_mfma_f32_32x32x16_bf16 v[80:95], v[120:123], v[128:131], v[80:95]
  s_add_u32 m0, s44, 29696
  s_add_u32 s35, s39, s41
  buffer_load_dwordx4 v2, s[8:11], s35 offen lds
  v_mfma_f32_32x32x16_bf16 v[96:111], v[124:127], v[128:131], v[96:111]
  v_add_u32 v152, 86016, v3
  v_add_u32 v153, 86016, v4
  v_add_u32 v154, 86016, v5
  ds_read_b128 v[128:131], v152
  ds_read_b64_tr_b16 v[112:113], v154 offset:0
  ds_read_b64_tr_b16 v[114:115], v154 offset:2048
  ds_read_b64_tr_b16 v[116:117], v154 offset:256
  ds_read_b64_tr_b16 v[118:119], v154 offset:2304
  ds_read_b64_tr_b16 v[120:121], v154 offset:512
  ds_read_b64_tr_b16 v[122:123], v154 offset:2560
  ds_read_b64_tr_b16 v[124:125], v154 offset:768
  ds_read_b64_tr_b16 v[126:127], v154 offset:2816
  s_waitcnt lgkmcnt(9)
  v_mfma_f32_32x32x16_bf16 v[48:63], v[132:135], v[148:151], v[48:63]
  s_add_u32 m0, s44, 30720
  s_add_u32 s35, s39, s42
  buffer_load_dwordx4 v2, s[8:11], s35 offen lds
  v_mfma_f32_32x32x16_bf16 v[64:79], v[136:139], v[148:151], v[64:79]
  v_mfma_f32_32x32x16_bf16 v[80:95], v[140:143], v[148:151], v[80:95]
  s_add_u32 m0, s44, 31744
  s_add_u32 s35, s39, s43
  buffer_load_dwordx4 v2, s[8:11], s35 offen lds
  s_add_u32 s39, s39, s40
  v_mfma_f32_32x32x16_bf16 v[96:111], v[144:147], v[148:151], v[96:111]
  s_waitcnt vmcnt(8)
  s_barrier
  ds_read_b128 v[148:151], v153
  ds_read_b64_tr_b16 v[132:133], v154 offset:8192
  ds_read_b64_tr_b16 v[134:135], v154 offset:10240
  ds_read_b64_tr_b16 v[136:137], v154 offset:8448
  ds_read_b64_tr_b16 v[138:139], v154 offset:10496
  ds_read_b64_tr_b16 v[140:141], v154 offset:8704
  ds_read_b64_tr_b16 v[142:143], v154 offset:10752
  ds_read_b64_tr_b16 v[144:145], v154 offset:8960
  ds_read_b64_tr_b16 v[146:147], v154 offset:11008
  s_waitcnt lgkmcnt(9)
  v_mfma_f32_32x32x16_bf16 v[48:63], v[112:115], v[128:131], v[48:63]
  s_add_u32 m0, s44, 57344
  s_nop 0
  buffer_load_dwordx4 v2, s[8:11], s39 offen lds
  v_mfma_f32_32x32x16_bf16 v[64:79], v[116:119], v[128:131], v[64:79]
  v_mfma_f32_32x32x16_bf16 v[80:95], v[120:123], v[128:131], v[80:95]
  s_add_u32 m0, s44, 58368
  s_add_u32 s35, s39, s41
  buffer_load_dwordx4 v2, s[8:11], s35 offen lds
  v_mfma_f32_32x32x16_bf16 v[96:111], v[124:127], v[128:131], v[96:111]
  v_add_u32 v152, 114688, v3
  v_add_u32 v153, 114688, v4
  v_add_u32 v154, 114688, v5
  ds_read_b128 v[128:131], v152
  ds_read_b64_tr_b16 v[112:113], v154 offset:0
  ds_read_b64_tr_b16 v[114:115], v154 offset:2048
  ds_read_b64_tr_b16 v[116:117], v154 offset:256
  ds_read_b64_tr_b16 v[118:119], v154 offset:2304
  ds_read_b64_tr_b16 v[120:121], v154 offset:512
  ds_read_b64_tr_b16 v[122:123], v154 offset:2560
  ds_read_b64_tr_b16 v[124:125], v154 offset:768
  ds_read_b64_tr_b16 v[126:127], v154 offset:2816
  s_waitcnt lgkmcnt(9)
  v_mfma_f32_32x32x16_bf16 v[48:63], v[132:135], v[148:151], v[48:63]
  s_add_u32 m0, s44, 59392
  s_add_u32 s35, s39, s42
  buffer_load_dwordx4 v2, s[8:11], s35 offen lds
  v_mfma_f32_32x32x16_bf16 v[64:79], v[136:139], v[148:151], v[64:79]
  v_mfma_f32_32x32x16_bf16 v[80:95], v[140:143], v[148:151], v[80:95]
  s_add_u32 m0, s44, 60416
  s_add_u32 s35, s39, s43
  buffer_load_dwordx4 v2, s[8:11], s35 offen lds
  s_add_u32 s39, s39, s40
  v_mfma_f32_32x32x16_bf16 v[96:111], v[144:147], v[148:151], v[96:111]
  s_waitcnt vmcnt(8)
  s_barrier
  ds_read_b128 v[148:151], v153
  ds_read_b64_tr_b16 v[132:133], v154 offset:8192
  ds_read_b64_tr_b16 v[134:135], v154 offset:10240
  ds_read_b64_tr_b16 v[136:137], v154 offset:8448
  ds_read_b64_tr_b16 v[138:139], v154 offset:10496
  ds_read_b64_tr_b16 v[140:141], v154 offset:8704
  ds_read_b64_tr_b16 v[142:143], v154 offset:10752
  ds_read_b64_tr_b16 v[144:145], v154 offset:8960
  ds_read_b64_tr_b16 v[146:147], v154 offset:11008
  s_waitcnt lgkmcnt(9)
  v_mfma_f32_32x32x16_bf16 v[48:63], v[112:115], v[128:131], v[48:63]
  s_add_u32 m0, s44, 86016
  s_nop 0
  buffer_load_dwordx4 v2, s[8:11], s39 offen lds
  v_mfma_f32_32x32x16_bf16 v[64:79], v[116:119], v[128:131], v[64:79]
  v_mfma_f32_32x32x16_bf16 v[80:95], v[120:123], v[128:131], v[80:95]
  s_add_u32 m0, s44, 87040
  s_add_u32 s35, s39, s41
  buffer_load_dwordx4 v2, s[8:11], s35 offen lds
  v_mfma_f32_32x32x16_bf16 v[96:111], v[124:127], v[128:131], v[96:111]
  v_add_u32 v152, 0, v3
  v_add_u32 v153, 0, v4
  v_add_u32 v154, 0, v5
  ds_read_b128 v[128:131], v152
  ds_read_b64_tr_b16 v[112:113], v154 offset:0
  ds_read_b64_tr_b16 v[114:115], v154 offset:2048
  ds_read_b64_tr_b16 v[116:117], v154 offset:256
  ds_read_b64_tr_b16 v[118:119], v154 offset:2304
  ds_read_b64_tr_b16 v[120:121], v154 offset:512
  ds_read_b64_tr_b16 v[122:123], v154 offset:2560
  ds_read_b64_tr_b16 v[124:125], v154 offset:768
  ds_read_b64_tr_b16 v[126:127], v154 offset:2816
  s_waitcnt lgkmcnt(9)
  v_mfma_f32_32x32x16_bf16 v[48:63], v[132:135], v[148:151], v[48:63]
  s_add_u32 m0, s44, 88064
  s_add_u32 s35, s39, s42
  buffer_load_dwordx4 v2, s[8:11], s35 offen lds
  v_mfma_f32_32x32x16_bf16 v[64:79], v[136:139], v[148:151], v[64:79]
  v_mfma_f32_32x32x16_bf16 v[80:95], v[140:143], v[148:151], v[80:95]
  s_add_u32 m0, s44, 89088
  s_add_u32 s35, s39, s43
  buffer_load_dwordx4 v2, s[8:11], s35 offen lds
  s_add_u32 s39, s39, s40
  v_mfma_f32_32x32x16_bf16 v[96:111], v[144:147], v[148:151], v[96:111]
  s_waitcnt vmcnt(8)
  s_barrier
  ds_read_b128 v[148:151], v153
  ds_read_b64_tr_b16 v[132:133], v154 offset:8192
  ds_read_b64_tr_b16 v[134:135], v154 offset:10240
  ds_read_b64_tr_b16 v[136:137], v154 offset:8448
  ds_read_b64_tr_b16 v[138:139], v154 offset:10496
  ds_read_b64_tr_b16 v[140:141], v154 offset:8704
  ds_read_b64_tr_b16 v[142:143], v154 offset:10752
  ds_read_b64_tr_b16 v[144:145], v154 offset:8960
  ds_read_b64_tr_b16 v[146:147], v154 offset:11008
  s_waitcnt lgkmcnt(9)
  v_mfma_f32_32x32x16_bf16 v[48:63], v[112:115], v[128:131], v[48:63]
  s_add_u32 m0, s44, 114688
  s_nop 0
  buffer_load_dwordx4 v2, s[8:11], s39 offen lds
  v_mfma_f32_32x32x16_bf16 v[64:79], v[116:119], v[128:131], v[64:79]
  v_mfma_f32_32x32x16_bf16 v[80:95], v[120:123], v[128:131], v[80:95]
  s_add_u32 m0, s44, 115712
  s_add_u32 s35, s39, s41
  buffer_load_dwordx4 v2, s[8:11], s35 offen lds
  v_mfma_f32_32x32x16_bf16 v[96:111], v[124:127], v[128:131], v[96:111]
  v_add_u32 v152, 28672, v3
  v_add_u32 v153, 28672, v4
  v_add_u32 v154, 28672, v5
  ds_read_b128 v[128:131], v152
  ds_read_b64_tr_b16 v[112:113], v154 offset:0
  ds_read_b64_tr_b16 v[114:115], v154 offset:2048
  ds_read_b64_tr_b16 v[116:117], v154 offset:256
  ds_read_b64_tr_b16 v[118:119], v154 offset:2304
  ds_read_b64_tr_b16 v[120:121], v154 offset:512
  ds_read_b64_tr_b16 v[122:123], v154 offset:2560
  ds_read_b64_tr_b16 v[124:125], v154 offset:768
  ds_read_b64_tr_b16 v[126:127], v154 offset:2816
  s_waitcnt lgkmcnt(9)
  v_mfma_f32_32x32x16_bf16 v[48:63], v[132:135], v[148:151], v[48:63]
  s_add_u32 m0, s44, 116736
  s_add_u32 s35, s39, s42
  buffer_load_dwordx4 v2, s[8:11], s35 offen lds
  v_mfma_f32_32x32x16_bf16 v[64:79], v[136:139], v[148:151], v[64:79]
  v_mfma_f32_32x32x16_bf16 v[80:95], v[140:143], v[148:151], v[80:95]
  s_add_u32 m0, s44, 117760
  s_add_u32 s35, s39, s43
  buffer_load_dwordx4 v2, s[8:11], s35 offen lds
  s_add_u32 s39, s39, s40
  v_mfma_f32_32x32x16_bf16 v[96:111], v[144:147], v[148:151], v[96:111]
  s_waitcnt vmcnt(8)
  s_barrier
  ds_read_b128 v[148:151], v153
  ds_read_b64_tr_b16 v[132:133], v154 offset:8192
  ds_read_b64_tr_b16 v[134:135], v154 offset:10240
  ds_read_b64_tr_b16 v[136:137], v154 offset:8448
  ds_read_b64_tr_b16 v[138:139], v154 offset:10496
  ds_read_b64_tr_b16 v[140:141], v154 offset:8704
  ds_read_b64_tr_b16 v[142:143], v154 offset:10752
  ds_read_b64_tr_b16 v[144:145], v154 offset:8960
  ds_read_b64_tr_b16 v[146:147], v154 offset:11008
  s_waitcnt lgkmcnt(9)
  v_mfma_f32_32x32x16_bf16 v[48:63], v[112:115], v[128:131], v[48:63]
  s_add_u32 m0, s44, 0
  s_nop 0
  buffer_load_dwordx4 v2, s[8:11], s39 offen lds
  v_mfma_f32_32x32x16_bf16 v[64:79], v[116:119], v[128:131], v[64:79]
  v_mfma_f32_32x32x16_bf16 v[80:95], v[120:123], v[128:131], v[80:95]
  s_add_u32 m0, s44, 1024
  s_add_u32 s35, s39, s41
  buffer_load_dwordx4 v2, s[8:11], s35 offen lds
  v_mfma_f32_32x32x16_bf16 v[96:111], v[124:127], v[128:131], v[96:111]
  v_add_u32 v152, 57344, v3
  v_add_u32 v153, 57344, v4
  v_add_u32 v154, 57344, v5
  ds_read_b128 v[128:131], v152
  ds_read_b64_tr_b16 v[112:113], v154 offset:0
  ds_read_b64_tr_b16 v[114:115], v154 offset:2048
  ds_read_b64_tr_b16 v[116:117], v154 offset:256
  ds_read_b64_tr_b16 v[118:119], v154 offset:2304
  ds_read_b64_tr_b16 v[120:121], v154 offset:512
  ds_read_b64_tr_b16 v[122:123], v154 offset:2560
  ds_read_b64_tr_b16 v[124:125], v154 offset:768
  ds_read_b64_tr_b16 v[126:127], v154 offset:2816
  s_waitcnt lgkmcnt(9)
  v_mfma_f32_32x32x16_bf16 v[48:63], v[132:135], v[148:151], v[48:63]
  s_add_u32 m0, s44, 2048
  s_add_u32 s35, s39, s42
  buffer_load_dwordx4 v2, s[8:11], s35 offen lds
  v_mfma_f32_32x32x16_bf16 v[64:79], v[136:139], v[148:151], v[64:79]
  v_mfma_f32_32x32x16_bf16 v[80:95], v[140:143], v[148:151], v[80:95]
  s_add_u32 m0, s44, 3072
  s_add_u32 s35, s39, s43
  buffer_load_dwordx4 v2, s[8:11], s35 offen lds
  s_add_u32 s39, s39, s40
  v_mfma_f32_32x32x16_bf16 v[96:111], v[144:147], v[148:151], v[96:111]
  s_waitcnt vmcnt(8)
  s_barrier
  ds_read_b128 v[148:151], v153
  ds_read_b64_tr_b16 v[132:133], v154 offset:8192
  ds_read_b64_tr_b16 v[134:135], v154 offset:10240
  ds_read_b64_tr_b16 v[136:137], v154 offset:8448
  ds_read_b64_tr_b16 v[138:139], v154 offset:10496
  ds_read_b64_tr_b16 v[140:141], v154 offset:8704
  ds_read_b64_tr_b16 v[142:143], v154 offset:10752
  ds_read_b64_tr_b16 v[144:145], v154 offset:8960
  ds_read_b64_tr_b16 v[146:147], v154 offset:11008
  s_waitcnt lgkmcnt(9)
  v_mfma_f32_32x32x16_bf16 v[48:63], v[112:115], v[128:131], v[48:63]
  s_add_u32 m0, s44, 28672
  s_nop 0
  buffer_load_dwordx4 v2, s[8:11], s39 offen lds
  v_mfma_f32_32x32x16_bf16 v[64:79], v[116:119], v[128:131], v[64:79]
  v_mfma_f32_32x32x16_bf16 v[80:95], v[120:123], v[128:131], v[80:95]
  s_add_u32 m0, s44, 29696
  s_add_u32 s35, s39, s41
  buffer_load_dwordx4 v2, s[8:11], s35 offen lds
  v_mfma_f32_32x32x16_bf16 v[96:111], v[124:127], v[128:131], v[96:111]
  v_add_u32 v152, 86016, v3
  v_add_u32 v153, 86016, v4
  v_add_u32 v154, 86016, v5
  ds_read_b128 v[128:131], v152
  ds_read_b64_tr_b16 v[112:113], v154 offset:0
  ds_read_b64_tr_b16 v[114:115], v154 offset:2048
  ds_read_b64_tr_b16 v[116:117], v154 offset:256
  ds_read_b64_tr_b16 v[118:119], v154 offset:2304
  ds_read_b64_tr_b16 v[120:121], v154 offset:512
  ds_read_b64_tr_b16 v[122:123], v154 offset:2560
  ds_read_b64_tr_b16 v[124:125], v154 offset:768
  ds_read_b64_tr_b16 v[126:127], v154 offset:2816
  s_waitcnt lgkmcnt(9)
  v_mfma_f32_32x32x16_bf16 v[48:63], v[132:135], v[148:151], v[48:63]
  s_add_u32 m0, s44, 30720
  s_add_u32 s35, s39, s42
  buffer_load_dwordx4 v2, s[8:11], s35 offen lds
  v_mfma_f32_32x32x16_bf16 v[64:79], v[136:139], v[148:151], v[64:79]
  v_mfma_f32_32x32x16_bf16 v[80:95], v[140:143], v[148:151], v[80:95]
  s_add_u32 m0, s44, 31744
  s_add_u32 s35, s39, s43
  buffer_load_dwordx4 v2, s[8:11], s35 offen lds
  s_add_u32 s39, s39, s40
  v_mfma_f32_32x32x16_bf16 v[96:111], v[144:147], v[148:151], v[96:111]
  s_waitcnt vmcnt(8)
  s_barrier
  ds_read_b128 v[148:151], v153
  ds_read_b64_tr_b16 v[132:133], v154 offset:8192
  ds_read_b64_tr_b16 v[134:135], v154 offset:10240
  ds_read_b64_tr_b16 v[136:137], v154 offset:8448
  ds_read_b64_tr_b16 v[138:139], v154 offset:10496
  ds_read_b64_tr_b16 v[140:141], v154 offset:8704
  ds_read_b64_tr_b16 v[142:143], v154 offset:10752
  ds_read_b64_tr_b16 v[144:145], v154 offset:8960
  ds_read_b64_tr_b16 v[146:147], v154 offset:11008
  s_waitcnt lgkmcnt(9)
  v_mfma_f32_32x32x16_bf16 v[48:63], v[112:115], v[128:131], v[48:63]
  s_add_u32 m0, s44, 57344
  s_nop 0
  buffer_load_dwordx4 v2, s[8:11], s39 offen lds
  v_mfma_f32_32x32x16_bf16 v[64:79], v[116:119], v[128:131], v[64:79]
  v_mfma_f32_32x32x16_bf16 v[80:95], v[120:123], v[128:131], v[80:95]
  s_add_u32 m0, s44, 58368
  s_add_u32 s35, s39, s41
  buffer_load_dwordx4 v2, s[8:11], s35 offen lds
  v_mfma_f32_32x32x16_bf16 v[96:111], v[124:127], v[128:131], v[96:111]
  v_add_u32 v152, 114688, v3
  v_add_u32 v153, 114688, v4
  v_add_u32 v154, 114688, v5
  ds_read_b128 v[128:131], v152
  ds_read_b64_tr_b16 v[112:113], v154 offset:0
  ds_read_b64_tr_b16 v[114:115], v154 offset:2048
  ds_read_b64_tr_b16 v[116:117], v154 offset:256
  ds_read_b64_tr_b16 v[118:119], v154 offset:2304
  ds_read_b64_tr_b16 v[120:121], v154 offset:512
  ds_read_b64_tr_b16 v[122:123], v154 offset:2560
  ds_read_b64_tr_b16 v[124:125], v154 offset:768
  ds_read_b64_tr_b16 v[126:127], v154 offset:2816
  s_waitcnt lgkmcnt(9)
  v_mfma_f32_32x32x16_bf16 v[48:63], v[132:135], v[148:151], v[48:63]
  s_add_u32 m0, s44, 59392
  s_add_u32 s35, s39, s42
  buffer_load_dwordx4 v2, s[8:11], s35 offen lds
  v_mfma_f32_32x32x16_bf16 v[64:79], v[136:139], v[148:151], v[64:79]
  v_mfma_f32_32x32x16_bf16 v[80:95], v[140:143], v[148:151], v[80:95]
  s_add_u32 m0, s44, 60416
  s_add_u32 s35, s39, s43
  buffer_load_dwordx4 v2, s[8:11], s35 offen lds
  s_add_u32 s39, s39, s40
  v_mfma_f32_32x32x16_bf16 v[96:111], v[144:147], v[148:151], v[96:111]
  s_waitcnt vmcnt(8)
  s_barrier
  ds_read_b128 v[148:151], v153
  ds_read_b64_tr_b16 v[132:133], v154 offset:8192
  ds_read_b64_tr_b16 v[134:135], v154 offset:10240
  ds_read_b64_tr_b16 v[136:137], v154 offset:8448
  ds_read_b64_tr_b16 v[138:139], v154 offset:10496
  ds_read_b64_tr_b16 v[140:141], v154 offset:8704
  ds_read_b64_tr_b16 v[142:143], v154 offset:10752
  ds_read_b64_tr_b16 v[144:145], v154 offset:8960
  ds_read_b64_tr_b16 v[146:147], v154 offset:11008
  s_waitcnt lgkmcnt(9)
  v_mfma_f32_32x32x16_bf16 v[48:63], v[112:115], v[128:131], v[48:63]
  s_add_u32 m0, s44, 86016
  s_nop 0
  buffer_load_dwordx4 v2, s[8:11], s39 offen lds
  v_mfma_f32_32x32x16_bf16 v[64:79], v[116:119], v[128:131], v[64:79]
  v_mfma_f32_32x32x16_bf16 v[80:95], v[120:123], v[128:131], v[80:95]
  s_add_u32 m0, s44, 87040
  s_add_u32 s35, s39, s41
  buffer_load_dwordx4 v2, s[8:11], s35 offen lds
  v_mfma_f32_32x32x16_bf16 v[96:111], v[124:127], v[128:131], v[96:111]
  v_add_u32 v152, 0, v3
  v_add_u32 v153, 0, v4
  v_add_u32 v154, 0, v5
  ds_read_b128 v[128:131], v152
  ds_read_b64_tr_b16 v[112:113], v154 offset:0
  ds_read_b64_tr_b16 v[114:115], v154 offset:2048
  ds_read_b64_tr_b16 v[116:117], v154 offset:256
  ds_read_b64_tr_b16 v[118:119], v154 offset:2304
  ds_read_b64_tr_b16 v[120:121], v154 offset:512
  ds_read_b64_tr_b16 v[122:123], v154 offset:2560
  ds_read_b64_tr_b16 v[124:125], v154 offset:768
  ds_read_b64_tr_b16 v[126:127], v154 offset:2816
  s_waitcnt lgkmcnt(9)
  v_mfma_f32_32x32x16_bf16 v[48:63], v[132:135], v[148:151], v[48:63]
  s_add_u32 m0, s44, 88064
  s_add_u32 s35, s39, s42
  buffer_load_dwordx4 v2, s[8:11], s35 offen lds
  v_mfma_f32_32x32x16_bf16 v[64:79], v[136:139], v[148:151], v[64:79]
  v_mfma_f32_32x32x16_bf16 v[80:95], v[140:143], v[148:151], v[80:95]
  s_add_u32 m0, s44, 89088
  s_add_u32 s35, s39, s43
  buffer_load_dwordx4 v2, s[8:11], s35 offen lds
  s_add_u32 s39, s39, s40
  v_mfma_f32_32x32x16_bf16 v[96:111], v[144:147], v[148:151], v[96:111]
  s_waitcnt vmcnt(8)
  s_barrier
  ds_read_b128 v[148:151], v153
  ds_read_b64_tr_b16 v[132:133], v154 offset:8192
  ds_read_b64_tr_b16 v[134:135], v154 offset:10240
  ds_read_b64_tr_b16 v[136:137], v154 offset:8448
  ds_read_b64_tr_b16 v[138:139], v154 offset:10496
  ds_read_b64_tr_b16 v[140:141], v154 offset:8704
  ds_read_b64_tr_b16 v[142:143], v154 offset:10752
  ds_read_b64_tr_b16 v[144:145], v154 offset:8960
  ds_read_b64_tr_b16 v[146:147], v154 offset:11008
  s_waitcnt lgkmcnt(9)
  v_mfma_f32_32x32x16_bf16 v[48:63], v[112:115], v[128:131], v[48:63]
  s_add_u32 m0, s44, 114688
  s_nop 0
  buffer_load_dwordx4 v2, s[8:11], s39 offen lds
  v_mfma_f32_32x32x16_bf16 v[64:79], v[116:119], v[128:131], v[64:79]
  v_mfma_f32_32x32x16_bf16 v[80:95], v[120:123], v[128:131], v[80:95]
  s_add_u32 m0, s44, 115712
  s_add_u32 s35, s39, s41
  buffer_load_dwordx4 v2, s[8:11], s35 offen lds
  v_mfma_f32_32x32x16_bf16 v[96:111], v[124:127], v[128:131], v[96:111]
  v_add_u32 v152, 28672, v3
  v_add_u32 v153, 28672, v4
  v_add_u32 v154, 28672, v5
  ds_read_b128 v[128:131], v152
  ds_read_b64_tr_b16 v[112:113], v154 offset:0
  ds_read_b64_tr_b16 v[114:115], v154 offset:2048
  ds_read_b64_tr_b16 v[116:117], v154 offset:256
  ds_read_b64_tr_b16 v[118:119], v154 offset:2304
  ds_read_b64_tr_b16 v[120:121], v154 offset:512
  ds_read_b64_tr_b16 v[122:123], v154 offset:2560
  ds_read_b64_tr_b16 v[124:125], v154 offset:768
  ds_read_b64_tr_b16 v[126:127], v154 offset:2816
  s_waitcnt lgkmcnt(9)
  v_mfma_f32_32x32x16_bf16 v[48:63], v[132:135], v[148:151], v[48:63]
  s_add_u32 m0, s44, 116736
  s_add_u32 s35, s39, s42
  buffer_load_dwordx4 v2, s[8:11], s35 offen lds
  v_mfma_f32_32x32x16_bf16 v[64:79], v[136:139], v[148:151], v[64:79]
  v_mfma_f32_32x32x16_bf16 v[80:95], v[140:143], v[148:151], v[80:95]
  s_add_u32 m0, s44, 117760
  s_add_u32 s35, s39, s43
  buffer_load_dwordx4 v2, s[8:11], s35 offen lds
  s_add_u32 s39, s39, s40
  v_mfma_f32_32x32x16_bf16 v[96:111], v[144:147], v[148:151], v[96:111]
  s_waitcnt vmcnt(8)
  s_barrier
  ds_read_b128 v[148:151], v153
  ds_read_b64_tr_b16 v[132:133], v154 offset:8192
  ds_read_b64_tr_b16 v[134:135], v154 offset:10240
  ds_read_b64_tr_b16 v[136:137], v154 offset:8448
  ds_read_b64_tr_b16 v[138:139], v154 offset:10496
  ds_read_b64_tr_b16 v[140:141], v154 offset:8704
  ds_read_b64_tr_b16 v[142:143], v154 offset:10752
  ds_read_b64_tr_b16 v[144:145], v154 offset:8960
  ds_read_b64_tr_b16 v[146:147], v154 offset:11008
  s_waitcnt lgkmcnt(9)
  v_mfma_f32_32x32x16_bf16 v[48:63], v[112:115], v[128:131], v[48:63]
  v_mfma_f32_32x32x16_bf16 v[64:79], v[116:119], v[128:131], v[64:79]
  v_mfma_f32_32x32x16_bf16 v[80:95], v[120:123], v[128:131], v[80:95]
  v_mfma_f32_32x32x16_bf16 v[96:111], v[124:127], v[128:131], v[96:111]
  s_add_u32 s35, s27, 0
  buffer_load_dwordx4 v[16:19], v12, s[4:7], s35 offen nt
  v_add_u32 v152, 57344, v3
  v_add_u32 v153, 57344, v4
  v_add_u32 v154, 57344, v5
  ds_read_b128 v[128:131], v152
  ds_read_b64_tr_b16 v[112:113], v154 offset:0
  ds_read_b64_tr_b16 v[114:115], v154 offset:2048
  ds_read_b64_tr_b16 v[116:117], v154 offset:256
  ds_read_b64_tr_b16 v[118:119], v154 offset:2304
  ds_read_b64_tr_b16 v[120:121], v154 offset:512
  ds_read_b64_tr_b16 v[122:123], v154 offset:2560
  ds_read_b64_tr_b16 v[124:125], v154 offset:768
  ds_read_b64_tr_b16 v[126:127], v154 offset:2816
  s_waitcnt lgkmcnt(9)
  v_mfma_f32_32x32x16_bf16 v[48:63], v[132:135], v[148:151], v[48:63]
  v_mfma_f32_32x32x16_bf16 v[64:79], v[136:139], v[148:151], v[64:79]
  v_mfma_f32_32x32x16_bf16 v[80:95], v[140:143], v[148:151], v[80:95]
  v_mfma_f32_32x32x16_bf16 v[96:111], v[144:147], v[148:151], v[96:111]
  s_add_u32 s35, s27, 1024
  buffer_load_dwordx4 v[20:23], v13, s[4:7], s35 offen nt
  s_waitcnt vmcnt(6)
  s_barrier
  ds_read_b128 v[148:151], v153
  ds_read_b64_tr_b16 v[132:133], v154 offset:8192
  ds_read_b64_tr_b16 v[134:135], v154 offset:10240
  ds_read_b64_tr_b16 v[136:137], v154 offset:8448
  ds_read_b64_tr_b16 v[138:139], v154 offset:10496
  ds_read_b64_tr_b16 v[140:141], v154 offset:8704
  ds_read_b64_tr_b16 v[142:143], v154 offset:10752
  ds_read_b64_tr_b16 v[144:145], v154 offset:8960
  ds_read_b64_tr_b16 v[146:147], v154 offset:11008
  s_waitcnt lgkmcnt(9)
  v_mfma_f32_32x32x16_bf16 v[48:63], v[112:115], v[128:131], v[48:63]
  v_mfma_f32_32x32x16_bf16 v[64:79], v[116:119], v[128:131], v[64:79]
  v_mfma_f32_32x32x16_bf16 v[80:95], v[120:123], v[128:131], v[80:95]
  v_mfma_f32_32x32x16_bf16 v[96:111], v[124:127], v[128:131], v[96:111]
  s_add_u32 s35, s27, 2048
  buffer_load_dwordx4 v[24:27], v14, s[4:7], s35 offen nt
  v_add_u32 v152, 86016, v3
  v_add_u32 v153, 86016, v4
  v_add_u32 v154, 86016, v5
  ds_read_b128 v[128:131], v152
  ds_read_b64_tr_b16 v[112:113], v154 offset:0
  ds_read_b64_tr_b16 v[114:115], v154 offset:2048
  ds_read_b64_tr_b16 v[116:117], v154 offset:256
  ds_read_b64_tr_b16 v[118:119], v154 offset:2304
  ds_read_b64_tr_b16 v[120:121], v154 offset:512
  ds_read_b64_tr_b16 v[122:123], v154 offset:2560
  ds_read_b64_tr_b16 v[124:125], v154 offset:768
  ds_read_b64_tr_b16 v[126:127], v154 offset:2816
  s_waitcnt lgkmcnt(9)
  v_mfma_f32_32x32x16_bf16 v[48:63], v[132:135], v[148:151], v[48:63]
  v_mfma_f32_32x32x16_bf16 v[64:79], v[136:139], v[148:151], v[64:79]
  v_mfma_f32_32x32x16_bf16 v[80:95], v[140:143], v[148:151], v[80:95]
  v_mfma_f32_32x32x16_bf16 v[96:111], v[144:147], v[148:151], v[96:111]
  s_add_u32 s35, s27, 3072
  buffer_load_dwordx4 v[28:31], v15, s[4:7], s35 offen nt
  s_waitcnt vmcnt(4)
  s_barrier
  ds_read_b128 v[148:151], v153
  ds_read_b64_tr_b16 v[132:133], v154 offset:8192
  ds_read_b64_tr_b16 v[134:135], v154 offset:10240
  ds_read_b64_tr_b16 v[136:137], v154 offset:8448
  ds_read_b64_tr_b16 v[138:139], v154 offset:10496
  ds_read_b64_tr_b16 v[140:141], v154 offset:8704
  ds_read_b64_tr_b16 v[142:143], v154 offset:10752
  ds_read_b64_tr_b16 v[144:145], v154 offset:8960
  ds_read_b64_tr_b16 v[146:147], v154 offset:11008
  s_waitcnt lgkmcnt(9)
  v_mfma_f32_32x32x16_bf16 v[48:63], v[112:115], v[128:131], v[48:63]
  v_mfma_f32_32x32x16_bf16 v[64:79], v[116:119], v[128:131], v[64:79]
  v_mfma_f32_32x32x16_bf16 v[80:95], v[120:123], v[128:131], v[80:95]
  v_mfma_f32_32x32x16_bf16 v[96:111], v[124:127], v[128:131], v[96:111]
  s_add_u32 s35, s27, 4096
  buffer_load_dwordx4 v[32:35], v12, s[4:7], s35 offen nt
  v_add_u32 v152, 114688, v3
  v_add_u32 v153, 114688, v4
  v_add_u32 v154, 114688, v5
  ds_read_b128 v[128:131], v152
  ds_read_b64_tr_b16 v[112:113], v154 offset:0
  ds_read_b64_tr_b16 v[114:115], v154 offset:2048
  ds_read_b64_tr_b16 v[116:117], v154 offset:256
  ds_read_b64_tr_b16 v[118:119], v154 offset:2304
  ds_read_b64_tr_b16 v[120:121], v154 offset:512
  ds_read_b64_tr_b16 v[122:123], v154 offset:2560
  ds_read_b64_tr_b16 v[124:125], v154 offset:768
  ds_read_b64_tr_b16 v[126:127], v154 offset:2816
  s_waitcnt lgkmcnt(9)
  v_mfma_f32_32x32x16_bf16 v[48:63], v[132:135], v[148:151], v[48:63]
  v_mfma_f32_32x32x16_bf16 v[64:79], v[136:139], v[148:151], v[64:79]
  v_mfma_f32_32x32x16_bf16 v[80:95], v[140:143], v[148:151], v[80:95]
  v_mfma_f32_32x32x16_bf16 v[96:111], v[144:147], v[148:151], v[96:111]
  s_add_u32 s35, s27, 5120
  buffer_load_dwordx4 v[36:39], v13, s[4:7], s35 offen nt
  s_barrier
  ds_read_b128 v[148:151], v153
  ds_read_b64_tr_b16 v[132:133], v154 offset:8192
  ds_read_b64_tr_b16 v[134:135], v154 offset:10240
  ds_read_b64_tr_b16 v[136:137], v154 offset:8448
  ds_read_b64_tr_b16 v[138:139], v154 offset:10496
  ds_read_b64_tr_b16 v[140:141], v154 offset:8704
  ds_read_b64_tr_b16 v[142:143], v154 offset:10752
  ds_read_b64_tr_b16 v[144:145], v154 offset:8960
  ds_read_b64_tr_b16 v[146:147], v154 offset:11008
  s_waitcnt lgkmcnt(9)
  v_mfma_f32_32x32x16_bf16 v[48:63], v[112:115], v[128:131], v[48:63]
  v_mfma_f32_32x32x16_bf16 v[64:79], v[116:119], v[128:131], v[64:79]
  v_mfma_f32_32x32x16_bf16 v[80:95], v[120:123], v[128:131], v[80:95]
  v_mfma_f32_32x32x16_bf16 v[96:111], v[124:127], v[128:131], v[96:111]
  s_add_u32 s35, s27, 6144
  buffer_load_dwordx4 v[40:43], v14, s[4:7], s35 offen nt
  s_waitcnt lgkmcnt(0)
  v_mfma_f32_32x32x16_bf16 v[48:63], v[132:135], v[148:151], v[48:63]
  v_mfma_f32_32x32x16_bf16 v[64:79], v[136:139], v[148:151], v[64:79]
  v_mfma_f32_32x32x16_bf16 v[80:95], v[140:143], v[148:151], v[80:95]
  v_mfma_f32_32x32x16_bf16 v[96:111], v[144:147], v[148:151], v[96:111]
  s_add_u32 s35, s27, 7168
  buffer_load_dwordx4 v[44:47], v15, s[4:7], s35 offen nt
  s_branch K1_QEND
K1_QB:
  s_barrier
  v_add_u32 v152, 0, v3
  v_add_u32 v153, 0, v4
  v_add_u32 v154, 0, v5
  ds_read_b128 v[128:131], v152
  ds_read_b64_tr_b16 v[112:113], v154 offset:0
  ds_read_b64_tr_b16 v[114:115], v154 offset:2048
  ds_read_b64_tr_b16 v[116:117], v154 offset:256
  ds_read_b64_tr_b16 v[118:119], v154 offset:2304
  ds_read_b64_tr_b16 v[120:121], v154 offset:512
  ds_read_b64_tr_b16 v[122:123], v154 offset:2560
  ds_read_b64_tr_b16 v[124:125], v154 offset:768
  ds_read_b64_tr_b16 v[126:127], v154 offset:2816
  ds_read_b128 v[148:151], v153
  ds_read_b64_tr_b16 v[132:133], v154 offset:8192
  ds_read_b64_tr_b16 v[134:135], v154 offset:10240
  ds_read_b64_tr_b16 v[136:137], v154 offset:8448
  ds_read_b64_tr_b16 v[138:139], v154 offset:10496
  ds_read_b64_tr_b16 v[140:141], v154 offset:8704
  ds_read_b64_tr_b16 v[142:143], v154 offset:10752
  ds_read_b64_tr_b16 v[144:145], v154 offset:8960
  ds_read_b64_tr_b16 v[146:147], v154 offset:11008
  s_waitcnt lgkmcnt(9)
  v_mfma_f32_32x32x16_bf16 v[48:63], v[112:115], v[128:131], v[48:63]
  v_mfma_f32_32x32x16_bf16 v[64:79], v[116:119], v[128:131], v[64:79]
  v_mfma_f32_32x32x16_bf16 v[80:95], v[120:123], v[128:131], v[80:95]
  v_mfma_f32_32x32x16_bf16 v[96:111], v[124:127], v[128:131], v[96:111]
  v_add_u32 v152, 28672, v3
  v_add_u32 v153, 28672, v4
  v_add_u32 v154, 28672, v5
  ds_read_b128 v[128:131], v152
  ds_read_b64_tr_b16 v[112:113], v154 offset:0
  ds_read_b64_tr_b16 v[114:115], v154 offset:2048
  ds_read_b64_tr_b16 v[116:117], v154 offset:256
  ds_read_b64_tr_b16 v[118:119], v154 offset:2304
  ds_read_b64_tr_b16 v[120:121], v154 offset:512
  ds_read_b64_tr_b16 v[122:123], v154 offset:2560
  ds_read_b64_tr_b16 v[124:125], v154 offset:768
  ds_read_b64_tr_b16 v[126:127], v154 offset:2816
  s_waitcnt lgkmcnt(9)
  v_mfma_f32_32x32x16_bf16 v[48:63], v[132:135], v[148:151], v[48:63]
  v_mfma_f32_32x32x16_bf16 v[64:79], v[136:139], v[148:151], v[64:79]
  v_mfma_f32_32x32x16_bf16 v[80:95], v[140:143], v[148:151], v[80:95]
  v_mfma_f32_32x32x16_bf16 v[96:111], v[144:147], v[148:151], v[96:111]
  s_barrier
  ds_read_b128 v[148:151], v153
  ds_read_b64_tr_b16 v[132:133], v154 offset:8192
  ds_read_b64_tr_b16 v[134:135], v154 offset:10240
  ds_read_b64_tr_b16 v[136:137], v154 offset:8448
  ds_read_b64_tr_b16 v[138:139], v154 offset:10496
  ds_read_b64_tr_b16 v[140:141], v154 offset:8704
  ds_read_b64_tr_b16 v[142:143], v154 offset:10752
  ds_read_b64_tr_b16 v[144:145], v154 offset:8960
  ds_read_b64_tr_b16 v[146:147], v154 offset:11008
  s_waitcnt lgkmcnt(9)
  v_mfma_f32_32x32x16_bf16 v[48:63], v[112:115], v[128:131], v[48:63]
  v_mfma_f32_32x32x16_bf16 v[64:79], v[116:119], v[128:131], v[64:79]
  v_mfma_f32_32x32x16_bf16 v[80:95], v[120:123], v[128:131], v[80:95]
  v_mfma_f32_32x32x16_bf16 v[96:111], v[124:127], v[128:131], v[96:111]
  v_add_u32 v152, 57344, v3
  v_add_u32 v153, 57344, v4
  v_add_u32 v154, 57344, v5
  ds_read_b128 v[128:131], v152
  ds_read_b64_tr_b16 v[112:113], v154 offset:0
  ds_read_b64_tr_b16 v[114:115], v154 offset:2048
  ds_read_b64_tr_b16 v[116:117], v154 offset:256
  ds_read_b64_tr_b16 v[118:119], v154 offset:2304
  ds_read_b64_tr_b16 v[120:121], v154 offset:512
  ds_read_b64_tr_b16 v[122:123], v154 offset:2560
  ds_read_b64_tr_b16 v[124:125], v154 offset:768
  ds_read_b64_tr_b16 v[126:127], v154 offset:2816
  s_waitcnt lgkmcnt(9)
  v_mfma_f32_32x32x16_bf16 v[48:63], v[132:135], v[148:151], v[48:63]
  v_mfma_f32_32x32x16_bf16 v[64:79], v[136:139], v[148:151], v[64:79]
  v_mfma_f32_32x32x16_bf16 v[80:95], v[140:143], v[148:151], v[80:95]
  v_mfma_f32_32x32x16_bf16 v[96:111], v[144:147], v[148:151], v[96:111]
  s_add_u32 s35, s27, 0
  buffer_load_dwordx4 v[16:19], v12, s[4:7], s35 offen nt
  s_barrier
  ds_read_b128 v[148:151], v153
  ds_read_b64_tr_b16 v[132:133], v154 offset:8192
  ds_read_b64_tr_b16 v[134:135], v154 offset:10240
  ds_read_b64_tr_b16 v[136:137], v154 offset:8448
  ds_read_b64_tr_b16 v[138:139], v154 offset:10496
  ds_read_b64_tr_b16 v[140:141], v154 offset:8704
  ds_read_b64_tr_b16 v[142:143], v154 offset:10752
  ds_read_b64_tr_b16 v[144:145], v154 offset:8960
  ds_read_b64_tr_b16 v[146:147], v154 offset:11008
  s_waitcnt lgkmcnt(9)
  v_mfma_f32_32x32x16_bf16 v[48:63], v[112:115], v[128:131], v[48:63]
  v_mfma_f32_32x32x16_bf16 v[64:79], v[116:119], v[128:131], v[64:79]
  v_mfma_f32_32x32x16_bf16 v[80:95], v[120:123], v[128:131], v[80:95]
  v_mfma_f32_32x32x16_bf16 v[96:111], v[124:127], v[128:131], v[96:111]
  v_add_u32 v152, 86016, v3
  v_add_u32 v153, 86016, v4
  v_add_u32 v154, 86016, v5
  ds_read_b128 v[128:131], v152
  ds_read_b64_tr_b16 v[112:113], v154 offset:0
  ds_read_b64_tr_b16 v[114:115], v154 offset:2048
  ds_read_b64_tr_b16 v[116:117], v154 offset:256
  ds_read_b64_tr_b16 v[118:119], v154 offset:2304
  ds_read_b64_tr_b16 v[120:121], v154 offset:512
  ds_read_b64_tr_b16 v[122:123], v154 offset:2560
  ds_read_b64_tr_b16 v[124:125], v154 offset:768
  ds_read_b64_tr_b16 v[126:127], v154 offset:2816
  s_waitcnt lgkmcnt(9)
  v_mfma_f32_32x32x16_bf16 v[48:63], v[132:135], v[148:151], v[48:63]
  v_mfma_f32_32x32x16_bf16 v[64:79], v[136:139], v[148:151], v[64:79]
  v_mfma_f32_32x32x16_bf16 v[80:95], v[140:143], v[148:151], v[80:95]
  v_mfma_f32_32x32x16_bf16 v[96:111], v[144:147], v[148:151], v[96:111]
  s_add_u32 s35, s27, 1024
  buffer_load_dwordx4 v[20:23], v13, s[4:7], s35 offen nt
  s_barrier
  ds_read_b128 v[148:151], v153
  ds_read_b64_tr_b16 v[132:133], v154 offset:8192
  ds_read_b64_tr_b16 v[134:135], v154 offset:10240
  ds_read_b64_tr_b16 v[136:137], v154 offset:8448
  ds_read_b64_tr_b16 v[138:139], v154 offset:10496
  ds_read_b64_tr_b16 v[140:141], v154 offset:8704
  ds_read_b64_tr_b16 v[142:143], v154 offset:10752
  ds_read_b64_tr_b16 v[144:145], v154 offset:8960
  ds_read_b64_tr_b16 v[146:147], v154 offset:11008
  s_waitcnt lgkmcnt(9)
  v_mfma_f32_32x32x16_bf16 v[48:63], v[112:115], v[128:131], v[48:63]
  v_mfma_f32_32x32x16_bf16 v[64:79], v[116:119], v[128:131], v[64:79]
  v_mfma_f32_32x32x16_bf16 v[80:95], v[120:123], v[128:131], v[80:95]
  v_mfma_f32_32x32x16_bf16 v[96:111], v[124:127], v[128:131], v[96:111]
  v_add_u32 v152, 114688, v3
  v_add_u32 v153, 114688, v4
  v_add_u32 v154, 114688, v5
  ds_read_b128 v[128:131], v152
  ds_read_b64_tr_b16 v[112:113], v154 offset:0
  ds_read_b64_tr_b16 v[114:115], v154 offset:2048
  ds_read_b64_tr_b16 v[116:117], v154 offset:256
  ds_read_b64_tr_b16 v[118:119], v154 offset:2304
  ds_read_b64_tr_b16 v[120:121], v154 offset:512
  ds_read_b64_tr_b16 v[122:123], v154 offset:2560
  ds_read_b64_tr_b16 v[124:125], v154 offset:768
  ds_read_b64_tr_b16 v[126:127], v154 offset:2816
  s_waitcnt lgkmcnt(9)
  v_mfma_f32_32x32x16_bf16 v[48:63], v[132:135], v[148:151], v[48:63]
  v_mfma_f32_32x32x16_bf16 v[64:79], v[136:139], v[148:151], v[64:79]
  v_mfma_f32_32x32x16_bf16 v[80:95], v[140:143], v[148:151], v[80:95]
  v_mfma_f32_32x32x16_bf16 v[96:111], v[144:147], v[148:151], v[96:111]
  s_add_u32 s35, s27, 2048
  buffer_load_dwordx4 v[24:27], v14, s[4:7], s35 offen nt
  s_barrier
  ds_read_b128 v[148:151], v153
  ds_read_b64_tr_b16 v[132:133], v154 offset:8192
  ds_read_b64_tr_b16 v[134:135], v154 offset:10240
  ds_read_b64_tr_b16 v[136:137], v154 offset:8448
  ds_read_b64_tr_b16 v[138:139], v154 offset:10496
  ds_read_b64_tr_b16 v[140:141], v154 offset:8704
  ds_read_b64_tr_b16 v[142:143], v154 offset:10752
  ds_read_b64_tr_b16 v[144:145], v154 offset:8960
  ds_read_b64_tr_b16 v[146:147], v154 offset:11008
  s_waitcnt lgkmcnt(9)
  v_mfma_f32_32x32x16_bf16 v[48:63], v[112:115], v[128:131], v[48:63]
  v_mfma_f32_32x32x16_bf16 v[64:79], v[116:119], v[128:131], v[64:79]
  v_mfma_f32_32x32x16_bf16 v[80:95], v[120:123], v[128:131], v[80:95]
  v_mfma_f32_32x32x16_bf16 v[96:111], v[124:127], v[128:131], v[96:111]
  v_add_u32 v152, 0, v3
  v_add_u32 v153, 0, v4
  v_add_u32 v154, 0, v5
  ds_read_b128 v[128:131], v152
  ds_read_b64_tr_b16 v[112:113], v154 offset:0
  ds_read_b64_tr_b16 v[114:115], v154 offset:2048
  ds_read_b64_tr_b16 v[116:117], v154 offset:256
  ds_read_b64_tr_b16 v[118:119], v154 offset:2304
  ds_read_b64_tr_b16 v[120:121], v154 offset:512
  ds_read_b64_tr_b16 v[122:123], v154 offset:2560
  ds_read_b64_tr_b16 v[124:125], v154 offset:768
  ds_read_b64_tr_b16 v[126:127], v154 offset:2816
  s_waitcnt lgkmcnt(9)
  v_mfma_f32_32x32x16_bf16 v[48:63], v[132:135], v[148:151], v[48:63]
  v_mfma_f32_32x32x16_bf16 v[64:79], v[136:139], v[148:151], v[64:79]
  v_mfma_f32_32x32x16_bf16 v[80:95], v[140:143], v[148:151], v[80:95]
  v_mfma_f32_32x32x16_bf16 v[96:111], v[144:147], v[148:151], v[96:111]
  s_add_u32 s35, s27, 3072
  buffer_load_dwordx4 v[28:31], v15, s[4:7], s35 offen nt
  s_barrier
  ds_read_b128 v[148:151], v153
  ds_read_b64_tr_b16 v[132:133], v154 offset:8192
  ds_read_b64_tr_b16 v[134:135], v154 offset:10240
  ds_read_b64_tr_b16 v[136:137], v154 offset:8448
  ds_read_b64_tr_b16 v[138:139], v154 offset:10496
  ds_read_b64_tr_b16 v[140:141], v154 offset:8704
  ds_read_b64_tr_b16 v[142:143], v154 offset:10752
  ds_read_b64_tr_b16 v[144:145], v154 offset:8960
  ds_read_b64_tr_b16 v[146:147], v154 offset:11008
  s_waitcnt lgkmcnt(9)
  v_mfma_f32_32x32x16_bf16 v[48:63], v[112:115], v[128:131], v[48:63]
  v_mfma_f32_32x32x16_bf16 v[64:79], v[116:119], v[128:131], v[64:79]
  v_mfma_f32_32x32x16_bf16 v[80:95], v[120:123], v[128:131], v[80:95]
  v_mfma_f32_32x32x16_bf16 v[96:111], v[124:127], v[128:131], v[96:111]
  v_add_u32 v152, 28672, v3
  v_add_u32 v153, 28672, v4
  v_add_u32 v154, 28672, v5
  ds_read_b128 v[128:131], v152
  ds_read_b64_tr_b16 v[112:113], v154 offset:0
  ds_read_b64_tr_b16 v[114:115], v154 offset:2048
  ds_read_b64_tr_b16 v[116:117], v154 offset:256
  ds_read_b64_tr_b16 v[118:119], v154 offset:2304
  ds_read_b64_tr_b16 v[120:121], v154 offset:512
  ds_read_b64_tr_b16 v[122:123], v154 offset:2560
  ds_read_b64_tr_b16 v[124:125], v154 offset:768
  ds_read_b64_tr_b16 v[126:127], v154 offset:2816
  s_waitcnt lgkmcnt(9)
  v_mfma_f32_32x32x16_bf16 v[48:63], v[132:135], v[148:151], v[48:63]
  v_mfma_f32_32x32x16_bf16 v[64:79], v[136:139], v[148:151], v[64:79]
  v_mfma_f32_32x32x16_bf16 v[80:95], v[140:143], v[148:151], v[80:95]
  v_mfma_f32_32x32x16_bf16 v[96:111], v[144:147], v[148:151], v[96:111]
  s_add_u32 s35, s27, 4096
  buffer_load_dwordx4 v[32:35], v12, s[4:7], s35 offen nt
  s_barrier
  ds_read_b128 v[148:151], v153
  ds_read_b64_tr_b16 v[132:133], v154 offset:8192
  ds_read_b64_tr_b16 v[134:135], v154 offset:10240
  ds_read_b64_tr_b16 v[136:137], v154 offset:8448
  ds_read_b64_tr_b16 v[138:139], v154 offset:10496
  ds_read_b64_tr_b16 v[140:141], v154 offset:8704
  ds_read_b64_tr_b16 v[142:143], v154 offset:10752
  ds_read_b64_tr_b16 v[144:145], v154 offset:8960
  ds_read_b64_tr_b16 v[146:147], v154 offset:11008
  s_waitcnt lgkmcnt(9)
  v_mfma_f32_32x32x16_bf16 v[48:63], v[112:115], v[128:131], v[48:63]
  v_mfma_f32_32x32x16_bf16 v[64:79], v[116:119], v[128:131], v[64:79]
  v_mfma_f32_32x32x16_bf16 v[80:95], v[120:123], v[128:131], v[80:95]
  v_mfma_f32_32x32x16_bf16 v[96:111], v[124:127], v[128:131], v[96:111]
  v_add_u32 v152, 57344, v3
  v_add_u32 v153, 57344, v4
  v_add_u32 v154, 57344, v5
  ds_read_b128 v[128:131], v152
  ds_read_b64_tr_b16 v[112:113], v154 offset:0
  ds_read_b64_tr_b16 v[114:115], v154 offset:2048
  ds_read_b64_tr_b16 v[116:117], v154 offset:256
  ds_read_b64_tr_b16 v[118:119], v154 offset:2304
  ds_read_b64_tr_b16 v[120:121], v154 offset:512
  ds_read_b64_tr_b16 v[122:123], v154 offset:2560
  ds_read_b64_tr_b16 v[124:125], v154 offset:768
  ds_read_b64_tr_b16 v[126:127], v154 offset:2816
  s_waitcnt lgkmcnt(9)
  v_mfma_f32_32x32x16_bf16 v[48:63], v[132:135], v[148:151], v[48:63]
  v_mfma_f32_32x32x16_bf16 v[64:79], v[136:139], v[148:151], v[64:79]
  v_mfma_f32_32x32x16_bf16 v[80:95], v[140:143], v[148:151], v[80:95]
  v_mfma_f32_32x32x16_bf16 v[96:111], v[144:147], v[148:151], v[96:111]
  s_add_u32 s35, s27, 5120
  buffer_load_dwordx4 v[36:39], v13, s[4:7], s35 offen nt
  s_barrier
  ds_read_b128 v[148:151], v153
  ds_read_b64_tr_b16 v[132:133], v154 offset:8192
  ds_read_b64_tr_b16 v[134:135], v154 offset:10240
  ds_read_b64_tr_b16 v[136:137], v154 offset:8448
  ds_read_b64_tr_b16 v[138:139], v154 offset:10496
  ds_read_b64_tr_b16 v[140:141], v154 offset:8704
  ds_read_b64_tr_b16 v[142:143], v154 offset:10752
  ds_read_b64_tr_b16 v[144:145], v154 offset:8960
  ds_read_b64_tr_b16 v[146:147], v154 offset:11008
  s_waitcnt lgkmcnt(9)
  v_mfma_f32_32x32x16_bf16 v[48:63], v[112:115], v[128:131], v[48:63]
  v_mfma_f32_32x32x16_bf16 v[64:79], v[116:119], v[128:131], v[64:79]
  v_mfma_f32_32x32x16_bf16 v[80:95], v[120:123], v[128:131], v[80:95]
  v_mfma_f32_32x32x16_bf16 v[96:111], v[124:127], v[128:131], v[96:111]
  v_add_u32 v152, 86016, v3
  v_add_u32 v153, 86016, v4
  v_add_u32 v154, 86016, v5
  ds_read_b128 v[128:131], v152
  ds_read_b64_tr_b16 v[112:113], v154 offset:0
  ds_read_b64_tr_b16 v[114:115], v154 offset:2048
  ds_read_b64_tr_b16 v[116:117], v154 offset:256
  ds_read_b64_tr_b16 v[118:119], v154 offset:2304
  ds_read_b64_tr_b16 v[120:121], v154 offset:512
  ds_read_b64_tr_b16 v[122:123], v154 offset:2560
  ds_read_b64_tr_b16 v[124:125], v154 offset:768
  ds_read_b64_tr_b16 v[126:127], v154 offset:2816
  s_waitcnt lgkmcnt(9)
  v_mfma_f32_32x32x16_bf16 v[48:63], v[132:135], v[148:151], v[48:63]
  v_mfma_f32_32x32x16_bf16 v[64:79], v[136:139], v[148:151], v[64:79]
  v_mfma_f32_32x32x16_bf16 v[80:95], v[140:143], v[148:151], v[80:95]
  v_mfma_f32_32x32x16_bf16 v[96:111], v[144:147], v[148:151], v[96:111]
  s_add_u32 s35, s27, 6144
  buffer_load_dwordx4 v[40:43], v14, s[4:7], s35 offen nt
  s_barrier
  ds_read_b128 v[148:151], v153
  ds_read_b64_tr_b16 v[132:133], v154 offset:8192
  ds_read_b64_tr_b16 v[134:135], v154 offset:10240
  ds_read_b64_tr_b16 v[136:137], v154 offset:8448
  ds_read_b64_tr_b16 v[138:139], v154 offset:10496
  ds_read_b64_tr_b16 v[140:141], v154 offset:8704
  ds_read_b64_tr_b16 v[142:143], v154 offset:10752
  ds_read_b64_tr_b16 v[144:145], v154 offset:8960
  ds_read_b64_tr_b16 v[146:147], v154 offset:11008
  s_waitcnt lgkmcnt(9)
  v_mfma_f32_32x32x16_bf16 v[48:63], v[112:115], v[128:131], v[48:63]
  v_mfma_f32_32x32x16_bf16 v[64:79], v[116:119], v[128:131], v[64:79]
  v_mfma_f32_32x32x16_bf16 v[80:95], v[120:123], v[128:131], v[80:95]
  v_mfma_f32_32x32x16_bf16 v[96:111], v[124:127], v[128:131], v[96:111]
  v_add_u32 v152, 114688, v3
  v_add_u32 v153, 114688, v4
  v_add_u32 v154, 114688, v5
  ds_read_b128 v[128:131], v152
  ds_read_b64_tr_b16 v[112:113], v154 offset:0
  ds_read_b64_tr_b16 v[114:115], v154 offset:2048
  ds_read_b64_tr_b16 v[116:117], v154 offset:256
  ds_read_b64_tr_b16 v[118:119], v154 offset:2304
  ds_read_b64_tr_b16 v[120:121], v154 offset:512
  ds_read_b64_tr_b16 v[122:123], v154 offset:2560
  ds_read_b64_tr_b16 v[124:125], v154 offset:768
  ds_read_b64_tr_b16 v[126:127], v154 offset:2816
  s_waitcnt lgkmcnt(9)
  v_mfma_f32_32x32x16_bf16 v[48:63], v[132:135], v[148:151], v[48:63]
  v_mfma_f32_32x32x16_bf16 v[64:79], v[136:139], v[148:151], v[64:79]
  v_mfma_f32_32x32x16_bf16 v[80:95], v[140:143], v[148:151], v[80:95]
  v_mfma_f32_32x32x16_bf16 v[96:111], v[144:147], v[148:151], v[96:111]
  s_add_u32 s35, s27, 7168
  buffer_load_dwordx4 v[44:47], v15, s[4:7], s35 offen nt
  s_barrier
  ds_read_b128 v[148:151], v153
  ds_read_b64_tr_b16 v[132:133], v154 offset:8192
  ds_read_b64_tr_b16 v[134:135], v154 offset:10240
  ds_read_b64_tr_b16 v[136:137], v154 offset:8448
  ds_read_b64_tr_b16 v[138:139], v154 offset:10496
  ds_read_b64_tr_b16 v[140:141], v154 offset:8704
  ds_read_b64_tr_b16 v[142:143], v154 offset:10752
  ds_read_b64_tr_b16 v[144:145], v154 offset:8960
  ds_read_b64_tr_b16 v[146:147], v154 offset:11008
  s_waitcnt lgkmcnt(9)
  v_mfma_f32_32x32x16_bf16 v[48:63], v[112:115], v[128:131], v[48:63]
  v_mfma_f32_32x32x16_bf16 v[64:79], v[116:119], v[128:131], v[64:79]
  v_mfma_f32_32x32x16_bf16 v[80:95], v[120:123], v[128:131], v[80:95]
  v_mfma_f32_32x32x16_bf16 v[96:111], v[124:127], v[128:131], v[96:111]
  v_add_u32 v152, 0, v3
  v_add_u32 v153, 0, v4
  v_add_u32 v154, 0, v5
  ds_read_b128 v[128:131], v152
  ds_read_b64_tr_b16 v[112:113], v154 offset:0
  ds_read_b64_tr_b16 v[114:115], v154 offset:2048
  ds_read_b64_tr_b16 v[116:117], v154 offset:256
  ds_read_b64_tr_b16 v[118:119], v154 offset:2304
  ds_read_b64_tr_b16 v[120:121], v154 offset:512
  ds_read_b64_tr_b16 v[122:123], v154 offset:2560
  ds_read_b64_tr_b16 v[124:125], v154 offset:768
  ds_read_b64_tr_b16 v[126:127], v154 offset:2816
  s_waitcnt lgkmcnt(9)
  v_mfma_f32_32x32x16_bf16 v[48:63], v[132:135], v[148:151], v[48:63]
  v_mfma_f32_32x32x16_bf16 v[64:79], v[136:139], v[148:151], v[64:79]
  v_mfma_f32_32x32x16_bf16 v[80:95], v[140:143], v[148:151], v[80:95]
  v_mfma_f32_32x32x16_bf16 v[96:111], v[144:147], v[148:151], v[96:111]
  s_barrier
  ds_read_b128 v[148:151], v153
  ds_read_b64_tr_b16 v[132:133], v154 offset:8192
  ds_read_b64_tr_b16 v[134:135], v154 offset:10240
  ds_read_b64_tr_b16 v[136:137], v154 offset:8448
  ds_read_b64_tr_b16 v[138:139], v154 offset:10496
  ds_read_b64_tr_b16 v[140:141], v154 offset:8704
  ds_read_b64_tr_b16 v[142:143], v154 offset:10752
  ds_read_b64_tr_b16 v[144:145], v154 offset:8960
  ds_read_b64_tr_b16 v[146:147], v154 offset:11008
  s_waitcnt lgkmcnt(9)
  v_mfma_f32_32x32x16_bf16 v[48:63], v[112:115], v[128:131], v[48:63]
  v_mfma_f32_32x32x16_bf16 v[64:79], v[116:119], v[128:131], v[64:79]
  v_mfma_f32_32x32x16_bf16 v[80:95], v[120:123], v[128:131], v[80:95]
  v_mfma_f32_32x32x16_bf16 v[96:111], v[124:127], v[128:131], v[96:111]
  v_add_u32 v152, 28672, v3
  v_add_u32 v153, 28672, v4
  v_add_u32 v154, 28672, v5
  ds_read_b128 v[128:131], v152
  ds_read_b64_tr_b16 v[112:113], v154 offset:0
  ds_read_b64_tr_b16 v[114:115], v154 offset:2048
  ds_read_b64_tr_b16 v[116:117], v154 offset:256
  ds_read_b64_tr_b16 v[118:119], v154 offset:2304
  ds_read_b64_tr_b16 v[120:121], v154 offset:512
  ds_read_b64_tr_b16 v[122:123], v154 offset:2560
  ds_read_b64_tr_b16 v[124:125], v154 offset:768
  ds_read_b64_tr_b16 v[126:127], v154 offset:2816
  s_waitcnt lgkmcnt(9)
  v_mfma_f32_32x32x16_bf16 v[48:63], v[132:135], v[148:151], v[48:63]
  v_mfma_f32_32x32x16_bf16 v[64:79], v[136:139], v[148:151], v[64:79]
  v_mfma_f32_32x32x16_bf16 v[80:95], v[140:143], v[148:151], v[80:95]
  v_mfma_f32_32x32x16_bf16 v[96:111], v[144:147], v[148:151], v[96:111]
  s_barrier
  ds_read_b128 v[148:151], v153
  ds_read_b64_tr_b16 v[132:133], v154 offset:8192
  ds_read_b64_tr_b16 v[134:135], v154 offset:10240
  ds_read_b64_tr_b16 v[136:137], v154 offset:8448
  ds_read_b64_tr_b16 v[138:139], v154 offset:10496
  ds_read_b64_tr_b16 v[140:141], v154 offset:8704
  ds_read_b64_tr_b16 v[142:143], v154 offset:10752
  ds_read_b64_tr_b16 v[144:145], v154 offset:8960
  ds_read_b64_tr_b16 v[146:147], v154 offset:11008
  s_waitcnt lgkmcnt(9)
  v_mfma_f32_32x32x16_bf16 v[48:63], v[112:115], v[128:131], v[48:63]
  v_mfma_f32_32x32x16_bf16 v[64:79], v[116:119], v[128:131], v[64:79]
  v_mfma_f32_32x32x16_bf16 v[80:95], v[120:123], v[128:131], v[80:95]
  v_mfma_f32_32x32x16_bf16 v[96:111], v[124:127], v[128:131], v[96:111]
  v_add_u32 v152, 57344, v3
  v_add_u32 v153, 57344, v4
  v_add_u32 v154, 57344, v5
  ds_read_b128 v[128:131], v152
  ds_read_b64_tr_b16 v[112:113], v154 offset:0
  ds_read_b64_tr_b16 v[114:115], v154 offset:2048
  ds_read_b64_tr_b16 v[116:117], v154 offset:256
  ds_read_b64_tr_b16 v[118:119], v154 offset:2304
  ds_read_b64_tr_b16 v[120:121], v154 offset:512
  ds_read_b64_tr_b16 v[122:123], v154 offset:2560
  ds_read_b64_tr_b16 v[124:125], v154 offset:768
  ds_read_b64_tr_b16 v[126:127], v154 offset:2816
  s_waitcnt lgkmcnt(9)
  v_mfma_f32_32x32x16_bf16 v[48:63], v[132:135], v[148:151], v[48:63]
  v_mfma_f32_32x32x16_bf16 v[64:79], v[136:139], v[148:151], v[64:79]
  v_mfma_f32_32x32x16_bf16 v[80:95], v[140:143], v[148:151], v[80:95]
  v_mfma_f32_32x32x16_bf16 v[96:111], v[144:147], v[148:151], v[96:111]
  s_barrier
  ds_read_b128 v[148:151], v153
  ds_read_b64_tr_b16 v[132:133], v154 offset:8192
  ds_read_b64_tr_b16 v[134:135], v154 offset:10240
  ds_read_b64_tr_b16 v[136:137], v154 offset:8448
  ds_read_b64_tr_b16 v[138:139], v154 offset:10496
  ds_read_b64_tr_b16 v[140:141], v154 offset:8704
  ds_read_b64_tr_b16 v[142:143], v154 offset:10752
  ds_read_b64_tr_b16 v[144:145], v154 offset:8960
  ds_read_b64_tr_b16 v[146:147], v154 offset:11008
  s_waitcnt lgkmcnt(9)
  v_mfma_f32_32x32x16_bf16 v[48:63], v[112:115], v[128:131], v[48:63]
  v_mfma_f32_32x32x16_bf16 v[64:79], v[116:119], v[128:131], v[64:79]
  v_mfma_f32_32x32x16_bf16 v[80:95], v[120:123], v[128:131], v[80:95]
  v_mfma_f32_32x32x16_bf16 v[96:111], v[124:127], v[128:131], v[96:111]
  v_add_u32 v152, 86016, v3
  v_add_u32 v153, 86016, v4
  v_add_u32 v154, 86016, v5
  ds_read_b128 v[128:131], v152
  ds_read_b64_tr_b16 v[112:113], v154 offset:0
  ds_read_b64_tr_b16 v[114:115], v154 offset:2048
  ds_read_b64_tr_b16 v[116:117], v154 offset:256
  ds_read_b64_tr_b16 v[118:119], v154 offset:2304
  ds_read_b64_tr_b16 v[120:121], v154 offset:512
  ds_read_b64_tr_b16 v[122:123], v154 offset:2560
  ds_read_b64_tr_b16 v[124:125], v154 offset:768
  ds_read_b64_tr_b16 v[126:127], v154 offset:2816
  s_waitcnt lgkmcnt(9)
  v_mfma_f32_32x32x16_bf16 v[48:63], v[132:135], v[148:151], v[48:63]
  v_mfma_f32_32x32x16_bf16 v[64:79], v[136:139], v[148:151], v[64:79]
  v_mfma_f32_32x32x16_bf16 v[80:95], v[140:143], v[148:151], v[80:95]
  v_mfma_f32_32x32x16_bf16 v[96:111], v[144:147], v[148:151], v[96:111]
  s_barrier
  ds_read_b128 v[148:151], v153
  ds_read_b64_tr_b16 v[132:133], v154 offset:8192
  ds_read_b64_tr_b16 v[134:135], v154 offset:10240
  ds_read_b64_tr_b16 v[136:137], v154 offset:8448
  ds_read_b64_tr_b16 v[138:139], v154 offset:10496
  ds_read_b64_tr_b16 v[140:141], v154 offset:8704
  ds_read_b64_tr_b16 v[142:143], v154 offset:10752
  ds_read_b64_tr_b16 v[144:145], v154 offset:8960
  ds_read_b64_tr_b16 v[146:147], v154 offset:11008
  s_waitcnt lgkmcnt(9)
  v_mfma_f32_32x32x16_bf16 v[48:63], v[112:115], v[128:131], v[48:63]
  v_mfma_f32_32x32x16_bf16 v[64:79], v[116:119], v[128:131], v[64:79]
  v_mfma_f32_32x32x16_bf16 v[80:95], v[120:123], v[128:131], v[80:95]
  v_mfma_f32_32x32x16_bf16 v[96:111], v[124:127], v[128:131], v[96:111]
  v_add_u32 v152, 114688, v3
  v_add_u32 v153, 114688, v4
  v_add_u32 v154, 114688, v5
  ds_read_b128 v[128:131], v152
  ds_read_b64_tr_b16 v[112:113], v154 offset:0
  ds_read_b64_tr_b16 v[114:115], v154 offset:2048
  ds_read_b64_tr_b16 v[116:117], v154 offset:256
  ds_read_b64_tr_b16 v[118:119], v154 offset:2304
  ds_read_b64_tr_b16 v[120:121], v154 offset:512
  ds_read_b64_tr_b16 v[122:123], v154 offset:2560
  ds_read_b64_tr_b16 v[124:125], v154 offset:768
  ds_read_b64_tr_b16 v[126:127], v154 offset:2816
  s_waitcnt lgkmcnt(9)
  v_mfma_f32_32x32x16_bf16 v[48:63], v[132:135], v[148:151], v[48:63]
  v_mfma_f32_32x32x16_bf16 v[64:79], v[136:139], v[148:151], v[64:79]
  v_mfma_f32_32x32x16_bf16 v[80:95], v[140:143], v[148:151], v[80:95]
  v_mfma_f32_32x32x16_bf16 v[96:111], v[144:147], v[148:151], v[96:111]
  s_barrier
  ds_read_b128 v[148:151], v153
  ds_read_b64_tr_b16 v[132:133], v154 offset:8192
  ds_read_b64_tr_b16 v[134:135], v154 offset:10240
  ds_read_b64_tr_b16 v[136:137], v154 offset:8448
  ds_read_b64_tr_b16 v[138:139], v154 offset:10496
  ds_read_b64_tr_b16 v[140:141], v154 offset:8704
  ds_read_b64_tr_b16 v[142:143], v154 offset:10752
  ds_read_b64_tr_b16 v[144:145], v154 offset:8960
  ds_read_b64_tr_b16 v[146:147], v154 offset:11008
  s_waitcnt lgkmcnt(9)
  v_mfma_f32_32x32x16_bf16 v[48:63], v[112:115], v[128:131], v[48:63]
  v_mfma_f32_32x32x16_bf16 v[64:79], v[116:119], v[128:131], v[64:79]
  v_mfma_f32_32x32x16_bf16 v[80:95], v[120:123], v[128:131], v[80:95]
  v_mfma_f32_32x32x16_bf16 v[96:111], v[124:127], v[128:131], v[96:111]
  v_add_u32 v152, 0, v3
  v_add_u32 v153, 0, v4
  v_add_u32 v154, 0, v5
  ds_read_b128 v[128:131], v152
  ds_read_b64_tr_b16 v[112:113], v154 offset:0
  ds_read_b64_tr_b16 v[114:115], v154 offset:2048
  ds_read_b64_tr_b16 v[116:117], v154 offset:256
  ds_read_b64_tr_b16 v[118:119], v154 offset:2304
  ds_read_b64_tr_b16 v[120:121], v154 offset:512
  ds_read_b64_tr_b16 v[122:123], v154 offset:2560
  ds_read_b64_tr_b16 v[124:125], v154 offset:768
  ds_read_b64_tr_b16 v[126:127], v154 offset:2816
  s_waitcnt lgkmcnt(9)
  v_mfma_f32_32x32x16_bf16 v[48:63], v[132:135], v[148:151], v[48:63]
  v_mfma_f32_32x32x16_bf16 v[64:79], v[136:139], v[148:151], v[64:79]
  v_mfma_f32_32x32x16_bf16 v[80:95], v[140:143], v[148:151], v[80:95]
  v_mfma_f32_32x32x16_bf16 v[96:111], v[144:147], v[148:151], v[96:111]
  s_barrier
  ds_read_b128 v[148:151], v153
  ds_read_b64_tr_b16 v[132:133], v154 offset:8192
  ds_read_b64_tr_b16 v[134:135], v154 offset:10240
  ds_read_b64_tr_b16 v[136:137], v154 offset:8448
  ds_read_b64_tr_b16 v[138:139], v154 offset:10496
  ds_read_b64_tr_b16 v[140:141], v154 offset:8704
  ds_read_b64_tr_b16 v[142:143], v154 offset:10752
  ds_read_b64_tr_b16 v[144:145], v154 offset:8960
  ds_read_b64_tr_b16 v[146:147], v154 offset:11008
  s_waitcnt lgkmcnt(9)
  v_mfma_f32_32x32x16_bf16 v[48:63], v[112:115], v[128:131], v[48:63]
  v_mfma_f32_32x32x16_bf16 v[64:79], v[116:119], v[128:131], v[64:79]
  v_mfma_f32_32x32x16_bf16 v[80:95], v[120:123], v[128:131], v[80:95]
  v_mfma_f32_32x32x16_bf16 v[96:111], v[124:127], v[128:131], v[96:111]
  v_add_u32 v152, 28672, v3
  v_add_u32 v153, 28672, v4
  v_add_u32 v154, 28672, v5
  ds_read_b128 v[128:131], v152
  ds_read_b64_tr_b16 v[112:113], v154 offset:0
  ds_read_b64_tr_b16 v[114:115], v154 offset:2048
  ds_read_b64_tr_b16 v[116:117], v154 offset:256
  ds_read_b64_tr_b16 v[118:119], v154 offset:2304
  ds_read_b64_tr_b16 v[120:121], v154 offset:512
  ds_read_b64_tr_b16 v[122:123], v154 offset:2560
  ds_read_b64_tr_b16 v[124:125], v154 offset:768
  ds_read_b64_tr_b16 v[126:127], v154 offset:2816
  s_waitcnt lgkmcnt(9)
  v_mfma_f32_32x32x16_bf16 v[48:63], v[132:135], v[148:151], v[48:63]
  v_mfma_f32_32x32x16_bf16 v[64:79], v[136:139], v[148:151], v[64:79]
  v_mfma_f32_32x32x16_bf16 v[80:95], v[140:143], v[148:151], v[80:95]
  v_mfma_f32_32x32x16_bf16 v[96:111], v[144:147], v[148:151], v[96:111]
  s_barrier
  ds_read_b128 v[148:151], v153
  ds_read_b64_tr_b16 v[132:133], v154 offset:8192
  ds_read_b64_tr_b16 v[134:135], v154 offset:10240
  ds_read_b64_tr_b16 v[136:137], v154 offset:8448
  ds_read_b64_tr_b16 v[138:139], v154 offset:10496
  ds_read_b64_tr_b16 v[140:141], v154 offset:8704
  ds_read_b64_tr_b16 v[142:143], v154 offset:10752
  ds_read_b64_tr_b16 v[144:145], v154 offset:8960
  ds_read_b64_tr_b16 v[146:147], v154 offset:11008
  s_waitcnt lgkmcnt(9)
  v_mfma_f32_32x32x16_bf16 v[48:63], v[112:115], v[128:131], v[48:63]
  v_mfma_f32_32x32x16_bf16 v[64:79], v[116:119], v[128:131], v[64:79]
  v_mfma_f32_32x32x16_bf16 v[80:95], v[120:123], v[128:131], v[80:95]
  v_mfma_f32_32x32x16_bf16 v[96:111], v[124:127], v[128:131], v[96:111]
  v_add_u32 v152, 57344, v3
  v_add_u32 v153, 57344, v4
  v_add_u32 v154, 57344, v5
  ds_read_b128 v[128:131], v152
  ds_read_b64_tr_b16 v[112:113], v154 offset:0
  ds_read_b64_tr_b16 v[114:115], v154 offset:2048
  ds_read_b64_tr_b16 v[116:117], v154 offset:256
  ds_read_b64_tr_b16 v[118:119], v154 offset:2304
  ds_read_b64_tr_b16 v[120:121], v154 offset:512
  ds_read_b64_tr_b16 v[122:123], v154 offset:2560
  ds_read_b64_tr_b16 v[124:125], v154 offset:768
  ds_read_b64_tr_b16 v[126:127], v154 offset:2816
  s_waitcnt lgkmcnt(9)
  v_mfma_f32_32x32x16_bf16 v[48:63], v[132:135], v[148:151], v[48:63]
  v_mfma_f32_32x32x16_bf16 v[64:79], v[136:139], v[148:151], v[64:79]
  v_mfma_f32_32x32x16_bf16 v[80:95], v[140:143], v[148:151], v[80:95]
  v_mfma_f32_32x32x16_bf16 v[96:111], v[144:147], v[148:151], v[96:111]
  s_barrier
  ds_read_b128 v[148:151], v153
  ds_read_b64_tr_b16 v[132:133], v154 offset:8192
  ds_read_b64_tr_b16 v[134:135], v154 offset:10240
  ds_read_b64_tr_b16 v[136:137], v154 offset:8448
  ds_read_b64_tr_b16 v[138:139], v154 offset:10496
  ds_read_b64_tr_b16 v[140:141], v154 offset:8704
  ds_read_b64_tr_b16 v[142:143], v154 offset:10752
  ds_read_b64_tr_b16 v[144:145], v154 offset:8960
  ds_read_b64_tr_b16 v[146:147], v154 offset:11008
  s_waitcnt lgkmcnt(9)
  v_mfma_f32_32x32x16_bf16 v[48:63], v[112:115], v[128:131], v[48:63]
  v_mfma_f32_32x32x16_bf16 v[64:79], v[116:119], v[128:131], v[64:79]
  v_mfma_f32_32x32x16_bf16 v[80:95], v[120:123], v[128:131], v[80:95]
  v_mfma_f32_32x32x16_bf16 v[96:111], v[124:127], v[128:131], v[96:111]
  v_add_u32 v152, 86016, v3
  v_add_u32 v153, 86016, v4
  v_add_u32 v154, 86016, v5
  ds_read_b128 v[128:131], v152
  ds_read_b64_tr_b16 v[112:113], v154 offset:0
  ds_read_b64_tr_b16 v[114:115], v154 offset:2048
  ds_read_b64_tr_b16 v[116:117], v154 offset:256
  ds_read_b64_tr_b16 v[118:119], v154 offset:2304
  ds_read_b64_tr_b16 v[120:121], v154 offset:512
  ds_read_b64_tr_b16 v[122:123], v154 offset:2560
  ds_read_b64_tr_b16 v[124:125], v154 offset:768
  ds_read_b64_tr_b16 v[126:127], v154 offset:2816
  s_waitcnt lgkmcnt(9)
  v_mfma_f32_32x32x16_bf16 v[48:63], v[132:135], v[148:151], v[48:63]
  v_mfma_f32_32x32x16_bf16 v[64:79], v[136:139], v[148:151], v[64:79]
  v_mfma_f32_32x32x16_bf16 v[80:95], v[140:143], v[148:151], v[80:95]
  v_mfma_f32_32x32x16_bf16 v[96:111], v[144:147], v[148:151], v[96:111]
  s_barrier
  ds_read_b128 v[148:151], v153
  ds_read_b64_tr_b16 v[132:133], v154 offset:8192
  ds_read_b64_tr_b16 v[134:135], v154 offset:10240
  ds_read_b64_tr_b16 v[136:137], v154 offset:8448
  ds_read_b64_tr_b16 v[138:139], v154 offset:10496
  ds_read_b64_tr_b16 v[140:141], v154 offset:8704
  ds_read_b64_tr_b16 v[142:143], v154 offset:10752
  ds_read_b64_tr_b16 v[144:145], v154 offset:8960
  ds_read_b64_tr_b16 v[146:147], v154 offset:11008
  s_waitcnt lgkmcnt(9)
  v_mfma_f32_32x32x16_bf16 v[48:63], v[112:115], v[128:131], v[48:63]
  v_mfma_f32_32x32x16_bf16 v[64:79], v[116:119], v[128:131], v[64:79]
  v_mfma_f32_32x32x16_bf16 v[80:95], v[120:123], v[128:131], v[80:95]
  v_mfma_f32_32x32x16_bf16 v[96:111], v[124:127], v[128:131], v[96:111]
  v_add_u32 v152, 114688, v3
  v_add_u32 v153, 114688, v4
  v_add_u32 v154, 114688, v5
  ds_read_b128 v[128:131], v152
  ds_read_b64_tr_b16 v[112:113], v154 offset:0
  ds_read_b64_tr_b16 v[114:115], v154 offset:2048
  ds_read_b64_tr_b16 v[116:117], v154 offset:256
  ds_read_b64_tr_b16 v[118:119], v154 offset:2304
  ds_read_b64_tr_b16 v[120:121], v154 offset:512
  ds_read_b64_tr_b16 v[122:123], v154 offset:2560
  ds_read_b64_tr_b16 v[124:125], v154 offset:768
  ds_read_b64_tr_b16 v[126:127], v154 offset:2816
  s_waitcnt lgkmcnt(9)
  v_mfma_f32_32x32x16_bf16 v[48:63], v[132:135], v[148:151], v[48:63]
  v_mfma_f32_32x32x16_bf16 v[64:79], v[136:139], v[148:151], v[64:79]
  v_mfma_f32_32x32x16_bf16 v[80:95], v[140:143], v[148:151], v[80:95]
  v_mfma_f32_32x32x16_bf16 v[96:111], v[144:147], v[148:151], v[96:111]
  s_barrier
  ds_read_b128 v[148:151], v153
  ds_read_b64_tr_b16 v[132:133], v154 offset:8192
  ds_read_b64_tr_b16 v[134:135], v154 offset:10240
  ds_read_b64_tr_b16 v[136:137], v154 offset:8448
  ds_read_b64_tr_b16 v[138:139], v154 offset:10496
  ds_read_b64_tr_b16 v[140:141], v154 offset:8704
  ds_read_b64_tr_b16 v[142:143], v154 offset:10752
  ds_read_b64_tr_b16 v[144:145], v154 offset:8960
  ds_read_b64_tr_b16 v[146:147], v154 offset:11008
  s_waitcnt lgkmcnt(9)
  v_mfma_f32_32x32x16_bf16 v[48:63], v[112:115], v[128:131], v[48:63]
  v_mfma_f32_32x32x16_bf16 v[64:79], v[116:119], v[128:131], v[64:79]
  v_mfma_f32_32x32x16_bf16 v[80:95], v[120:123], v[128:131], v[80:95]
  v_mfma_f32_32x32x16_bf16 v[96:111], v[124:127], v[128:131], v[96:111]
  s_waitcnt lgkmcnt(0)
  v_mfma_f32_32x32x16_bf16 v[48:63], v[132:135], v[148:151], v[48:63]
  v_mfma_f32_32x32x16_bf16 v[64:79], v[136:139], v[148:151], v[64:79]
  v_mfma_f32_32x32x16_bf16 v[80:95], v[140:143], v[148:151], v[80:95]
  v_mfma_f32_32x32x16_bf16 v[96:111], v[144:147], v[148:151], v[96:111]
K1_QEND:
  s_barrier
  s_cmp_ge_u32 s28, 8
  s_cbranch_scc1 K1_NOKV3
  s_and_b32 s74, s26, 15
  s_lshl_b32 s74, s74, 13
  s_add_u32 s74, s74, s46
  s_add_u32 s26, s26, 1
  s_add_u32 s75, s47, 98304
  s_add_u32 m0, s75, 0
  s_add_u32 s35, s74, 0
  buffer_load_dwordx4 v6, s[12:15], s35 offen nt lds
  s_add_u32 m0, s75, 1024
  s_add_u32 s35, s74, 1024
  buffer_load_dwordx4 v7, s[12:15], s35 offen nt lds
  s_add_u32 m0, s75, 2048
  s_add_u32 s35, s74, 2048
  buffer_load_dwordx4 v8, s[12:15], s35 offen nt lds
  s_add_u32 m0, s75, 3072
  s_add_u32 s35, s74, 3072
  buffer_load_dwordx4 v9, s[12:15], s35 offen nt lds
K1_NOKV3:
  v_lshlrev_b32 v156, 4, v1
  v_add_u32 v156, s72, v156
  s_cmp_ge_u32 s28, 8
  s_cbranch_scc1 K1_PFW1
  s_cmp_eq_u32 s28, 7
  s_cbranch_scc1 K1_PFW3
  s_waitcnt vmcnt(4)
  s_branch K1_PFW2
K1_PFW3:
  s_waitcnt vmcnt(4)
  s_branch K1_PFW2
K1_PFW1:
  s_waitcnt vmcnt(0)
K1_PFW2:
  ds_write_b128 v156, v[16:19] offset:0
  ds_write_b128 v156, v[20:23] offset:1024
  ds_write_b128 v156, v[24:27] offset:2048
  ds_write_b128 v156, v[28:31] offset:3072
  ds_write_b128 v156, v[32:35] offset:4096
  ds_write_b128 v156, v[36:39] offset:5120
  ds_write_b128 v156, v[40:43] offset:6144
  ds_write_b128 v156, v[44:47] offset:7168
  s_waitcnt lgkmcnt(0)
  v_mul_f32 v48, s38, v48
  v_mul_f32 v49, s38, v49
  v_mul_f32 v50, s38, v50
  v_mul_f32 v51, s38, v51
  v_mul_f32 v52, s38, v52
  v_mul_f32 v53, s38, v53
  v_mul_f32 v54, s38, v54
  v_mul_f32 v55, s38, v55
  v_mul_f32 v56, s38, v56
  v_mul_f32 v57, s38, v57
  v_mul_f32 v58, s38, v58
  v_mul_f32 v59, s38, v59
  v_mul_f32 v60, s38, v60
  v_mul_f32 v61, s38, v61
  v_mul_f32 v62, s38, v62
  v_mul_f32 v63, s38, v63
  v_cvt_pk_bf16_f32 v16, v48, v49
  v_cvt_pk_bf16_f32 v17, v50, v51
  v_cvt_pk_bf16_f32 v18, v52, v53
  v_cvt_pk_bf16_f32 v19, v54, v55
  v_cvt_pk_bf16_f32 v20, v56, v57
  v_cvt_pk_bf16_f32 v21, v58, v59
  v_cvt_pk_bf16_f32 v22, v60, v61
  v_cvt_pk_bf16_f32 v23, v62, v63
  v_mul_f32 v64, s38, v64
  v_mul_f32 v65, s38, v65
  v_mul_f32 v66, s38, v66
  v_mul_f32 v67, s38, v67
  v_mul_f32 v68, s38, v68
  v_mul_f32 v69, s38, v69
  v_mul_f32 v70, s38, v70
  v_mul_f32 v71, s38, v71
  v_mul_f32 v72, s38, v72
  v_mul_f32 v73, s38, v73
  v_mul_f32 v74, s38, v74
  v_mul_f32 v75, s38, v75
  v_mul_f32 v76, s38, v76
  v_mul_f32 v77, s38, v77
  v_mul_f32 v78, s38, v78
  v_mul_f32 v79, s38, v79
  v_cvt_pk_bf16_f32 v24, v64, v65
  v_cvt_pk_bf16_f32 v25, v66, v67
  v_cvt_pk_bf16_f32 v26, v68, v69
  v_cvt_pk_bf16_f32 v27, v70, v71
  v_cvt_pk_bf16_f32 v28, v72, v73
  v_cvt_pk_bf16_f32 v29, v74, v75
  v_cvt_pk_bf16_f32 v30, v76, v77
  v_cvt_pk_bf16_f32 v31, v78, v79
  v_mul_f32 v80, s38, v80
  v_mul_f32 v81, s38, v81
  v_mul_f32 v82, s38, v82
  v_mul_f32 v83, s38, v83
  v_mul_f32 v84, s38, v84
  v_mul_f32 v85, s38, v85
  v_mul_f32 v86, s38, v86
  v_mul_f32 v87, s38, v87
  v_mul_f32 v88, s38, v88
  v_mul_f32 v89, s38, v89
  v_mul_f32 v90, s38, v90
  v_mul_f32 v91, s38, v91
  v_mul_f32 v92, s38, v92
  v_mul_f32 v93, s38, v93
  v_mul_f32 v94, s38, v94
  v_mul_f32 v95, s38, v95
  v_cvt_pk_bf16_f32 v32, v80, v81
  v_cvt_pk_bf16_f32 v33, v82, v83
  v_cvt_pk_bf16_f32 v34, v84, v85
  v_cvt_pk_bf16_f32 v35, v86, v87
  v_cvt_pk_bf16_f32 v36, v88, v89
  v_cvt_pk_bf16_f32 v37, v90, v91
  v_cvt_pk_bf16_f32 v38, v92, v93
  v_cvt_pk_bf16_f32 v39, v94, v95
  v_mul_f32 v96, s38, v96
  v_mul_f32 v97, s38, v97
  v_mul_f32 v98, s38, v98
  v_mul_f32 v99, s38, v99
  v_mul_f32 v100, s38, v100
  v_mul_f32 v101, s38, v101
  v_mul_f32 v102, s38, v102
  v_mul_f32 v103, s38, v103
  v_mul_f32 v104, s38, v104
  v_mul_f32 v105, s38, v105
  v_mul_f32 v106, s38, v106
  v_mul_f32 v107, s38, v107
  v_mul_f32 v108, s38, v108
  v_mul_f32 v109, s38, v109
  v_mul_f32 v110, s38, v110
  v_mul_f32 v111, s38, v111
  v_cvt_pk_bf16_f32 v40, v96, v97
  v_cvt_pk_bf16_f32 v41, v98, v99
  v_cvt_pk_bf16_f32 v42, v100, v101
  v_cvt_pk_bf16_f32 v43, v102, v103
  v_cvt_pk_bf16_f32 v44, v104, v105
  v_cvt_pk_bf16_f32 v45, v106, v107
  v_cvt_pk_bf16_f32 v46, v108, v109
  v_cvt_pk_bf16_f32 v47, v110, v111
  v_mov_b32 v48, 0
  v_mov_b32 v49, 0
  v_mov_b32 v50, 0
  v_mov_b32 v51, 0
  v_mov_b32 v52, 0
  v_mov_b32 v53, 0
  v_mov_b32 v54, 0
  v_mov_b32 v55, 0
  v_mov_b32 v56, 0
  v_mov_b32 v57, 0
  v_mov_b32 v58, 0
  v_mov_b32 v59, 0
  v_mov_b32 v60, 0
  v_mov_b32 v61, 0
  v_mov_b32 v62, 0
  v_mov_b32 v63, 0
  v_mov_b32 v64, 0
  v_mov_b32 v65, 0
  v_mov_b32 v66, 0
  v_mov_b32 v67, 0
  v_mov_b32 v68, 0
  v_mov_b32 v69, 0
  v_mov_b32 v70, 0
  v_mov_b32 v71, 0
  v_mov_b32 v72, 0
  v_mov_b32 v73, 0
  v_mov_b32 v74, 0
  v_mov_b32 v75, 0
  v_mov_b32 v76, 0
  v_mov_b32 v77, 0
  v_mov_b32 v78, 0
  v_mov_b32 v79, 0
  v_mov_b32 v80, 0
  v_mov_b32 v81, 0
  v_mov_b32 v82, 0
  v_mov_b32 v83, 0
  v_mov_b32 v84, 0
  v_mov_b32 v85, 0
  v_mov_b32 v86, 0
  v_mov_b32 v87, 0
  v_mov_b32 v88, 0
  v_mov_b32 v89, 0
  v_mov_b32 v90, 0
  v_mov_b32 v91, 0
  v_mov_b32 v92, 0
  v_mov_b32 v93, 0
  v_mov_b32 v94, 0
  v_mov_b32 v95, 0
  v_mov_b32 v96, 0
  v_mov_b32 v97, 0
  v_mov_b32 v98, 0
  v_mov_b32 v99, 0
  v_mov_b32 v100, 0
  v_mov_b32 v101, 0
  v_mov_b32 v102, 0
  v_mov_b32 v103, 0
  v_mov_b32 v104, 0
  v_mov_b32 v105, 0
  v_mov_b32 v106, 0
  v_mov_b32 v107, 0
  v_mov_b32 v108, 0
  v_mov_b32 v109, 0
  v_mov_b32 v110, 0
  v_mov_b32 v111, 0
  v_mov_b32 v12, 0
  s_lshl_b32 s34, s30, 5
  s_lshl_b32 s35, s31, 1
  s_add_u32 s34, s34, s35
  s_lshl_b32 s34, s34, 17
  s_add_u32 s4, s50, s34
  s_addc_u32 s5, s51, 0
  s_mov_b32 s6, 262144
  s_mov_b32 s7, 0x00020000
  s_mov_b32 s24, 0
  s_mov_b32 s25, 131072
  s_mov_b32 s45, 0
  s_cmp_ge_u32 s28, 8
  s_cbranch_scc1 K1_NOW0
  s_waitcnt vmcnt(4)
K1_NOW0:
  s_barrier
  s_cmp_lt_u32 s28, 4
  s_cbranch_scc1 K1_A0
  s_cmp_lt_u32 s28, 8
  s_cbranch_scc1 K1_A1
  s_branch K1_A2
K1_A0:
  v_add_u32 v2, 147456, v10
  s_mov_b32 s24, 0
  s_mov_b32 s38, 32768
  s_waitcnt lgkmcnt(0)
  ds_read_b128 v[144:147], v2
  v_xor_b32 v4, 32, v2
  ds_read_b128 v[148:151], v4
  v_xor_b32 v3, 64, v2
  ds_read_b128 v[152:155], v3
  v_xor_b32 v4, 96, v2
  ds_read_b128 v[156:159], v4
  s_waitcnt lgkmcnt(3)
  v_mfma_f32_32x32x16_bf16 v[112:127], v[144:147], v[16:19], 0
  v_xor_b32 v3, 128, v2
  ds_read_b128 v[144:147], v3
  s_waitcnt lgkmcnt(3)
  v_mfma_f32_32x32x16_bf16 v[112:127], v[148:151], v[20:23], v[112:127]
  v_xor_b32 v4, 160, v2
  ds_read_b128 v[148:151], v4
  s_waitcnt lgkmcnt(3)
  v_mfma_f32_32x32x16_bf16 v[112:127], v[152:155], v[24:27], v[112:127]
  v_xor_b32 v3, 192, v2
  ds_read_b128 v[152:155], v3
  s_waitcnt lgkmcnt(3)
  v_mfma_f32_32x32x16_bf16 v[112:127], v[156:159], v[28:31], v[112:127]
  v_xor_b32 v4, 224, v2
  ds_read_b128 v[156:159], v4
  s_waitcnt lgkmcnt(3)
  v_mfma_f32_32x32x16_bf16 v[112:127], v[144:147], v[32:35], v[112:127]
  s_waitcnt lgkmcnt(2)
  v_mfma_f32_32x32x16_bf16 v[112:127], v[148:151], v[36:39], v[112:127]
  s_waitcnt lgkmcnt(1)
  v_mfma_f32_32x32x16_bf16 v[112:127], v[152:155], v[40:43], v[112:127]
  s_waitcnt lgkmcnt(0)
  v_mfma_f32_32x32x16_bf16 v[112:127], v[156:159], v[44:47], v[112:127]
  v_mov_b32 v160, v10
  ds_read_b128 v[144:147], v160
  v_xor_b32 v4, 32, v160
  ds_read_b128 v[148:151], v4
  v_xor_b32 v3, 64, v160
  ds_read_b128 v[152:155], v3
  v_xor_b32 v4, 96, v160
  ds_read_b128 v[156:159], v4
  s_nop 3
  v_max3_f32 v14, v112, v113, v114
  v_max3_f32 v14, v14, v115, v116
  v_max3_f32 v14, v14, v117, v118
  v_max3_f32 v14, v14, v119, v120
  v_max3_f32 v14, v14, v121, v122
  v_max3_f32 v14, v14, v123, v124
  v_max3_f32 v14, v14, v125, v126
  v_max_f32 v14, v14, v127
  v_mov_b32 v15, v14
  s_nop 1
  v_permlane32_swap_b32 v14, v15
  v_max_f32 v14, v14, v15
  v_mov_b32 v0, v14
  v_sub_f32 v112, v112, v0
  v_sub_f32 v113, v113, v0
  v_exp_f32 v112, v112
  v_exp_f32 v113, v113
  v_sub_f32 v114, v114, v0
  v_sub_f32 v115, v115, v0
  v_exp_f32 v114, v114
  v_exp_f32 v115, v115
  v_sub_f32 v116, v116, v0
  v_sub_f32 v117, v117, v0
  v_exp_f32 v116, v116
  v_exp_f32 v117, v117
  v_sub_f32 v118, v118, v0
  v_sub_f32 v119, v119, v0
  v_exp_f32 v118, v118
  v_exp_f32 v119, v119
  v_add_f32 v13, v112, v113
  v_cvt_pk_bf16_f32 v112, v112, v113
  v_add_f32 v14, v114, v115
  v_cvt_pk_bf16_f32 v113, v114, v115
  v_add_f32 v13, v13, v116
  v_add_f32 v14, v14, v117
  v_cvt_pk_bf16_f32 v114, v116, v117
  v_add_f32 v13, v13, v118
  v_add_f32 v14, v14, v119
  v_cvt_pk_bf16_f32 v115, v118, v119
K1_A0L:
  s_waitcnt vmcnt(8)
  s_barrier
  s_setprio 1
  v_add_u32 v5, s24, v11
  s_waitcnt lgkmcnt(3)
  v_mfma_f32_32x32x16_bf16 v[128:143], v[144:147], v[16:19], 0
  v_xor_b32 v3, 128, v160
  ds_read_b128 v[144:147], v3
  v_sub_f32 v120, v120, v0
  v_sub_f32 v121, v121, v0
  v_exp_f32 v120, v120
  v_exp_f32 v121, v121
  s_waitcnt lgkmcnt(3)
  v_mfma_f32_32x32x16_bf16 v[128:143], v[148:151], v[20:23], v[128:143]
  v_xor_b32 v4, 160, v160
  ds_read_b128 v[148:151], v4
  v_add_f32 v13, v13, v120
  v_add_f32 v14, v14, v121
  v_cvt_pk_bf16_f32 v120, v120, v121
  s_and_b32 s74, s26, 15
  s_lshl_b32 s74, s74, 13
  s_add_u32 s74, s74, s46
  s_add_u32 s26, s26, 1
  s_add_u32 s75, s25, s47
  s_add_u32 m0, s75, 0
  s_add_u32 s35, s74, 0
  buffer_load_dwordx4 v6, s[12:15], s35 offen nt lds
  s_waitcnt lgkmcnt(3)
  v_mfma_f32_32x32x16_bf16 v[128:143], v[152:155], v[24:27], v[128:143]
  v_xor_b32 v3, 192, v160
  ds_read_b128 v[152:155], v3
  v_sub_f32 v122, v122, v0
  v_sub_f32 v123, v123, v0
  v_exp_f32 v122, v122
  v_exp_f32 v123, v123
  s_waitcnt lgkmcnt(3)
  v_mfma_f32_32x32x16_bf16 v[128:143], v[156:159], v[28:31], v[128:143]
  v_xor_b32 v4, 224, v160
  ds_read_b128 v[156:159], v4
  v_add_f32 v13, v13, v122
  v_add_f32 v14, v14, v123
  v_cvt_pk_bf16_f32 v121, v122, v123
  s_add_u32 m0, s75, 1024
  s_add_u32 s35, s74, 1024
  buffer_load_dwordx4 v7, s[12:15], s35 offen nt lds
  s_waitcnt lgkmcnt(3)
  v_mfma_f32_32x32x16_bf16 v[128:143], v[144:147], v[32:35], v[128:143]
  ds_read_b64_tr_b16 v[144:145], v5 offset:0
  ds_read_b64_tr_b16 v[146:147], v5 offset:2048
  v_sub_f32 v124, v124, v0
  v_sub_f32 v125, v125, v0
  v_exp_f32 v124, v124
  v_exp_f32 v125, v125
  s_waitcnt lgkmcnt(4)
  v_mfma_f32_32x32x16_bf16 v[128:143], v[148:151], v[36:39], v[128:143]
  ds_read_b64_tr_b16 v[148:149], v5 offset:256
  ds_read_b64_tr_b16 v[150:151], v5 offset:2304
  v_add_f32 v13, v13, v124
  v_add_f32 v14, v14, v125
  v_cvt_pk_bf16_f32 v122, v124, v125
  s_add_u32 m0, s75, 2048
  s_add_u32 s35, s74, 2048
  buffer_load_dwordx4 v8, s[12:15], s35 offen nt lds
  s_waitcnt lgkmcnt(5)
  v_mfma_f32_32x32x16_bf16 v[128:143], v[152:155], v[40:43], v[128:143]
  ds_read_b64_tr_b16 v[152:153], v5 offset:512
  ds_read_b64_tr_b16 v[154:155], v5 offset:2560
  v_sub_f32 v126, v126, v0
  v_sub_f32 v127, v127, v0
  v_exp_f32 v126, v126
  v_exp_f32 v127, v127
  s_waitcnt lgkmcnt(6)
  v_mfma_f32_32x32x16_bf16 v[128:143], v[156:159], v[44:47], v[128:143]
  ds_read_b64_tr_b16 v[156:157], v5 offset:768
  ds_read_b64_tr_b16 v[158:159], v5 offset:2816
  v_add_f32 v13, v13, v126
  v_add_f32 v14, v14, v127
  v_cvt_pk_bf16_f32 v123, v126, v127
  s_add_u32 m0, s75, 3072
  s_add_u32 s35, s74, 3072
  buffer_load_dwordx4 v9, s[12:15], s35 offen nt lds
  v_add_f32 v13, v13, v14
  v_cmp_nge_f32 vcc, 0x49800000, v13
  s_nop 0
  s_cbranch_vccnz K1_A0L0_SLOW
K1_A0L0_CONT:
  v_add_f32 v12, v12, v13
  v_add_u32 v160, s38, v10
  s_waitcnt lgkmcnt(6)
  v_mfma_f32_32x32x16_bf16 v[48:63], v[144:147], v[112:115], v[48:63]
  ds_read_b64_tr_b16 v[144:145], v5 offset:4096
  ds_read_b64_tr_b16 v[146:147], v5 offset:6144
  s_waitcnt lgkmcnt(6)
  v_mfma_f32_32x32x16_bf16 v[64:79], v[148:151], v[112:115], v[64:79]
  ds_read_b64_tr_b16 v[148:149], v5 offset:4352
  ds_read_b64_tr_b16 v[150:151], v5 offset:6400
  v_sub_f32 v128, v128, v0
  v_sub_f32 v129, v129, v0
  v_exp_f32 v128, v128
  v_exp_f32 v129, v129
  s_waitcnt lgkmcnt(6)
  v_mfma_f32_32x32x16_bf16 v[80:95], v[152:155], v[112:115], v[80:95]
  ds_read_b64_tr_b16 v[152:153], v5 offset:4608
  ds_read_b64_tr_b16 v[154:155], v5 offset:6656
  v_add_f32 v13, v128, v129
  v_cvt_pk_bf16_f32 v128, v128, v129
  s_waitcnt lgkmcnt(6)
  v_mfma_f32_32x32x16_bf16 v[96:111], v[156:159], v[112:115], v[96:111]
  ds_read_b64_tr_b16 v[156:157], v5 offset:4864
  ds_read_b64_tr_b16 v[158:159], v5 offset:6912
  v_sub_f32 v130, v130, v0
  v_sub_f32 v131, v131, v0
  v_exp_f32 v130, v130
  v_exp_f32 v131, v131
  s_waitcnt lgkmcnt(6)
  v_mfma_f32_32x32x16_bf16 v[48:63], v[144:147], v[120:123], v[48:63]
  ds_read_b128 v[144:147], v160
  v_add_f32 v14, v130, v131
  v_cvt_pk_bf16_f32 v129, v130, v131
  s_waitcnt lgkmcnt(5)
  v_mfma_f32_32x32x16_bf16 v[64:79], v[148:151], v[120:123], v[64:79]
  v_xor_b32 v4, 32, v160
  ds_read_b128 v[148:151], v4
  v_sub_f32 v132, v132, v0
  v_sub_f32 v133, v133, v0
  v_exp_f32 v132, v132
  v_exp_f32 v133, v133
  s_waitcnt lgkmcnt(4)
  v_mfma_f32_32x32x16_bf16 v[80:95], v[152:155], v[120:123], v[80:95]
  v_xor_b32 v3, 64, v160
  ds_read_b128 v[152:155], v3
  v_add_f32 v13, v13, v132
  v_add_f32 v14, v14, v133
  v_cvt_pk_bf16_f32 v130, v132, v133
  s_waitcnt lgkmcnt(3)
  v_mfma_f32_32x32x16_bf16 v[96:111], v[156:159], v[120:123], v[96:111]
  v_xor_b32 v4, 96, v160
  ds_read_b128 v[156:159], v4
  v_sub_f32 v134, v134, v0
  v_sub_f32 v135, v135, v0
  v_exp_f32 v134, v134
  v_exp_f32 v135, v135
  v_add_f32 v13, v13, v134
  v_add_f32 v14, v14, v135
  v_cvt_pk_bf16_f32 v131, v134, v135
  s_add_u32 s25, s25, 32768
  s_cmp_eq_u32 s25, 163840
  s_cselect_b32 s25, 0, s25
  s_mov_b32 s24, s38
  s_add_u32 s38, s38, 32768
  s_cmp_eq_u32 s38, 163840
  s_cselect_b32 s38, 0, s38
  s_add_u32 s73, s73, 1
  s_waitcnt vmcnt(8)
  s_barrier
  s_setprio 1
  v_add_u32 v5, s24, v11
  s_waitcnt lgkmcnt(3)
  v_mfma_f32_32x32x16_bf16 v[112:127], v[144:147], v[16:19], 0
  v_xor_b32 v3, 128, v160
  ds_read_b128 v[144:147], v3
  v_sub_f32 v136, v136, v0
  v_sub_f32 v137, v137, v0
  v_exp_f32 v136, v136
  v_exp_f32 v137, v137
  s_waitcnt lgkmcnt(3)
  v_mfma_f32_32x32x16_bf16 v[112:127], v[148:151], v[20:23], v[112:127]
  v_xor_b32 v4, 160, v160
  ds_read_b128 v[148:151], v4
  v_add_f32 v13, v13, v136
  v_add_f32 v14, v14, v137
  v_cvt_pk_bf16_f32 v136, v136, v137
  s_and_b32 s74, s26, 15
  s_lshl_b32 s74, s74, 13
  s_add_u32 s74, s74, s46
  s_add_u32 s26, s26, 1
  s_add_u32 s75, s25, s47
  s_add_u32 m0, s75, 0
  s_add_u32 s35, s74, 0
  buffer_load_dwordx4 v6, s[12:15], s35 offen nt lds
  s_waitcnt lgkmcnt(3)
  v_mfma_f32_32x32x16_bf16 v[112:127], v[152:155], v[24:27], v[112:127]
  v_xor_b32 v3, 192, v160
  ds_read_b128 v[152:155], v3
  v_sub_f32 v138, v138, v0
  v_sub_f32 v139, v139, v0
  v_exp_f32 v138, v138
  v_exp_f32 v139, v139
  s_waitcnt lgkmcnt(3)
  v_mfma_f32_32x32x16_bf16 v[112:127], v[156:159], v[28:31], v[112:127]
  v_xor_b32 v4, 224, v160
  ds_read_b128 v[156:159], v4
  v_add_f32 v13, v13, v138
  v_add_f32 v14, v14, v139
  v_cvt_pk_bf16_f32 v137, v138, v139
  s_add_u32 m0, s75, 1024
  s_add_u32 s35, s74, 1024
  buffer_load_dwordx4 v7, s[12:15], s35 offen nt lds
  s_waitcnt lgkmcnt(3)
  v_mfma_f32_32x32x16_bf16 v[112:127], v[144:147], v[32:35], v[112:127]
  ds_read_b64_tr_b16 v[144:145], v5 offset:0
  ds_read_b64_tr_b16 v[146:147], v5 offset:2048
  v_sub_f32 v140, v140, v0
  v_sub_f32 v141, v141, v0
  v_exp_f32 v140, v140
  v_exp_f32 v141, v141
  s_waitcnt lgkmcnt(4)
  v_mfma_f32_32x32x16_bf16 v[112:127], v[148:151], v[36:39], v[112:127]
  ds_read_b64_tr_b16 v[148:149], v5 offset:256
  ds_read_b64_tr_b16 v[150:151], v5 offset:2304
  v_add_f32 v13, v13, v140
  v_add_f32 v14, v14, v141
  v_cvt_pk_bf16_f32 v138, v140, v141
  s_add_u32 m0, s75, 2048
  s_add_u32 s35, s74, 2048
  buffer_load_dwordx4 v8, s[12:15], s35 offen nt lds
  s_waitcnt lgkmcnt(5)
  v_mfma_f32_32x32x16_bf16 v[112:127], v[152:155], v[40:43], v[112:127]
  ds_read_b64_tr_b16 v[152:153], v5 offset:512
  ds_read_b64_tr_b16 v[154:155], v5 offset:2560
  v_sub_f32 v142, v142, v0
  v_sub_f32 v143, v143, v0
  v_exp_f32 v142, v142
  v_exp_f32 v143, v143
  s_waitcnt lgkmcnt(6)
  v_mfma_f32_32x32x16_bf16 v[112:127], v[156:159], v[44:47], v[112:127]
  ds_read_b64_tr_b16 v[156:157], v5 offset:768
  ds_read_b64_tr_b16 v[158:159], v5 offset:2816
  v_add_f32 v13, v13, v142
  v_add_f32 v14, v14, v143
  v_cvt_pk_bf16_f32 v139, v142, v143
  s_add_u32 m0, s75, 3072
  s_add_u32 s35, s74, 3072
  buffer_load_dwordx4 v9, s[12:15], s35 offen nt lds
  v_add_f32 v13, v13, v14
  v_cmp_nge_f32 vcc, 0x49800000, v13
  s_nop 0
  s_cbranch_vccnz K1_A0L1_SLOW
K1_A0L1_CONT:
  v_add_f32 v12, v12, v13
  v_add_u32 v160, s38, v10
  s_waitcnt lgkmcnt(6)
  v_mfma_f32_32x32x16_bf16 v[48:63], v[144:147], v[128:131], v[48:63]
  ds_read_b64_tr_b16 v[144:145], v5 offset:4096
  ds_read_b64_tr_b16 v[146:147], v5 offset:6144
  s_waitcnt lgkmcnt(6)
  v_mfma_f32_32x32x16_bf16 v[64:79], v[148:151], v[128:131], v[64:79]
  ds_read_b64_tr_b16 v[148:149], v5 offset:4352
  ds_read_b64_tr_b16 v[150:151], v5 offset:6400
  v_sub_f32 v112, v112, v0
  v_sub_f32 v113, v113, v0
  v_exp_f32 v112, v112
  v_exp_f32 v113, v113
  s_waitcnt lgkmcnt(6)
  v_mfma_f32_32x32x16_bf16 v[80:95], v[152:155], v[128:131], v[80:95]
  ds_read_b64_tr_b16 v[152:153], v5 offset:4608
  ds_read_b64_tr_b16 v[154:155], v5 offset:6656
  v_add_f32 v13, v112, v113
  v_cvt_pk_bf16_f32 v112, v112, v113
  s_waitcnt lgkmcnt(6)
  v_mfma_f32_32x32x16_bf16 v[96:111], v[156:159], v[128:131], v[96:111]
  ds_read_b64_tr_b16 v[156:157], v5 offset:4864
  ds_read_b64_tr_b16 v[158:159], v5 offset:6912
  v_sub_f32 v114, v114, v0
  v_sub_f32 v115, v115, v0
  v_exp_f32 v114, v114
  v_exp_f32 v115, v115
  s_waitcnt lgkmcnt(6)
  v_mfma_f32_32x32x16_bf16 v[48:63], v[144:147], v[136:139], v[48:63]
  ds_read_b128 v[144:147], v160
  v_add_f32 v14, v114, v115
  v_cvt_pk_bf16_f32 v113, v114, v115
  s_waitcnt lgkmcnt(5)
  v_mfma_f32_32x32x16_bf16 v[64:79], v[148:151], v[136:139], v[64:79]
  v_xor_b32 v4, 32, v160
  ds_read_b128 v[148:151], v4
  v_sub_f32 v116, v116, v0
  v_sub_f32 v117, v117, v0
  v_exp_f32 v116, v116
  v_exp_f32 v117, v117
  s_waitcnt lgkmcnt(4)
  v_mfma_f32_32x32x16_bf16 v[80:95], v[152:155], v[136:139], v[80:95]
  v_xor_b32 v3, 64, v160
  ds_read_b128 v[152:155], v3
  v_add_f32 v13, v13, v116
  v_add_f32 v14, v14, v117
  v_cvt_pk_bf16_f32 v114, v116, v117
  s_waitcnt lgkmcnt(3)
  v_mfma_f32_32x32x16_bf16 v[96:111], v[156:159], v[136:139], v[96:111]
  v_xor_b32 v4, 96, v160
  ds_read_b128 v[156:159], v4
  v_sub_f32 v118, v118, v0
  v_sub_f32 v119, v119, v0
  v_exp_f32 v118, v118
  v_exp_f32 v119, v119
  v_add_f32 v13, v13, v118
  v_add_f32 v14, v14, v119
  v_cvt_pk_bf16_f32 v115, v118, v119
  s_add_u32 s25, s25, 32768
  s_cmp_eq_u32 s25, 163840
  s_cselect_b32 s25, 0, s25
  s_mov_b32 s24, s38
  s_add_u32 s38, s38, 32768
  s_cmp_eq_u32 s38, 163840
  s_cselect_b32 s38, 0, s38
  s_add_u32 s73, s73, 1
  s_add_u32 s45, s45, 1
  s_cmp_lt_u32 s45, 6
  s_cbranch_scc1 K1_A0L
  s_waitcnt vmcnt(8)
  s_barrier
  s_setprio 1
  v_add_u32 v5, s24, v11
  s_waitcnt lgkmcnt(3)
  v_mfma_f32_32x32x16_bf16 v[128:143], v[144:147], v[16:19], 0
  v_xor_b32 v3, 128, v160
  ds_read_b128 v[144:147], v3
  v_sub_f32 v120, v120, v0
  v_sub_f32 v121, v121, v0
  v_exp_f32 v120, v120
  v_exp_f32 v121, v121
  s_waitcnt lgkmcnt(3)
  v_mfma_f32_32x32x16_bf16 v[128:143], v[148:151], v[20:23], v[128:143]
  v_xor_b32 v4, 160, v160
  ds_read_b128 v[148:151], v4
  v_add_f32 v13, v13, v120
  v_add_f32 v14, v14, v121
  v_cvt_pk_bf16_f32 v120, v120, v121
  s_waitcnt lgkmcnt(3)
  v_mfma_f32_32x32x16_bf16 v[128:143], v[152:155], v[24:27], v[128:143]
  v_xor_b32 v3, 192, v160
  ds_read_b128 v[152:155], v3
  v_sub_f32 v122, v122, v0
  v_sub_f32 v123, v123, v0
  v_exp_f32 v122, v122
  v_exp_f32 v123, v123
  s_waitcnt lgkmcnt(3)
  v_mfma_f32_32x32x16_bf16 v[128:143], v[156:159], v[28:31], v[128:143]
  v_xor_b32 v4, 224, v160
  ds_read_b128 v[156:159], v4
  v_add_f32 v13, v13, v122
  v_add_f32 v14, v14, v123
  v_cvt_pk_bf16_f32 v121, v122, v123
  s_waitcnt lgkmcnt(3)
  v_mfma_f32_32x32x16_bf16 v[128:143], v[144:147], v[32:35], v[128:143]
  ds_read_b64_tr_b16 v[144:145], v5 offset:0
  ds_read_b64_tr_b16 v[146:147], v5 offset:2048
  v_sub_f32 v124, v124, v0
  v_sub_f32 v125, v125, v0
  v_exp_f32 v124, v124
  v_exp_f32 v125, v125
  s_waitcnt lgkmcnt(4)
  v_mfma_f32_32x32x16_bf16 v[128:143], v[148:151], v[36:39], v[128:143]
  ds_read_b64_tr_b16 v[148:149], v5 offset:256
  ds_read_b64_tr_b16 v[150:151], v5 offset:2304
  v_add_f32 v13, v13, v124
  v_add_f32 v14, v14, v125
  v_cvt_pk_bf16_f32 v122, v124, v125
  s_waitcnt lgkmcnt(5)
  v_mfma_f32_32x32x16_bf16 v[128:143], v[152:155], v[40:43], v[128:143]
  ds_read_b64_tr_b16 v[152:153], v5 offset:512
  ds_read_b64_tr_b16 v[154:155], v5 offset:2560
  v_sub_f32 v126, v126, v0
  v_sub_f32 v127, v127, v0
  v_exp_f32 v126, v126
  v_exp_f32 v127, v127
  s_waitcnt lgkmcnt(6)
  v_mfma_f32_32x32x16_bf16 v[128:143], v[156:159], v[44:47], v[128:143]
  ds_read_b64_tr_b16 v[156:157], v5 offset:768
  ds_read_b64_tr_b16 v[158:159], v5 offset:2816
  v_add_f32 v13, v13, v126
  v_add_f32 v14, v14, v127
  v_cvt_pk_bf16_f32 v123, v126, v127
  v_add_f32 v13, v13, v14
  v_cmp_nge_f32 vcc, 0x49800000, v13
  s_nop 0
  s_cbranch_vccnz K1_A0T12_SLOW
K1_A0T12_CONT:
  v_add_f32 v12, v12, v13
  v_add_u32 v160, s38, v10
  s_waitcnt lgkmcnt(6)
  v_mfma_f32_32x32x16_bf16 v[48:63], v[144:147], v[112:115], v[48:63]
  ds_read_b64_tr_b16 v[144:145], v5 offset:4096
  ds_read_b64_tr_b16 v[146:147], v5 offset:6144
  s_waitcnt lgkmcnt(6)
  v_mfma_f32_32x32x16_bf16 v[64:79], v[148:151], v[112:115], v[64:79]
  ds_read_b64_tr_b16 v[148:149], v5 offset:4352
  ds_read_b64_tr_b16 v[150:151], v5 offset:6400
  v_sub_f32 v128, v128, v0
  v_sub_f32 v129, v129, v0
  v_exp_f32 v128, v128
  v_exp_f32 v129, v129
  s_waitcnt lgkmcnt(6)
  v_mfma_f32_32x32x16_bf16 v[80:95], v[152:155], v[112:115], v[80:95]
  ds_read_b64_tr_b16 v[152:153], v5 offset:4608
  ds_read_b64_tr_b16 v[154:155], v5 offset:6656
  v_add_f32 v13, v128, v129
  v_cvt_pk_bf16_f32 v128, v128, v129
  s_waitcnt lgkmcnt(6)
  v_mfma_f32_32x32x16_bf16 v[96:111], v[156:159], v[112:115], v[96:111]
  ds_read_b64_tr_b16 v[156:157], v5 offset:4864
  ds_read_b64_tr_b16 v[158:159], v5 offset:6912
  v_sub_f32 v130, v130, v0
  v_sub_f32 v131, v131, v0
  v_exp_f32 v130, v130
  v_exp_f32 v131, v131
  s_waitcnt lgkmcnt(6)
  v_mfma_f32_32x32x16_bf16 v[48:63], v[144:147], v[120:123], v[48:63]
  ds_read_b128 v[144:147], v160
  v_add_f32 v14, v130, v131
  v_cvt_pk_bf16_f32 v129, v130, v131
  s_waitcnt lgkmcnt(5)
  v_mfma_f32_32x32x16_bf16 v[64:79], v[148:151], v[120:123], v[64:79]
  v_xor_b32 v4, 32, v160
  ds_read_b128 v[148:151], v4
  v_sub_f32 v132, v132, v0
  v_sub_f32 v133, v133, v0
  v_exp_f32 v132, v132
  v_exp_f32 v133, v133
  s_waitcnt lgkmcnt(4)
  v_mfma_f32_32x32x16_bf16 v[80:95], v[152:155], v[120:123], v[80:95]
  v_xor_b32 v3, 64, v160
  ds_read_b128 v[152:155], v3
  v_add_f32 v13, v13, v132
  v_add_f32 v14, v14, v133
  v_cvt_pk_bf16_f32 v130, v132, v133
  s_waitcnt lgkmcnt(3)
  v_mfma_f32_32x32x16_bf16 v[96:111], v[156:159], v[120:123], v[96:111]
  v_xor_b32 v4, 96, v160
  ds_read_b128 v[156:159], v4
  v_sub_f32 v134, v134, v0
  v_sub_f32 v135, v135, v0
  v_exp_f32 v134, v134
  v_exp_f32 v135, v135
  v_add_f32 v13, v13, v134
  v_add_f32 v14, v14, v135
  v_cvt_pk_bf16_f32 v131, v134, v135
  s_mov_b32 s24, s38
  s_add_u32 s38, s38, 32768
  s_cmp_eq_u32 s38, 163840
  s_cselect_b32 s38, 0, s38
  s_add_u32 s73, s73, 1
  s_waitcnt vmcnt(4)
  s_barrier
  s_setprio 1
  v_add_u32 v5, s24, v11
  s_waitcnt lgkmcnt(3)
  v_mfma_f32_32x32x16_bf16 v[112:127], v[144:147], v[16:19], 0
  v_xor_b32 v3, 128, v160
  ds_read_b128 v[144:147], v3
  v_sub_f32 v136, v136, v0
  v_sub_f32 v137, v137, v0
  v_exp_f32 v136, v136
  v_exp_f32 v137, v137
  s_waitcnt lgkmcnt(3)
  v_mfma_f32_32x32x16_bf16 v[112:127], v[148:151], v[20:23], v[112:127]
  v_xor_b32 v4, 160, v160
  ds_read_b128 v[148:151], v4
  v_add_f32 v13, v13, v136
  v_add_f32 v14, v14, v137
  v_cvt_pk_bf16_f32 v136, v136, v137
  s_waitcnt lgkmcnt(3)
  v_mfma_f32_32x32x16_bf16 v[112:127], v[152:155], v[24:27], v[112:127]
  v_xor_b32 v3, 192, v160
  ds_read_b128 v[152:155], v3
  v_sub_f32 v138, v138, v0
  v_sub_f32 v139, v139, v0
  v_exp_f32 v138, v138
  v_exp_f32 v139, v139
  s_waitcnt lgkmcnt(3)
  v_mfma_f32_32x32x16_bf16 v[112:127], v[156:159], v[28:31], v[112:127]
  v_xor_b32 v4, 224, v160
  ds_read_b128 v[156:159], v4
  v_add_f32 v13, v13, v138
  v_add_f32 v14, v14, v139
  v_cvt_pk_bf16_f32 v137, v138, v139
  s_waitcnt lgkmcnt(3)
  v_mfma_f32_32x32x16_bf16 v[112:127], v[144:147], v[32:35], v[112:127]
  ds_read_b64_tr_b16 v[144:145], v5 offset:0
  ds_read_b64_tr_b16 v[146:147], v5 offset:2048
  v_sub_f32 v140, v140, v0
  v_sub_f32 v141, v141, v0
  v_exp_f32 v140, v140
  v_exp_f32 v141, v141
  s_waitcnt lgkmcnt(4)
  v_mfma_f32_32x32x16_bf16 v[112:127], v[148:151], v[36:39], v[112:127]
  ds_read_b64_tr_b16 v[148:149], v5 offset:256
  ds_read_b64_tr_b16 v[150:151], v5 offset:2304
  v_add_f32 v13, v13, v140
  v_add_f32 v14, v14, v141
  v_cvt_pk_bf16_f32 v138, v140, v141
  s_waitcnt lgkmcnt(5)
  v_mfma_f32_32x32x16_bf16 v[112:127], v[152:155], v[40:43], v[112:127]
  ds_read_b64_tr_b16 v[152:153], v5 offset:512
  ds_read_b64_tr_b16 v[154:155], v5 offset:2560
  v_sub_f32 v142, v142, v0
  v_sub_f32 v143, v143, v0
  v_exp_f32 v142, v142
  v_exp_f32 v143, v143
  s_waitcnt lgkmcnt(6)
  v_mfma_f32_32x32x16_bf16 v[112:127], v[156:159], v[44:47], v[112:127]
  ds_read_b64_tr_b16 v[156:157], v5 offset:768
  ds_read_b64_tr_b16 v[158:159], v5 offset:2816
  v_add_f32 v13, v13, v142
  v_add_f32 v14, v14, v143
  v_cvt_pk_bf16_f32 v139, v142, v143
  v_add_f32 v13, v13, v14
  v_cmp_nge_f32 vcc, 0x49800000, v13
  s_nop 0
  s_cbranch_vccnz K1_A0T13_SLOW
K1_A0T13_CONT:
  v_add_f32 v12, v12, v13
  v_add_u32 v160, s38, v10
  s_waitcnt lgkmcnt(6)
  v_mfma_f32_32x32x16_bf16 v[48:63], v[144:147], v[128:131], v[48:63]
  ds_read_b64_tr_b16 v[144:145], v5 offset:4096
  ds_read_b64_tr_b16 v[146:147], v5 offset:6144
  s_waitcnt lgkmcnt(6)
  v_mfma_f32_32x32x16_bf16 v[64:79], v[148:151], v[128:131], v[64:79]
  ds_read_b64_tr_b16 v[148:149], v5 offset:4352
  ds_read_b64_tr_b16 v[150:151], v5 offset:6400
  v_sub_f32 v112, v112, v0
  v_sub_f32 v113, v113, v0
  v_exp_f32 v112, v112
  v_exp_f32 v113, v113
  s_waitcnt lgkmcnt(6)
  v_mfma_f32_32x32x16_bf16 v[80:95], v[152:155], v[128:131], v[80:95]
  ds_read_b64_tr_b16 v[152:153], v5 offset:4608
  ds_read_b64_tr_b16 v[154:155], v5 offset:6656
  v_add_f32 v13, v112, v113
  v_cvt_pk_bf16_f32 v112, v112, v113
  s_waitcnt lgkmcnt(6)
  v_mfma_f32_32x32x16_bf16 v[96:111], v[156:159], v[128:131], v[96:111]
  ds_read_b64_tr_b16 v[156:157], v5 offset:4864
  ds_read_b64_tr_b16 v[158:159], v5 offset:6912
  v_sub_f32 v114, v114, v0
  v_sub_f32 v115, v115, v0
  v_exp_f32 v114, v114
  v_exp_f32 v115, v115
  s_waitcnt lgkmcnt(6)
  v_mfma_f32_32x32x16_bf16 v[48:63], v[144:147], v[136:139], v[48:63]
  ds_read_b128 v[144:147], v160
  v_add_f32 v14, v114, v115
  v_cvt_pk_bf16_f32 v113, v114, v115
  s_waitcnt lgkmcnt(5)
  v_mfma_f32_32x32x16_bf16 v[64:79], v[148:151], v[136:139], v[64:79]
  v_xor_b32 v4, 32, v160
  ds_read_b128 v[148:151], v4
  v_sub_f32 v116, v116, v0
  v_sub_f32 v117, v117, v0
  v_exp_f32 v116, v116
  v_exp_f32 v117, v117
  s_waitcnt lgkmcnt(4)
  v_mfma_f32_32x32x16_bf16 v[80:95], v[152:155], v[136:139], v[80:95]
  v_xor_b32 v3, 64, v160
  ds_read_b128 v[152:155], v3
  v_add_f32 v13, v13, v116
  v_add_f32 v14, v14, v117
  v_cvt_pk_bf16_f32 v114, v116, v117
  s_waitcnt lgkmcnt(3)
  v_mfma_f32_32x32x16_bf16 v[96:111], v[156:159], v[136:139], v[96:111]
  v_xor_b32 v4, 96, v160
  ds_read_b128 v[156:159], v4
  v_sub_f32 v118, v118, v0
  v_sub_f32 v119, v119, v0
  v_exp_f32 v118, v118
  v_exp_f32 v119, v119
  v_add_f32 v13, v13, v118
  v_add_f32 v14, v14, v119
  v_cvt_pk_bf16_f32 v115, v118, v119
  s_mov_b32 s24, s38
  s_add_u32 s38, s38, 32768
  s_cmp_eq_u32 s38, 163840
  s_cselect_b32 s38, 0, s38
  s_add_u32 s73, s73, 1
  s_waitcnt vmcnt(0)
  s_barrier
  s_setprio 1
  v_add_u32 v5, s24, v11
  s_waitcnt lgkmcnt(3)
  v_mfma_f32_32x32x16_bf16 v[128:143], v[144:147], v[16:19], 0
  v_xor_b32 v3, 128, v160
  ds_read_b128 v[144:147], v3
  v_sub_f32 v120, v120, v0
  v_sub_f32 v121, v121, v0
  v_exp_f32 v120, v120
  v_exp_f32 v121, v121
  s_waitcnt lgkmcnt(3)
  v_mfma_f32_32x32x16_bf16 v[128:143], v[148:151], v[20:23], v[128:143]
  v_xor_b32 v4, 160, v160
  ds_read_b128 v[148:151], v4
  v_add_f32 v13, v13, v120
  v_add_f32 v14, v14, v121
  v_cvt_pk_bf16_f32 v120, v120, v121
  s_waitcnt lgkmcnt(3)
  v_mfma_f32_32x32x16_bf16 v[128:143], v[152:155], v[24:27], v[128:143]
  v_xor_b32 v3, 192, v160
  ds_read_b128 v[152:155], v3
  v_sub_f32 v122, v122, v0
  v_sub_f32 v123, v123, v0
  v_exp_f32 v122, v122
  v_exp_f32 v123, v123
  s_waitcnt lgkmcnt(3)
  v_mfma_f32_32x32x16_bf16 v[128:143], v[156:159], v[28:31], v[128:143]
  v_xor_b32 v4, 224, v160
  ds_read_b128 v[156:159], v4
  v_add_f32 v13, v13, v122
  v_add_f32 v14, v14, v123
  v_cvt_pk_bf16_f32 v121, v122, v123
  s_waitcnt lgkmcnt(3)
  v_mfma_f32_32x32x16_bf16 v[128:143], v[144:147], v[32:35], v[128:143]
  ds_read_b64_tr_b16 v[144:145], v5 offset:0
  ds_read_b64_tr_b16 v[146:147], v5 offset:2048
  v_sub_f32 v124, v124, v0
  v_sub_f32 v125, v125, v0
  v_exp_f32 v124, v124
  v_exp_f32 v125, v125
  s_waitcnt lgkmcnt(4)
  v_mfma_f32_32x32x16_bf16 v[128:143], v[148:151], v[36:39], v[128:143]
  ds_read_b64_tr_b16 v[148:149], v5 offset:256
  ds_read_b64_tr_b16 v[150:151], v5 offset:2304
  v_add_f32 v13, v13, v124
  v_add_f32 v14, v14, v125
  v_cvt_pk_bf16_f32 v122, v124, v125
  s_waitcnt lgkmcnt(5)
  v_mfma_f32_32x32x16_bf16 v[128:143], v[152:155], v[40:43], v[128:143]
  ds_read_b64_tr_b16 v[152:153], v5 offset:512
  ds_read_b64_tr_b16 v[154:155], v5 offset:2560
  v_sub_f32 v126, v126, v0
  v_sub_f32 v127, v127, v0
  v_exp_f32 v126, v126
  v_exp_f32 v127, v127
  s_waitcnt lgkmcnt(6)
  v_mfma_f32_32x32x16_bf16 v[128:143], v[156:159], v[44:47], v[128:143]
  ds_read_b64_tr_b16 v[156:157], v5 offset:768
  ds_read_b64_tr_b16 v[158:159], v5 offset:2816
  v_add_f32 v13, v13, v126
  v_add_f32 v14, v14, v127
  v_cvt_pk_bf16_f32 v123, v126, v127
  v_add_f32 v13, v13, v14
  v_cmp_nge_f32 vcc, 0x49800000, v13
  s_nop 0
  s_cbranch_vccnz K1_A0T14_SLOW
K1_A0T14_CONT:
  v_add_f32 v12, v12, v13
  s_waitcnt lgkmcnt(6)
  v_mfma_f32_32x32x16_bf16 v[48:63], v[144:147], v[112:115], v[48:63]
  ds_read_b64_tr_b16 v[144:145], v5 offset:4096
  ds_read_b64_tr_b16 v[146:147], v5 offset:6144
  s_waitcnt lgkmcnt(6)
  v_mfma_f32_32x32x16_bf16 v[64:79], v[148:151], v[112:115], v[64:79]
  ds_read_b64_tr_b16 v[148:149], v5 offset:4352
  ds_read_b64_tr_b16 v[150:151], v5 offset:6400
  v_sub_f32 v128, v128, v0
  v_sub_f32 v129, v129, v0
  v_exp_f32 v128, v128
  v_exp_f32 v129, v129
  s_waitcnt lgkmcnt(6)
  v_mfma_f32_32x32x16_bf16 v[80:95], v[152:155], v[112:115], v[80:95]
  ds_read_b64_tr_b16 v[152:153], v5 offset:4608
  ds_read_b64_tr_b16 v[154:155], v5 offset:6656
  v_add_f32 v13, v128, v129
  v_cvt_pk_bf16_f32 v128, v128, v129
  s_waitcnt lgkmcnt(6)
  v_mfma_f32_32x32x16_bf16 v[96:111], v[156:159], v[112:115], v[96:111]
  ds_read_b64_tr_b16 v[156:157], v5 offset:4864
  ds_read_b64_tr_b16 v[158:159], v5 offset:6912
  v_sub_f32 v130, v130, v0
  v_sub_f32 v131, v131, v0
  v_exp_f32 v130, v130
  v_exp_f32 v131, v131
  s_waitcnt lgkmcnt(6)
  v_mfma_f32_32x32x16_bf16 v[48:63], v[144:147], v[120:123], v[48:63]
  v_add_f32 v14, v130, v131
  v_cvt_pk_bf16_f32 v129, v130, v131
  s_waitcnt lgkmcnt(4)
  v_mfma_f32_32x32x16_bf16 v[64:79], v[148:151], v[120:123], v[64:79]
  v_sub_f32 v132, v132, v0
  v_sub_f32 v133, v133, v0
  v_exp_f32 v132, v132
  v_exp_f32 v133, v133
  s_waitcnt lgkmcnt(2)
  v_mfma_f32_32x32x16_bf16 v[80:95], v[152:155], v[120:123], v[80:95]
  v_add_f32 v13, v13, v132
  v_add_f32 v14, v14, v133
  v_cvt_pk_bf16_f32 v130, v132, v133
  s_waitcnt lgkmcnt(0)
  v_mfma_f32_32x32x16_bf16 v[96:111], v[156:159], v[120:123], v[96:111]
  v_sub_f32 v134, v134, v0
  v_sub_f32 v135, v135, v0
  v_exp_f32 v134, v134
  v_exp_f32 v135, v135
  v_add_f32 v13, v13, v134
  v_add_f32 v14, v14, v135
  v_cvt_pk_bf16_f32 v131, v134, v135
  s_mov_b32 s24, s38
  s_add_u32 s38, s38, 32768
  s_cmp_eq_u32 s38, 163840
  s_cselect_b32 s38, 0, s38
  s_add_u32 s73, s73, 1
  s_waitcnt vmcnt(0)
  s_barrier
  s_setprio 1
  v_add_u32 v5, s24, v11
  v_sub_f32 v136, v136, v0
  v_sub_f32 v137, v137, v0
  v_exp_f32 v136, v136
  v_exp_f32 v137, v137
  v_add_f32 v13, v13, v136
  v_add_f32 v14, v14, v137
  v_cvt_pk_bf16_f32 v136, v136, v137
  v_sub_f32 v138, v138, v0
  v_sub_f32 v139, v139, v0
  v_exp_f32 v138, v138
  v_exp_f32 v139, v139
  v_add_f32 v13, v13, v138
  v_add_f32 v14, v14, v139
  v_cvt_pk_bf16_f32 v137, v138, v139
  ds_read_b64_tr_b16 v[144:145], v5 offset:0
  ds_read_b64_tr_b16 v[146:147], v5 offset:2048
  v_sub_f32 v140, v140, v0
  v_sub_f32 v141, v141, v0
  v_exp_f32 v140, v140
  v_exp_f32 v141, v141
  ds_read_b64_tr_b16 v[148:149], v5 offset:256
  ds_read_b64_tr_b16 v[150:151], v5 offset:2304
  v_add_f32 v13, v13, v140
  v_add_f32 v14, v14, v141
  v_cvt_pk_bf16_f32 v138, v140, v141
  ds_read_b64_tr_b16 v[152:153], v5 offset:512
  ds_read_b64_tr_b16 v[154:155], v5 offset:2560
  v_sub_f32 v142, v142, v0
  v_sub_f32 v143, v143, v0
  v_exp_f32 v142, v142
  v_exp_f32 v143, v143
  ds_read_b64_tr_b16 v[156:157], v5 offset:768
  ds_read_b64_tr_b16 v[158:159], v5 offset:2816
  v_add_f32 v13, v13, v142
  v_add_f32 v14, v14, v143
  v_cvt_pk_bf16_f32 v139, v142, v143
  v_add_f32 v13, v13, v14
  v_cmp_nge_f32 vcc, 0x49800000, v13
  s_nop 0
  s_cbranch_vccnz K1_A0T15_SLOW
K1_A0T15_CONT:
  v_add_f32 v12, v12, v13
  s_waitcnt lgkmcnt(6)
  v_mfma_f32_32x32x16_bf16 v[48:63], v[144:147], v[128:131], v[48:63]
  ds_read_b64_tr_b16 v[144:145], v5 offset:4096
  ds_read_b64_tr_b16 v[146:147], v5 offset:6144
  s_waitcnt lgkmcnt(6)
  v_mfma_f32_32x32x16_bf16 v[64:79], v[148:151], v[128:131], v[64:79]
  ds_read_b64_tr_b16 v[148:149], v5 offset:4352
  ds_read_b64_tr_b16 v[150:151], v5 offset:6400
  s_waitcnt lgkmcnt(6)
  v_mfma_f32_32x32x16_bf16 v[80:95], v[152:155], v[128:131], v[80:95]
  ds_read_b64_tr_b16 v[152:153], v5 offset:4608
  ds_read_b64_tr_b16 v[154:155], v5 offset:6656
  s_waitcnt lgkmcnt(6)
  v_mfma_f32_32x32x16_bf16 v[96:111], v[156:159], v[128:131], v[96:111]
  ds_read_b64_tr_b16 v[156:157], v5 offset:4864
  ds_read_b64_tr_b16 v[158:159], v5 offset:6912
  s_waitcnt lgkmcnt(6)
  v_mfma_f32_32x32x16_bf16 v[48:63], v[144:147], v[136:139], v[48:63]
  s_waitcnt lgkmcnt(4)
  v_mfma_f32_32x32x16_bf16 v[64:79], v[148:151], v[136:139], v[64:79]
  s_waitcnt lgkmcnt(2)
  v_mfma_f32_32x32x16_bf16 v[80:95], v[152:155], v[136:139], v[80:95]
  s_waitcnt lgkmcnt(0)
  v_mfma_f32_32x32x16_bf16 v[96:111], v[156:159], v[136:139], v[96:111]
  s_mov_b32 s24, s38
  s_add_u32 s38, s38, 32768
  s_cmp_eq_u32 s38, 163840
  s_cselect_b32 s38, 0, s38
  s_add_u32 s73, s73, 1
  s_branch K1_EPI
K1_A0L0_SLOW:
  s_waitcnt lgkmcnt(0)
  v_and_b32 v14, 31, v1
  v_lshlrev_b32 v14, 8, v14
  v_lshrrev_b32 v15, 5, v1
  v_lshl_add_u32 v14, v15, 4, v14
  s_and_b32 s34, s73, 15
  s_lshl_b32 s34, s34, 13
  s_lshl_b32 s35, s32, 17
  s_add_u32 s34, s34, s35
  buffer_load_dwordx4 v[144:147], v14, s[4:7], s34 offen offset:0
  buffer_load_dwordx4 v[148:151], v14, s[4:7], s34 offen offset:32
  buffer_load_dwordx4 v[152:155], v14, s[4:7], s34 offen offset:64
  buffer_load_dwordx4 v[156:159], v14, s[4:7], s34 offen offset:96
  s_waitcnt vmcnt(0)
  v_mfma_f32_32x32x16_bf16 v[112:127], v[144:147], v[16:19], 0
  v_mfma_f32_32x32x16_bf16 v[112:127], v[148:151], v[20:23], v[112:127]
  v_mfma_f32_32x32x16_bf16 v[112:127], v[152:155], v[24:27], v[112:127]
  v_mfma_f32_32x32x16_bf16 v[112:127], v[156:159], v[28:31], v[112:127]
  buffer_load_dwordx4 v[144:147], v14, s[4:7], s34 offen offset:128
  buffer_load_dwordx4 v[148:151], v14, s[4:7], s34 offen offset:160
  buffer_load_dwordx4 v[152:155], v14, s[4:7], s34 offen offset:192
  buffer_load_dwordx4 v[156:159], v14, s[4:7], s34 offen offset:224
  s_waitcnt vmcnt(0)
  v_mfma_f32_32x32x16_bf16 v[112:127], v[144:147], v[32:35], v[112:127]
  v_mfma_f32_32x32x16_bf16 v[112:127], v[148:151], v[36:39], v[112:127]
  v_mfma_f32_32x32x16_bf16 v[112:127], v[152:155], v[40:43], v[112:127]
  v_mfma_f32_32x32x16_bf16 v[112:127], v[156:159], v[44:47], v[112:127]
  s_nop 11
  v_max3_f32 v14, v112, v113, v114
  v_max3_f32 v14, v14, v115, v116
  v_max3_f32 v14, v14, v117, v118
  v_max3_f32 v14, v14, v119, v120
  v_max3_f32 v14, v14, v121, v122
  v_max3_f32 v14, v14, v123, v124
  v_max3_f32 v14, v14, v125, v126
  v_max_f32 v14, v14, v127
  v_mov_b32 v15, v14
  s_nop 1
  v_permlane32_swap_b32 v14, v15
  v_max_f32 v14, v14, v15
  v_max_f32 v14, v14, v0
  v_sub_f32 v15, v0, v14
  v_exp_f32 v15, v15
  v_mov_b32 v0, v14
  v_mul_f32 v12, v12, v15
  v_mul_f32 v48, v48, v15
  v_mul_f32 v49, v49, v15
  v_mul_f32 v50, v50, v15
  v_mul_f32 v51, v51, v15
  v_mul_f32 v52, v52, v15
  v_mul_f32 v53, v53, v15
  v_mul_f32 v54, v54, v15
  v_mul_f32 v55, v55, v15
  v_mul_f32 v56, v56, v15
  v_mul_f32 v57, v57, v15
  v_mul_f32 v58, v58, v15
  v_mul_f32 v59, v59, v15
  v_mul_f32 v60, v60, v15
  v_mul_f32 v61, v61, v15
  v_mul_f32 v62, v62, v15
  v_mul_f32 v63, v63, v15
  v_mul_f32 v64, v64, v15
  v_mul_f32 v65, v65, v15
  v_mul_f32 v66, v66, v15
  v_mul_f32 v67, v67, v15
  v_mul_f32 v68, v68, v15
  v_mul_f32 v69, v69, v15
  v_mul_f32 v70, v70, v15
  v_mul_f32 v71, v71, v15
  v_mul_f32 v72, v72, v15
  v_mul_f32 v73, v73, v15
  v_mul_f32 v74, v74, v15
  v_mul_f32 v75, v75, v15
  v_mul_f32 v76, v76, v15
  v_mul_f32 v77, v77, v15
  v_mul_f32 v78, v78, v15
  v_mul_f32 v79, v79, v15
  v_mul_f32 v80, v80, v15
  v_mul_f32 v81, v81, v15
  v_mul_f32 v82, v82, v15
  v_mul_f32 v83, v83, v15
  v_mul_f32 v84, v84, v15
  v_mul_f32 v85, v85, v15
  v_mul_f32 v86, v86, v15
  v_mul_f32 v87, v87, v15
  v_mul_f32 v88, v88, v15
  v_mul_f32 v89, v89, v15
  v_mul_f32 v90, v90, v15
  v_mul_f32 v91, v91, v15
  v_mul_f32 v92, v92, v15
  v_mul_f32 v93, v93, v15
  v_mul_f32 v94, v94, v15
  v_mul_f32 v95, v95, v15
  v_mul_f32 v96, v96, v15
  v_mul_f32 v97, v97, v15
  v_mul_f32 v98, v98, v15
  v_mul_f32 v99, v99, v15
  v_mul_f32 v100, v100, v15
  v_mul_f32 v101, v101, v15
  v_mul_f32 v102, v102, v15
  v_mul_f32 v103, v103, v15
  v_mul_f32 v104, v104, v15
  v_mul_f32 v105, v105, v15
  v_mul_f32 v106, v106, v15
  v_mul_f32 v107, v107, v15
  v_mul_f32 v108, v108, v15
  v_mul_f32 v109, v109, v15
  v_mul_f32 v110, v110, v15
  v_mul_f32 v111, v111, v15
  ds_read_b64_tr_b16 v[144:145], v5 offset:0
  ds_read_b64_tr_b16 v[146:147], v5 offset:2048
  ds_read_b64_tr_b16 v[148:149], v5 offset:256
  ds_read_b64_tr_b16 v[150:151], v5 offset:2304
  ds_read_b64_tr_b16 v[152:153], v5 offset:512
  ds_read_b64_tr_b16 v[154:155], v5 offset:2560
  ds_read_b64_tr_b16 v[156:157], v5 offset:768
  ds_read_b64_tr_b16 v[158:159], v5 offset:2816
  v_sub_f32 v112, v112, v0
  v_sub_f32 v113, v113, v0
  v_exp_f32 v112, v112
  v_exp_f32 v113, v113
  v_sub_f32 v114, v114, v0
  v_sub_f32 v115, v115, v0
  v_exp_f32 v114, v114
  v_exp_f32 v115, v115
  v_sub_f32 v116, v116, v0
  v_sub_f32 v117, v117, v0
  v_exp_f32 v116, v116
  v_exp_f32 v117, v117
  v_sub_f32 v118, v118, v0
  v_sub_f32 v119, v119, v0
  v_exp_f32 v118, v118
  v_exp_f32 v119, v119
  v_sub_f32 v120, v120, v0
  v_sub_f32 v121, v121, v0
  v_exp_f32 v120, v120
  v_exp_f32 v121, v121
  v_sub_f32 v122, v122, v0
  v_sub_f32 v123, v123, v0
  v_exp_f32 v122, v122
  v_exp_f32 v123, v123
  v_sub_f32 v124, v124, v0
  v_sub_f32 v125, v125, v0
  v_exp_f32 v124, v124
  v_exp_f32 v125, v125
  v_sub_f32 v126, v126, v0
  v_sub_f32 v127, v127, v0
  v_exp_f32 v126, v126
  v_exp_f32 v127, v127
  v_add_f32 v13, v112, v113
  v_cvt_pk_bf16_f32 v112, v112, v113
  v_add_f32 v14, v114, v115
  v_cvt_pk_bf16_f32 v113, v114, v115
  v_add_f32 v13, v13, v116
  v_add_f32 v14, v14, v117
  v_cvt_pk_bf16_f32 v114, v116, v117
  v_add_f32 v13, v13, v118
  v_add_f32 v14, v14, v119
  v_cvt_pk_bf16_f32 v115, v118, v119
  v_add_f32 v13, v13, v120
  v_add_f32 v14, v14, v121
  v_cvt_pk_bf16_f32 v120, v120, v121
  v_add_f32 v13, v13, v122
  v_add_f32 v14, v14, v123
  v_cvt_pk_bf16_f32 v121, v122, v123
  v_add_f32 v13, v13, v124
  v_add_f32 v14, v14, v125
  v_cvt_pk_bf16_f32 v122, v124, v125
  v_add_f32 v13, v13, v126
  v_add_f32 v14, v14, v127
  v_cvt_pk_bf16_f32 v123, v126, v127
  v_add_f32 v13, v13, v14
  s_nop 0
  s_branch K1_A0L0_CONT
K1_A0L1_SLOW:
  s_waitcnt lgkmcnt(0)
  v_and_b32 v14, 31, v1
  v_lshlrev_b32 v14, 8, v14
  v_lshrrev_b32 v15, 5, v1
  v_lshl_add_u32 v14, v15, 4, v14
  s_and_b32 s34, s73, 15
  s_lshl_b32 s34, s34, 13
  s_lshl_b32 s35, s32, 17
  s_add_u32 s34, s34, s35
  buffer_load_dwordx4 v[144:147], v14, s[4:7], s34 offen offset:0
  buffer_load_dwordx4 v[148:151], v14, s[4:7], s34 offen offset:32
  buffer_load_dwordx4 v[152:155], v14, s[4:7], s34 offen offset:64
  buffer_load_dwordx4 v[156:159], v14, s[4:7], s34 offen offset:96
  s_waitcnt vmcnt(0)
  v_mfma_f32_32x32x16_bf16 v[128:143], v[144:147], v[16:19], 0
  v_mfma_f32_32x32x16_bf16 v[128:143], v[148:151], v[20:23], v[128:143]
  v_mfma_f32_32x32x16_bf16 v[128:143], v[152:155], v[24:27], v[128:143]
  v_mfma_f32_32x32x16_bf16 v[128:143], v[156:159], v[28:31], v[128:143]
  buffer_load_dwordx4 v[144:147], v14, s[4:7], s34 offen offset:128
  buffer_load_dwordx4 v[148:151], v14, s[4:7], s34 offen offset:160
  buffer_load_dwordx4 v[152:155], v14, s[4:7], s34 offen offset:192
  buffer_load_dwordx4 v[156:159], v14, s[4:7], s34 offen offset:224
  s_waitcnt vmcnt(0)
  v_mfma_f32_32x32x16_bf16 v[128:143], v[144:147], v[32:35], v[128:143]
  v_mfma_f32_32x32x16_bf16 v[128:143], v[148:151], v[36:39], v[128:143]
  v_mfma_f32_32x32x16_bf16 v[128:143], v[152:155], v[40:43], v[128:143]
  v_mfma_f32_32x32x16_bf16 v[128:143], v[156:159], v[44:47], v[128:143]
  s_nop 11
  v_max3_f32 v14, v128, v129, v130
  v_max3_f32 v14, v14, v131, v132
  v_max3_f32 v14, v14, v133, v134
  v_max3_f32 v14, v14, v135, v136
  v_max3_f32 v14, v14, v137, v138
  v_max3_f32 v14, v14, v139, v140
  v_max3_f32 v14, v14, v141, v142
  v_max_f32 v14, v14, v143
  v_mov_b32 v15, v14
  s_nop 1
  v_permlane32_swap_b32 v14, v15
  v_max_f32 v14, v14, v15
  v_max_f32 v14, v14, v0
  v_sub_f32 v15, v0, v14
  v_exp_f32 v15, v15
  v_mov_b32 v0, v14
  v_mul_f32 v12, v12, v15
  v_mul_f32 v48, v48, v15
  v_mul_f32 v49, v49, v15
  v_mul_f32 v50, v50, v15
  v_mul_f32 v51, v51, v15
  v_mul_f32 v52, v52, v15
  v_mul_f32 v53, v53, v15
  v_mul_f32 v54, v54, v15
  v_mul_f32 v55, v55, v15
  v_mul_f32 v56, v56, v15
  v_mul_f32 v57, v57, v15
  v_mul_f32 v58, v58, v15
  v_mul_f32 v59, v59, v15
  v_mul_f32 v60, v60, v15
  v_mul_f32 v61, v61, v15
  v_mul_f32 v62, v62, v15
  v_mul_f32 v63, v63, v15
  v_mul_f32 v64, v64, v15
  v_mul_f32 v65, v65, v15
  v_mul_f32 v66, v66, v15
  v_mul_f32 v67, v67, v15
  v_mul_f32 v68, v68, v15
  v_mul_f32 v69, v69, v15
  v_mul_f32 v70, v70, v15
  v_mul_f32 v71, v71, v15
  v_mul_f32 v72, v72, v15
  v_mul_f32 v73, v73, v15
  v_mul_f32 v74, v74, v15
  v_mul_f32 v75, v75, v15
  v_mul_f32 v76, v76, v15
  v_mul_f32 v77, v77, v15
  v_mul_f32 v78, v78, v15
  v_mul_f32 v79, v79, v15
  v_mul_f32 v80, v80, v15
  v_mul_f32 v81, v81, v15
  v_mul_f32 v82, v82, v15
  v_mul_f32 v83, v83, v15
  v_mul_f32 v84, v84, v15
  v_mul_f32 v85, v85, v15
  v_mul_f32 v86, v86, v15
  v_mul_f32 v87, v87, v15
  v_mul_f32 v88, v88, v15
  v_mul_f32 v89, v89, v15
  v_mul_f32 v90, v90, v15
  v_mul_f32 v91, v91, v15
  v_mul_f32 v92, v92, v15
  v_mul_f32 v93, v93, v15
  v_mul_f32 v94, v94, v15
  v_mul_f32 v95, v95, v15
  v_mul_f32 v96, v96, v15
  v_mul_f32 v97, v97, v15
  v_mul_f32 v98, v98, v15
  v_mul_f32 v99, v99, v15
  v_mul_f32 v100, v100, v15
  v_mul_f32 v101, v101, v15
  v_mul_f32 v102, v102, v15
  v_mul_f32 v103, v103, v15
  v_mul_f32 v104, v104, v15
  v_mul_f32 v105, v105, v15
  v_mul_f32 v106, v106, v15
  v_mul_f32 v107, v107, v15
  v_mul_f32 v108, v108, v15
  v_mul_f32 v109, v109, v15
  v_mul_f32 v110, v110, v15
  v_mul_f32 v111, v111, v15
  ds_read_b64_tr_b16 v[144:145], v5 offset:0
  ds_read_b64_tr_b16 v[146:147], v5 offset:2048
  ds_read_b64_tr_b16 v[148:149], v5 offset:256
  ds_read_b64_tr_b16 v[150:151], v5 offset:2304
  ds_read_b64_tr_b16 v[152:153], v5 offset:512
  ds_read_b64_tr_b16 v[154:155], v5 offset:2560
  ds_read_b64_tr_b16 v[156:157], v5 offset:768
  ds_read_b64_tr_b16 v[158:159], v5 offset:2816
  v_sub_f32 v128, v128, v0
  v_sub_f32 v129, v129, v0
  v_exp_f32 v128, v128
  v_exp_f32 v129, v129
  v_sub_f32 v130, v130, v0
  v_sub_f32 v131, v131, v0
  v_exp_f32 v130, v130
  v_exp_f32 v131, v131
  v_sub_f32 v132, v132, v0
  v_sub_f32 v133, v133, v0
  v_exp_f32 v132, v132
  v_exp_f32 v133, v133
  v_sub_f32 v134, v134, v0
  v_sub_f32 v135, v135, v0
  v_exp_f32 v134, v134
  v_exp_f32 v135, v135
  v_sub_f32 v136, v136, v0
  v_sub_f32 v137, v137, v0
  v_exp_f32 v136, v136
  v_exp_f32 v137, v137
  v_sub_f32 v138, v138, v0
  v_sub_f32 v139, v139, v0
  v_exp_f32 v138, v138
  v_exp_f32 v139, v139
  v_sub_f32 v140, v140, v0
  v_sub_f32 v141, v141, v0
  v_exp_f32 v140, v140
  v_exp_f32 v141, v141
  v_sub_f32 v142, v142, v0
  v_sub_f32 v143, v143, v0
  v_exp_f32 v142, v142
  v_exp_f32 v143, v143
  v_add_f32 v13, v128, v129
  v_cvt_pk_bf16_f32 v128, v128, v129
  v_add_f32 v14, v130, v131
  v_cvt_pk_bf16_f32 v129, v130, v131
  v_add_f32 v13, v13, v132
  v_add_f32 v14, v14, v133
  v_cvt_pk_bf16_f32 v130, v132, v133
  v_add_f32 v13, v13, v134
  v_add_f32 v14, v14, v135
  v_cvt_pk_bf16_f32 v131, v134, v135
  v_add_f32 v13, v13, v136
  v_add_f32 v14, v14, v137
  v_cvt_pk_bf16_f32 v136, v136, v137
  v_add_f32 v13, v13, v138
  v_add_f32 v14, v14, v139
  v_cvt_pk_bf16_f32 v137, v138, v139
  v_add_f32 v13, v13, v140
  v_add_f32 v14, v14, v141
  v_cvt_pk_bf16_f32 v138, v140, v141
  v_add_f32 v13, v13, v142
  v_add_f32 v14, v14, v143
  v_cvt_pk_bf16_f32 v139, v142, v143
  v_add_f32 v13, v13, v14
  s_nop 0
  s_branch K1_A0L1_CONT
K1_A0T12_SLOW:
  s_waitcnt lgkmcnt(0)
  v_and_b32 v14, 31, v1
  v_lshlrev_b32 v14, 8, v14
  v_lshrrev_b32 v15, 5, v1
  v_lshl_add_u32 v14, v15, 4, v14
  s_and_b32 s34, s73, 15
  s_lshl_b32 s34, s34, 13
  s_lshl_b32 s35, s32, 17
  s_add_u32 s34, s34, s35
  buffer_load_dwordx4 v[144:147], v14, s[4:7], s34 offen offset:0
  buffer_load_dwordx4 v[148:151], v14, s[4:7], s34 offen offset:32
  buffer_load_dwordx4 v[152:155], v14, s[4:7], s34 offen offset:64
  buffer_load_dwordx4 v[156:159], v14, s[4:7], s34 offen offset:96
  s_waitcnt vmcnt(0)
  v_mfma_f32_32x32x16_bf16 v[112:127], v[144:147], v[16:19], 0
  v_mfma_f32_32x32x16_bf16 v[112:127], v[148:151], v[20:23], v[112:127]
  v_mfma_f32_32x32x16_bf16 v[112:127], v[152:155], v[24:27], v[112:127]
  v_mfma_f32_32x32x16_bf16 v[112:127], v[156:159], v[28:31], v[112:127]
  buffer_load_dwordx4 v[144:147], v14, s[4:7], s34 offen offset:128
  buffer_load_dwordx4 v[148:151], v14, s[4:7], s34 offen offset:160
  buffer_load_dwordx4 v[152:155], v14, s[4:7], s34 offen offset:192
  buffer_load_dwordx4 v[156:159], v14, s[4:7], s34 offen offset:224
  s_waitcnt vmcnt(0)
  v_mfma_f32_32x32x16_bf16 v[112:127], v[144:147], v[32:35], v[112:127]
  v_mfma_f32_32x32x16_bf16 v[112:127], v[148:151], v[36:39], v[112:127]
  v_mfma_f32_32x32x16_bf16 v[112:127], v[152:155], v[40:43], v[112:127]
  v_mfma_f32_32x32x16_bf16 v[112:127], v[156:159], v[44:47], v[112:127]
  s_nop 11
  v_max3_f32 v14, v112, v113, v114
  v_max3_f32 v14, v14, v115, v116
  v_max3_f32 v14, v14, v117, v118
  v_max3_f32 v14, v14, v119, v120
  v_max3_f32 v14, v14, v121, v122
  v_max3_f32 v14, v14, v123, v124
  v_max3_f32 v14, v14, v125, v126
  v_max_f32 v14, v14, v127
  v_mov_b32 v15, v14
  s_nop 1
  v_permlane32_swap_b32 v14, v15
  v_max_f32 v14, v14, v15
  v_max_f32 v14, v14, v0
  v_sub_f32 v15, v0, v14
  v_exp_f32 v15, v15
  v_mov_b32 v0, v14
  v_mul_f32 v12, v12, v15
  v_mul_f32 v48, v48, v15
  v_mul_f32 v49, v49, v15
  v_mul_f32 v50, v50, v15
  v_mul_f32 v51, v51, v15
  v_mul_f32 v52, v52, v15
  v_mul_f32 v53, v53, v15
  v_mul_f32 v54, v54, v15
  v_mul_f32 v55, v55, v15
  v_mul_f32 v56, v56, v15
  v_mul_f32 v57, v57, v15
  v_mul_f32 v58, v58, v15
  v_mul_f32 v59, v59, v15
  v_mul_f32 v60, v60, v15
  v_mul_f32 v61, v61, v15
  v_mul_f32 v62, v62, v15
  v_mul_f32 v63, v63, v15
  v_mul_f32 v64, v64, v15
  v_mul_f32 v65, v65, v15
  v_mul_f32 v66, v66, v15
  v_mul_f32 v67, v67, v15
  v_mul_f32 v68, v68, v15
  v_mul_f32 v69, v69, v15
  v_mul_f32 v70, v70, v15
  v_mul_f32 v71, v71, v15
  v_mul_f32 v72, v72, v15
  v_mul_f32 v73, v73, v15
  v_mul_f32 v74, v74, v15
  v_mul_f32 v75, v75, v15
  v_mul_f32 v76, v76, v15
  v_mul_f32 v77, v77, v15
  v_mul_f32 v78, v78, v15
  v_mul_f32 v79, v79, v15
  v_mul_f32 v80, v80, v15
  v_mul_f32 v81, v81, v15
  v_mul_f32 v82, v82, v15
  v_mul_f32 v83, v83, v15
  v_mul_f32 v84, v84, v15
  v_mul_f32 v85, v85, v15
  v_mul_f32 v86, v86, v15
  v_mul_f32 v87, v87, v15
  v_mul_f32 v88, v88, v15
  v_mul_f32 v89, v89, v15
  v_mul_f32 v90, v90, v15
  v_mul_f32 v91, v91, v15
  v_mul_f32 v92, v92, v15
  v_mul_f32 v93, v93, v15
  v_mul_f32 v94, v94, v15
  v_mul_f32 v95, v95, v15
  v_mul_f32 v96, v96, v15
  v_mul_f32 v97, v97, v15
  v_mul_f32 v98, v98, v15
  v_mul_f32 v99, v99, v15
  v_mul_f32 v100, v100, v15
  v_mul_f32 v101, v101, v15
  v_mul_f32 v102, v102, v15
  v_mul_f32 v103, v103, v15
  v_mul_f32 v104, v104, v15
  v_mul_f32 v105, v105, v15
  v_mul_f32 v106, v106, v15
  v_mul_f32 v107, v107, v15
  v_mul_f32 v108, v108, v15
  v_mul_f32 v109, v109, v15
  v_mul_f32 v110, v110, v15
  v_mul_f32 v111, v111, v15
  ds_read_b64_tr_b16 v[144:145], v5 offset:0
  ds_read_b64_tr_b16 v[146:147], v5 offset:2048
  ds_read_b64_tr_b16 v[148:149], v5 offset:256
  ds_read_b64_tr_b16 v[150:151], v5 offset:2304
  ds_read_b64_tr_b16 v[152:153], v5 offset:512
  ds_read_b64_tr_b16 v[154:155], v5 offset:2560
  ds_read_b64_tr_b16 v[156:157], v5 offset:768
  ds_read_b64_tr_b16 v[158:159], v5 offset:2816
  v_sub_f32 v112, v112, v0
  v_sub_f32 v113, v113, v0
  v_exp_f32 v112, v112
  v_exp_f32 v113, v113
  v_sub_f32 v114, v114, v0
  v_sub_f32 v115, v115, v0
  v_exp_f32 v114, v114
  v_exp_f32 v115, v115
  v_sub_f32 v116, v116, v0
  v_sub_f32 v117, v117, v0
  v_exp_f32 v116, v116
  v_exp_f32 v117, v117
  v_sub_f32 v118, v118, v0
  v_sub_f32 v119, v119, v0
  v_exp_f32 v118, v118
  v_exp_f32 v119, v119
  v_sub_f32 v120, v120, v0
  v_sub_f32 v121, v121, v0
  v_exp_f32 v120, v120
  v_exp_f32 v121, v121
  v_sub_f32 v122, v122, v0
  v_sub_f32 v123, v123, v0
  v_exp_f32 v122, v122
  v_exp_f32 v123, v123
  v_sub_f32 v124, v124, v0
  v_sub_f32 v125, v125, v0
  v_exp_f32 v124, v124
  v_exp_f32 v125, v125
  v_sub_f32 v126, v126, v0
  v_sub_f32 v127, v127, v0
  v_exp_f32 v126, v126
  v_exp_f32 v127, v127
  v_add_f32 v13, v112, v113
  v_cvt_pk_bf16_f32 v112, v112, v113
  v_add_f32 v14, v114, v115
  v_cvt_pk_bf16_f32 v113, v114, v115
  v_add_f32 v13, v13, v116
  v_add_f32 v14, v14, v117
  v_cvt_pk_bf16_f32 v114, v116, v117
  v_add_f32 v13, v13, v118
  v_add_f32 v14, v14, v119
  v_cvt_pk_bf16_f32 v115, v118, v119
  v_add_f32 v13, v13, v120
  v_add_f32 v14, v14, v121
  v_cvt_pk_bf16_f32 v120, v120, v121
  v_add_f32 v13, v13, v122
  v_add_f32 v14, v14, v123
  v_cvt_pk_bf16_f32 v121, v122, v123
  v_add_f32 v13, v13, v124
  v_add_f32 v14, v14, v125
  v_cvt_pk_bf16_f32 v122, v124, v125
  v_add_f32 v13, v13, v126
  v_add_f32 v14, v14, v127
  v_cvt_pk_bf16_f32 v123, v126, v127
  v_add_f32 v13, v13, v14
  s_nop 0
  s_branch K1_A0T12_CONT
K1_A0T13_SLOW:
  s_waitcnt lgkmcnt(0)
  v_and_b32 v14, 31, v1
  v_lshlrev_b32 v14, 8, v14
  v_lshrrev_b32 v15, 5, v1
  v_lshl_add_u32 v14, v15, 4, v14
  s_and_b32 s34, s73, 15
  s_lshl_b32 s34, s34, 13
  s_lshl_b32 s35, s32, 17
  s_add_u32 s34, s34, s35
  buffer_load_dwordx4 v[144:147], v14, s[4:7], s34 offen offset:0
  buffer_load_dwordx4 v[148:151], v14, s[4:7], s34 offen offset:32
  buffer_load_dwordx4 v[152:155], v14, s[4:7], s34 offen offset:64
  buffer_load_dwordx4 v[156:159], v14, s[4:7], s34 offen offset:96
  s_waitcnt vmcnt(0)
  v_mfma_f32_32x32x16_bf16 v[128:143], v[144:147], v[16:19], 0
  v_mfma_f32_32x32x16_bf16 v[128:143], v[148:151], v[20:23], v[128:143]
  v_mfma_f32_32x32x16_bf16 v[128:143], v[152:155], v[24:27], v[128:143]
  v_mfma_f32_32x32x16_bf16 v[128:143], v[156:159], v[28:31], v[128:143]
  buffer_load_dwordx4 v[144:147], v14, s[4:7], s34 offen offset:128
  buffer_load_dwordx4 v[148:151], v14, s[4:7], s34 offen offset:160
  buffer_load_dwordx4 v[152:155], v14, s[4:7], s34 offen offset:192
  buffer_load_dwordx4 v[156:159], v14, s[4:7], s34 offen offset:224
  s_waitcnt vmcnt(0)
  v_mfma_f32_32x32x16_bf16 v[128:143], v[144:147], v[32:35], v[128:143]
  v_mfma_f32_32x32x16_bf16 v[128:143], v[148:151], v[36:39], v[128:143]
  v_mfma_f32_32x32x16_bf16 v[128:143], v[152:155], v[40:43], v[128:143]
  v_mfma_f32_32x32x16_bf16 v[128:143], v[156:159], v[44:47], v[128:143]
  s_nop 11
  v_max3_f32 v14, v128, v129, v130
  v_max3_f32 v14, v14, v131, v132
  v_max3_f32 v14, v14, v133, v134
  v_max3_f32 v14, v14, v135, v136
  v_max3_f32 v14, v14, v137, v138
  v_max3_f32 v14, v14, v139, v140
  v_max3_f32 v14, v14, v141, v142
  v_max_f32 v14, v14, v143
  v_mov_b32 v15, v14
  s_nop 1
  v_permlane32_swap_b32 v14, v15
  v_max_f32 v14, v14, v15
  v_max_f32 v14, v14, v0
  v_sub_f32 v15, v0, v14
  v_exp_f32 v15, v15
  v_mov_b32 v0, v14
  v_mul_f32 v12, v12, v15
  v_mul_f32 v48, v48, v15
  v_mul_f32 v49, v49, v15
  v_mul_f32 v50, v50, v15
  v_mul_f32 v51, v51, v15
  v_mul_f32 v52, v52, v15
  v_mul_f32 v53, v53, v15
  v_mul_f32 v54, v54, v15
  v_mul_f32 v55, v55, v15
  v_mul_f32 v56, v56, v15
  v_mul_f32 v57, v57, v15
  v_mul_f32 v58, v58, v15
  v_mul_f32 v59, v59, v15
  v_mul_f32 v60, v60, v15
  v_mul_f32 v61, v61, v15
  v_mul_f32 v62, v62, v15
  v_mul_f32 v63, v63, v15
  v_mul_f32 v64, v64, v15
  v_mul_f32 v65, v65, v15
  v_mul_f32 v66, v66, v15
  v_mul_f32 v67, v67, v15
  v_mul_f32 v68, v68, v15
  v_mul_f32 v69, v69, v15
  v_mul_f32 v70, v70, v15
  v_mul_f32 v71, v71, v15
  v_mul_f32 v72, v72, v15
  v_mul_f32 v73, v73, v15
  v_mul_f32 v74, v74, v15
  v_mul_f32 v75, v75, v15
  v_mul_f32 v76, v76, v15
  v_mul_f32 v77, v77, v15
  v_mul_f32 v78, v78, v15
  v_mul_f32 v79, v79, v15
  v_mul_f32 v80, v80, v15
  v_mul_f32 v81, v81, v15
  v_mul_f32 v82, v82, v15
  v_mul_f32 v83, v83, v15
  v_mul_f32 v84, v84, v15
  v_mul_f32 v85, v85, v15
  v_mul_f32 v86, v86, v15
  v_mul_f32 v87, v87, v15
  v_mul_f32 v88, v88, v15
  v_mul_f32 v89, v89, v15
  v_mul_f32 v90, v90, v15
  v_mul_f32 v91, v91, v15
  v_mul_f32 v92, v92, v15
  v_mul_f32 v93, v93, v15
  v_mul_f32 v94, v94, v15
  v_mul_f32 v95, v95, v15
  v_mul_f32 v96, v96, v15
  v_mul_f32 v97, v97, v15
  v_mul_f32 v98, v98, v15
  v_mul_f32 v99, v99, v15
  v_mul_f32 v100, v100, v15
  v_mul_f32 v101, v101, v15
  v_mul_f32 v102, v102, v15
  v_mul_f32 v103, v103, v15
  v_mul_f32 v104, v104, v15
  v_mul_f32 v105, v105, v15
  v_mul_f32 v106, v106, v15
  v_mul_f32 v107, v107, v15
  v_mul_f32 v108, v108, v15
  v_mul_f32 v109, v109, v15
  v_mul_f32 v110, v110, v15
  v_mul_f32 v111, v111, v15
  ds_read_b64_tr_b16 v[144:145], v5 offset:0
  ds_read_b64_tr_b16 v[146:147], v5 offset:2048
  ds_read_b64_tr_b16 v[148:149], v5 offset:256
  ds_read_b64_tr_b16 v[150:151], v5 offset:2304
  ds_read_b64_tr_b16 v[152:153], v5 offset:512
  ds_read_b64_tr_b16 v[154:155], v5 offset:2560
  ds_read_b64_tr_b16 v[156:157], v5 offset:768
  ds_read_b64_tr_b16 v[158:159], v5 offset:2816
  v_sub_f32 v128, v128, v0
  v_sub_f32 v129, v129, v0
  v_exp_f32 v128, v128
  v_exp_f32 v129, v129
  v_sub_f32 v130, v130, v0
  v_sub_f32 v131, v131, v0
  v_exp_f32 v130, v130
  v_exp_f32 v131, v131
  v_sub_f32 v132, v132, v0
  v_sub_f32 v133, v133, v0
  v_exp_f32 v132, v132
  v_exp_f32 v133, v133
  v_sub_f32 v134, v134, v0
  v_sub_f32 v135, v135, v0
  v_exp_f32 v134, v134
  v_exp_f32 v135, v135
  v_sub_f32 v136, v136, v0
  v_sub_f32 v137, v137, v0
  v_exp_f32 v136, v136
  v_exp_f32 v137, v137
  v_sub_f32 v138, v138, v0
  v_sub_f32 v139, v139, v0
  v_exp_f32 v138, v138
  v_exp_f32 v139, v139
  v_sub_f32 v140, v140, v0
  v_sub_f32 v141, v141, v0
  v_exp_f32 v140, v140
  v_exp_f32 v141, v141
  v_sub_f32 v142, v142, v0
  v_sub_f32 v143, v143, v0
  v_exp_f32 v142, v142
  v_exp_f32 v143, v143
  v_add_f32 v13, v128, v129
  v_cvt_pk_bf16_f32 v128, v128, v129
  v_add_f32 v14, v130, v131
  v_cvt_pk_bf16_f32 v129, v130, v131
  v_add_f32 v13, v13, v132
  v_add_f32 v14, v14, v133
  v_cvt_pk_bf16_f32 v130, v132, v133
  v_add_f32 v13, v13, v134
  v_add_f32 v14, v14, v135
  v_cvt_pk_bf16_f32 v131, v134, v135
  v_add_f32 v13, v13, v136
  v_add_f32 v14, v14, v137
  v_cvt_pk_bf16_f32 v136, v136, v137
  v_add_f32 v13, v13, v138
  v_add_f32 v14, v14, v139
  v_cvt_pk_bf16_f32 v137, v138, v139
  v_add_f32 v13, v13, v140
  v_add_f32 v14, v14, v141
  v_cvt_pk_bf16_f32 v138, v140, v141
  v_add_f32 v13, v13, v142
  v_add_f32 v14, v14, v143
  v_cvt_pk_bf16_f32 v139, v142, v143
  v_add_f32 v13, v13, v14
  s_nop 0
  s_branch K1_A0T13_CONT
K1_A0T14_SLOW:
  s_waitcnt lgkmcnt(0)
  v_and_b32 v14, 31, v1
  v_lshlrev_b32 v14, 8, v14
  v_lshrrev_b32 v15, 5, v1
  v_lshl_add_u32 v14, v15, 4, v14
  s_and_b32 s34, s73, 15
  s_lshl_b32 s34, s34, 13
  s_lshl_b32 s35, s32, 17
  s_add_u32 s34, s34, s35
  buffer_load_dwordx4 v[144:147], v14, s[4:7], s34 offen offset:0
  buffer_load_dwordx4 v[148:151], v14, s[4:7], s34 offen offset:32
  buffer_load_dwordx4 v[152:155], v14, s[4:7], s34 offen offset:64
  buffer_load_dwordx4 v[156:159], v14, s[4:7], s34 offen offset:96
  s_waitcnt vmcnt(0)
  v_mfma_f32_32x32x16_bf16 v[112:127], v[144:147], v[16:19], 0
  v_mfma_f32_32x32x16_bf16 v[112:127], v[148:151], v[20:23], v[112:127]
  v_mfma_f32_32x32x16_bf16 v[112:127], v[152:155], v[24:27], v[112:127]
  v_mfma_f32_32x32x16_bf16 v[112:127], v[156:159], v[28:31], v[112:127]
  buffer_load_dwordx4 v[144:147], v14, s[4:7], s34 offen offset:128
  buffer_load_dwordx4 v[148:151], v14, s[4:7], s34 offen offset:160
  buffer_load_dwordx4 v[152:155], v14, s[4:7], s34 offen offset:192
  buffer_load_dwordx4 v[156:159], v14, s[4:7], s34 offen offset:224
  s_waitcnt vmcnt(0)
  v_mfma_f32_32x32x16_bf16 v[112:127], v[144:147], v[32:35], v[112:127]
  v_mfma_f32_32x32x16_bf16 v[112:127], v[148:151], v[36:39], v[112:127]
  v_mfma_f32_32x32x16_bf16 v[112:127], v[152:155], v[40:43], v[112:127]
  v_mfma_f32_32x32x16_bf16 v[112:127], v[156:159], v[44:47], v[112:127]
  s_nop 11
  v_max3_f32 v14, v112, v113, v114
  v_max3_f32 v14, v14, v115, v116
  v_max3_f32 v14, v14, v117, v118
  v_max3_f32 v14, v14, v119, v120
  v_max3_f32 v14, v14, v121, v122
  v_max3_f32 v14, v14, v123, v124
  v_max3_f32 v14, v14, v125, v126
  v_max_f32 v14, v14, v127
  v_mov_b32 v15, v14
  s_nop 1
  v_permlane32_swap_b32 v14, v15
  v_max_f32 v14, v14, v15
  v_max_f32 v14, v14, v0
  v_sub_f32 v15, v0, v14
  v_exp_f32 v15, v15
  v_mov_b32 v0, v14
  v_mul_f32 v12, v12, v15
  v_mul_f32 v48, v48, v15
  v_mul_f32 v49, v49, v15
  v_mul_f32 v50, v50, v15
  v_mul_f32 v51, v51, v15
  v_mul_f32 v52, v52, v15
  v_mul_f32 v53, v53, v15
  v_mul_f32 v54, v54, v15
  v_mul_f32 v55, v55, v15
  v_mul_f32 v56, v56, v15
  v_mul_f32 v57, v57, v15
  v_mul_f32 v58, v58, v15
  v_mul_f32 v59, v59, v15
  v_mul_f32 v60, v60, v15
  v_mul_f32 v61, v61, v15
  v_mul_f32 v62, v62, v15
  v_mul_f32 v63, v63, v15
  v_mul_f32 v64, v64, v15
  v_mul_f32 v65, v65, v15
  v_mul_f32 v66, v66, v15
  v_mul_f32 v67, v67, v15
  v_mul_f32 v68, v68, v15
  v_mul_f32 v69, v69, v15
  v_mul_f32 v70, v70, v15
  v_mul_f32 v71, v71, v15
  v_mul_f32 v72, v72, v15
  v_mul_f32 v73, v73, v15
  v_mul_f32 v74, v74, v15
  v_mul_f32 v75, v75, v15
  v_mul_f32 v76, v76, v15
  v_mul_f32 v77, v77, v15
  v_mul_f32 v78, v78, v15
  v_mul_f32 v79, v79, v15
  v_mul_f32 v80, v80, v15
  v_mul_f32 v81, v81, v15
  v_mul_f32 v82, v82, v15
  v_mul_f32 v83, v83, v15
  v_mul_f32 v84, v84, v15
  v_mul_f32 v85, v85, v15
  v_mul_f32 v86, v86, v15
  v_mul_f32 v87, v87, v15
  v_mul_f32 v88, v88, v15
  v_mul_f32 v89, v89, v15
  v_mul_f32 v90, v90, v15
  v_mul_f32 v91, v91, v15
  v_mul_f32 v92, v92, v15
  v_mul_f32 v93, v93, v15
  v_mul_f32 v94, v94, v15
  v_mul_f32 v95, v95, v15
  v_mul_f32 v96, v96, v15
  v_mul_f32 v97, v97, v15
  v_mul_f32 v98, v98, v15
  v_mul_f32 v99, v99, v15
  v_mul_f32 v100, v100, v15
  v_mul_f32 v101, v101, v15
  v_mul_f32 v102, v102, v15
  v_mul_f32 v103, v103, v15
  v_mul_f32 v104, v104, v15
  v_mul_f32 v105, v105, v15
  v_mul_f32 v106, v106, v15
  v_mul_f32 v107, v107, v15
  v_mul_f32 v108, v108, v15
  v_mul_f32 v109, v109, v15
  v_mul_f32 v110, v110, v15
  v_mul_f32 v111, v111, v15
  ds_read_b64_tr_b16 v[144:145], v5 offset:0
  ds_read_b64_tr_b16 v[146:147], v5 offset:2048
  ds_read_b64_tr_b16 v[148:149], v5 offset:256
  ds_read_b64_tr_b16 v[150:151], v5 offset:2304
  ds_read_b64_tr_b16 v[152:153], v5 offset:512
  ds_read_b64_tr_b16 v[154:155], v5 offset:2560
  ds_read_b64_tr_b16 v[156:157], v5 offset:768
  ds_read_b64_tr_b16 v[158:159], v5 offset:2816
  v_sub_f32 v112, v112, v0
  v_sub_f32 v113, v113, v0
  v_exp_f32 v112, v112
  v_exp_f32 v113, v113
  v_sub_f32 v114, v114, v0
  v_sub_f32 v115, v115, v0
  v_exp_f32 v114, v114
  v_exp_f32 v115, v115
  v_sub_f32 v116, v116, v0
  v_sub_f32 v117, v117, v0
  v_exp_f32 v116, v116
  v_exp_f32 v117, v117
  v_sub_f32 v118, v118, v0
  v_sub_f32 v119, v119, v0
  v_exp_f32 v118, v118
  v_exp_f32 v119, v119
  v_sub_f32 v120, v120, v0
  v_sub_f32 v121, v121, v0
  v_exp_f32 v120, v120
  v_exp_f32 v121, v121
  v_sub_f32 v122, v122, v0
  v_sub_f32 v123, v123, v0
  v_exp_f32 v122, v122
  v_exp_f32 v123, v123
  v_sub_f32 v124, v124, v0
  v_sub_f32 v125, v125, v0
  v_exp_f32 v124, v124
  v_exp_f32 v125, v125
  v_sub_f32 v126, v126, v0
  v_sub_f32 v127, v127, v0
  v_exp_f32 v126, v126
  v_exp_f32 v127, v127
  v_add_f32 v13, v112, v113
  v_cvt_pk_bf16_f32 v112, v112, v113
  v_add_f32 v14, v114, v115
  v_cvt_pk_bf16_f32 v113, v114, v115
  v_add_f32 v13, v13, v116
  v_add_f32 v14, v14, v117
  v_cvt_pk_bf16_f32 v114, v116, v117
  v_add_f32 v13, v13, v118
  v_add_f32 v14, v14, v119
  v_cvt_pk_bf16_f32 v115, v118, v119
  v_add_f32 v13, v13, v120
  v_add_f32 v14, v14, v121
  v_cvt_pk_bf16_f32 v120, v120, v121
  v_add_f32 v13, v13, v122
  v_add_f32 v14, v14, v123
  v_cvt_pk_bf16_f32 v121, v122, v123
  v_add_f32 v13, v13, v124
  v_add_f32 v14, v14, v125
  v_cvt_pk_bf16_f32 v122, v124, v125
  v_add_f32 v13, v13, v126
  v_add_f32 v14, v14, v127
  v_cvt_pk_bf16_f32 v123, v126, v127
  v_add_f32 v13, v13, v14
  s_nop 0
  s_branch K1_A0T14_CONT
K1_A0T15_SLOW:
  s_waitcnt lgkmcnt(0)
  v_and_b32 v14, 31, v1
  v_lshlrev_b32 v14, 8, v14
  v_lshrrev_b32 v15, 5, v1
  v_lshl_add_u32 v14, v15, 4, v14
  s_and_b32 s34, s73, 15
  s_lshl_b32 s34, s34, 13
  s_lshl_b32 s35, s32, 17
  s_add_u32 s34, s34, s35
  buffer_load_dwordx4 v[144:147], v14, s[4:7], s34 offen offset:0
  buffer_load_dwordx4 v[148:151], v14, s[4:7], s34 offen offset:32
  buffer_load_dwordx4 v[152:155], v14, s[4:7], s34 offen offset:64
  buffer_load_dwordx4 v[156:159], v14, s[4:7], s34 offen offset:96
  s_waitcnt vmcnt(0)
  v_mfma_f32_32x32x16_bf16 v[128:143], v[144:147], v[16:19], 0
  v_mfma_f32_32x32x16_bf16 v[128:143], v[148:151], v[20:23], v[128:143]
  v_mfma_f32_32x32x16_bf16 v[128:143], v[152:155], v[24:27], v[128:143]
  v_mfma_f32_32x32x16_bf16 v[128:143], v[156:159], v[28:31], v[128:143]
  buffer_load_dwordx4 v[144:147], v14, s[4:7], s34 offen offset:128
  buffer_load_dwordx4 v[148:151], v14, s[4:7], s34 offen offset:160
  buffer_load_dwordx4 v[152:155], v14, s[4:7], s34 offen offset:192
  buffer_load_dwordx4 v[156:159], v14, s[4:7], s34 offen offset:224
  s_waitcnt vmcnt(0)
  v_mfma_f32_32x32x16_bf16 v[128:143], v[144:147], v[32:35], v[128:143]
  v_mfma_f32_32x32x16_bf16 v[128:143], v[148:151], v[36:39], v[128:143]
  v_mfma_f32_32x32x16_bf16 v[128:143], v[152:155], v[40:43], v[128:143]
  v_mfma_f32_32x32x16_bf16 v[128:143], v[156:159], v[44:47], v[128:143]
  s_nop 11
  v_max3_f32 v14, v128, v129, v130
  v_max3_f32 v14, v14, v131, v132
  v_max3_f32 v14, v14, v133, v134
  v_max3_f32 v14, v14, v135, v136
  v_max3_f32 v14, v14, v137, v138
  v_max3_f32 v14, v14, v139, v140
  v_max3_f32 v14, v14, v141, v142
  v_max_f32 v14, v14, v143
  v_mov_b32 v15, v14
  s_nop 1
  v_permlane32_swap_b32 v14, v15
  v_max_f32 v14, v14, v15
  v_max_f32 v14, v14, v0
  v_sub_f32 v15, v0, v14
  v_exp_f32 v15, v15
  v_mov_b32 v0, v14
  v_mul_f32 v12, v12, v15
  v_mul_f32 v48, v48, v15
  v_mul_f32 v49, v49, v15
  v_mul_f32 v50, v50, v15
  v_mul_f32 v51, v51, v15
  v_mul_f32 v52, v52, v15
  v_mul_f32 v53, v53, v15
  v_mul_f32 v54, v54, v15
  v_mul_f32 v55, v55, v15
  v_mul_f32 v56, v56, v15
  v_mul_f32 v57, v57, v15
  v_mul_f32 v58, v58, v15
  v_mul_f32 v59, v59, v15
  v_mul_f32 v60, v60, v15
  v_mul_f32 v61, v61, v15
  v_mul_f32 v62, v62, v15
  v_mul_f32 v63, v63, v15
  v_mul_f32 v64, v64, v15
  v_mul_f32 v65, v65, v15
  v_mul_f32 v66, v66, v15
  v_mul_f32 v67, v67, v15
  v_mul_f32 v68, v68, v15
  v_mul_f32 v69, v69, v15
  v_mul_f32 v70, v70, v15
  v_mul_f32 v71, v71, v15
  v_mul_f32 v72, v72, v15
  v_mul_f32 v73, v73, v15
  v_mul_f32 v74, v74, v15
  v_mul_f32 v75, v75, v15
  v_mul_f32 v76, v76, v15
  v_mul_f32 v77, v77, v15
  v_mul_f32 v78, v78, v15
  v_mul_f32 v79, v79, v15
  v_mul_f32 v80, v80, v15
  v_mul_f32 v81, v81, v15
  v_mul_f32 v82, v82, v15
  v_mul_f32 v83, v83, v15
  v_mul_f32 v84, v84, v15
  v_mul_f32 v85, v85, v15
  v_mul_f32 v86, v86, v15
  v_mul_f32 v87, v87, v15
  v_mul_f32 v88, v88, v15
  v_mul_f32 v89, v89, v15
  v_mul_f32 v90, v90, v15
  v_mul_f32 v91, v91, v15
  v_mul_f32 v92, v92, v15
  v_mul_f32 v93, v93, v15
  v_mul_f32 v94, v94, v15
  v_mul_f32 v95, v95, v15
  v_mul_f32 v96, v96, v15
  v_mul_f32 v97, v97, v15
  v_mul_f32 v98, v98, v15
  v_mul_f32 v99, v99, v15
  v_mul_f32 v100, v100, v15
  v_mul_f32 v101, v101, v15
  v_mul_f32 v102, v102, v15
  v_mul_f32 v103, v103, v15
  v_mul_f32 v104, v104, v15
  v_mul_f32 v105, v105, v15
  v_mul_f32 v106, v106, v15
  v_mul_f32 v107, v107, v15
  v_mul_f32 v108, v108, v15
  v_mul_f32 v109, v109, v15
  v_mul_f32 v110, v110, v15
  v_mul_f32 v111, v111, v15
  ds_read_b64_tr_b16 v[144:145], v5 offset:0
  ds_read_b64_tr_b16 v[146:147], v5 offset:2048
  ds_read_b64_tr_b16 v[148:149], v5 offset:256
  ds_read_b64_tr_b16 v[150:151], v5 offset:2304
  ds_read_b64_tr_b16 v[152:153], v5 offset:512
  ds_read_b64_tr_b16 v[154:155], v5 offset:2560
  ds_read_b64_tr_b16 v[156:157], v5 offset:768
  ds_read_b64_tr_b16 v[158:159], v5 offset:2816
  v_sub_f32 v128, v128, v0
  v_sub_f32 v129, v129, v0
  v_exp_f32 v128, v128
  v_exp_f32 v129, v129
  v_sub_f32 v130, v130, v0
  v_sub_f32 v131, v131, v0
  v_exp_f32 v130, v130
  v_exp_f32 v131, v131
  v_sub_f32 v132, v132, v0
  v_sub_f32 v133, v133, v0
  v_exp_f32 v132, v132
  v_exp_f32 v133, v133
  v_sub_f32 v134, v134, v0
  v_sub_f32 v135, v135, v0
  v_exp_f32 v134, v134
  v_exp_f32 v135, v135
  v_sub_f32 v136, v136, v0
  v_sub_f32 v137, v137, v0
  v_exp_f32 v136, v136
  v_exp_f32 v137, v137
  v_sub_f32 v138, v138, v0
  v_sub_f32 v139, v139, v0
  v_exp_f32 v138, v138
  v_exp_f32 v139, v139
  v_sub_f32 v140, v140, v0
  v_sub_f32 v141, v141, v0
  v_exp_f32 v140, v140
  v_exp_f32 v141, v141
  v_sub_f32 v142, v142, v0
  v_sub_f32 v143, v143, v0
  v_exp_f32 v142, v142
  v_exp_f32 v143, v143
  v_add_f32 v13, v128, v129
  v_cvt_pk_bf16_f32 v128, v128, v129
  v_add_f32 v14, v130, v131
  v_cvt_pk_bf16_f32 v129, v130, v131
  v_add_f32 v13, v13, v132
  v_add_f32 v14, v14, v133
  v_cvt_pk_bf16_f32 v130, v132, v133
  v_add_f32 v13, v13, v134
  v_add_f32 v14, v14, v135
  v_cvt_pk_bf16_f32 v131, v134, v135
  v_add_f32 v13, v13, v136
  v_add_f32 v14, v14, v137
  v_cvt_pk_bf16_f32 v136, v136, v137
  v_add_f32 v13, v13, v138
  v_add_f32 v14, v14, v139
  v_cvt_pk_bf16_f32 v137, v138, v139
  v_add_f32 v13, v13, v140
  v_add_f32 v14, v14, v141
  v_cvt_pk_bf16_f32 v138, v140, v141
  v_add_f32 v13, v13, v142
  v_add_f32 v14, v14, v143
  v_cvt_pk_bf16_f32 v139, v142, v143
  v_add_f32 v13, v13, v14
  s_nop 0
  s_branch K1_A0T15_CONT
K1_A1:
  v_add_u32 v2, 147456, v10
  s_mov_b32 s24, 0
  s_mov_b32 s38, 32768
  s_waitcnt lgkmcnt(0)
  ds_read_b128 v[144:147], v2
  v_xor_b32 v4, 32, v2
  ds_read_b128 v[148:151], v4
  v_xor_b32 v3, 64, v2
  ds_read_b128 v[152:155], v3
  v_xor_b32 v4, 96, v2
  ds_read_b128 v[156:159], v4
  s_waitcnt lgkmcnt(3)
  v_mfma_f32_32x32x16_bf16 v[112:127], v[144:147], v[16:19], 0
  v_xor_b32 v3, 128, v2
  ds_read_b128 v[144:147], v3
  s_waitcnt lgkmcnt(3)
  v_mfma_f32_32x32x16_bf16 v[112:127], v[148:151], v[20:23], v[112:127]
  v_xor_b32 v4, 160, v2
  ds_read_b128 v[148:151], v4
  s_waitcnt lgkmcnt(3)
  v_mfma_f32_32x32x16_bf16 v[112:127], v[152:155], v[24:27], v[112:127]
  v_xor_b32 v3, 192, v2
  ds_read_b128 v[152:155], v3
  s_waitcnt lgkmcnt(3)
  v_mfma_f32_32x32x16_bf16 v[112:127], v[156:159], v[28:31], v[112:127]
  v_xor_b32 v4, 224, v2
  ds_read_b128 v[156:159], v4
  s_waitcnt lgkmcnt(3)
  v_mfma_f32_32x32x16_bf16 v[112:127], v[144:147], v[32:35], v[112:127]
  s_waitcnt lgkmcnt(2)
  v_mfma_f32_32x32x16_bf16 v[112:127], v[148:151], v[36:39], v[112:127]
  s_waitcnt lgkmcnt(1)
  v_mfma_f32_32x32x16_bf16 v[112:127], v[152:155], v[40:43], v[112:127]
  s_waitcnt lgkmcnt(0)
  v_mfma_f32_32x32x16_bf16 v[112:127], v[156:159], v[44:47], v[112:127]
  v_mov_b32 v160, v10
  ds_read_b128 v[144:147], v160
  v_xor_b32 v4, 32, v160
  ds_read_b128 v[148:151], v4
  v_xor_b32 v3, 64, v160
  ds_read_b128 v[152:155], v3
  v_xor_b32 v4, 96, v160
  ds_read_b128 v[156:159], v4
  s_nop 3
  v_max3_f32 v14, v112, v113, v114
  v_max3_f32 v14, v14, v115, v116
  v_max3_f32 v14, v14, v117, v118
  v_max3_f32 v14, v14, v119, v120
  v_max3_f32 v14, v14, v121, v122
  v_max3_f32 v14, v14, v123, v124
  v_max3_f32 v14, v14, v125, v126
  v_max_f32 v14, v14, v127
  v_mov_b32 v15, v14
  s_nop 1
  v_permlane32_swap_b32 v14, v15
  v_max_f32 v14, v14, v15
  v_mov_b32 v0, v14
  v_sub_f32 v112, v112, v0
  v_sub_f32 v113, v113, v0
  v_exp_f32 v112, v112
  v_exp_f32 v113, v113
  v_sub_f32 v114, v114, v0
  v_sub_f32 v115, v115, v0
  v_exp_f32 v114, v114
  v_exp_f32 v115, v115
  v_sub_f32 v116, v116, v0
  v_sub_f32 v117, v117, v0
  v_exp_f32 v116, v116
  v_exp_f32 v117, v117
  v_sub_f32 v118, v118, v0
  v_sub_f32 v119, v119, v0
  v_exp_f32 v118, v118
  v_exp_f32 v119, v119
  v_add_f32 v13, v112, v113
  v_cvt_pk_bf16_f32 v112, v112, v113
  v_add_f32 v14, v114, v115
  v_cvt_pk_bf16_f32 v113, v114, v115
  v_add_f32 v13, v13, v116
  v_add_f32 v14, v14, v117
  v_cvt_pk_bf16_f32 v114, v116, v117
  v_add_f32 v13, v13, v118
  v_add_f32 v14, v14, v119
  v_cvt_pk_bf16_f32 v115, v118, v119
K1_A1L:
  s_setprio 1
  v_add_u32 v5, s24, v11
  s_waitcnt lgkmcnt(3)
  v_mfma_f32_32x32x16_bf16 v[128:143], v[144:147], v[16:19], 0
  v_xor_b32 v3, 128, v160
  ds_read_b128 v[144:147], v3
  v_sub_f32 v120, v120, v0
  v_sub_f32 v121, v121, v0
  v_exp_f32 v120, v120
  v_exp_f32 v121, v121
  s_waitcnt lgkmcnt(3)
  v_mfma_f32_32x32x16_bf16 v[128:143], v[148:151], v[20:23], v[128:143]
  v_xor_b32 v4, 160, v160
  ds_read_b128 v[148:151], v4
  v_add_f32 v13, v13, v120
  v_add_f32 v14, v14, v121
  v_cvt_pk_bf16_f32 v120, v120, v121
  s_waitcnt lgkmcnt(3)
  v_mfma_f32_32x32x16_bf16 v[128:143], v[152:155], v[24:27], v[128:143]
  v_xor_b32 v3, 192, v160
  ds_read_b128 v[152:155], v3
  v_sub_f32 v122, v122, v0
  v_sub_f32 v123, v123, v0
  v_exp_f32 v122, v122
  v_exp_f32 v123, v123
  s_waitcnt lgkmcnt(3)
  v_mfma_f32_32x32x16_bf16 v[128:143], v[156:159], v[28:31], v[128:143]
  v_xor_b32 v4, 224, v160
  ds_read_b128 v[156:159], v4
  v_add_f32 v13, v13, v122
  v_add_f32 v14, v14, v123
  v_cvt_pk_bf16_f32 v121, v122, v123
  s_waitcnt lgkmcnt(3)
  v_mfma_f32_32x32x16_bf16 v[128:143], v[144:147], v[32:35], v[128:143]
  ds_read_b64_tr_b16 v[144:145], v5 offset:0
  ds_read_b64_tr_b16 v[146:147], v5 offset:2048
  v_sub_f32 v124, v124, v0
  v_sub_f32 v125, v125, v0
  v_exp_f32 v124, v124
  v_exp_f32 v125, v125
  s_waitcnt lgkmcnt(4)
  v_mfma_f32_32x32x16_bf16 v[128:143], v[148:151], v[36:39], v[128:143]
  ds_read_b64_tr_b16 v[148:149], v5 offset:256
  ds_read_b64_tr_b16 v[150:151], v5 offset:2304
  v_add_f32 v13, v13, v124
  v_add_f32 v14, v14, v125
  v_cvt_pk_bf16_f32 v122, v124, v125
  s_waitcnt lgkmcnt(5)
  v_mfma_f32_32x32x16_bf16 v[128:143], v[152:155], v[40:43], v[128:143]
  ds_read_b64_tr_b16 v[152:153], v5 offset:512
  ds_read_b64_tr_b16 v[154:155], v5 offset:2560
  v_sub_f32 v126, v126, v0
  v_sub_f32 v127, v127, v0
  v_exp_f32 v126, v126
  v_exp_f32 v127, v127
  s_waitcnt lgkmcnt(6)
  v_mfma_f32_32x32x16_bf16 v[128:143], v[156:159], v[44:47], v[128:143]
  ds_read_b64_tr_b16 v[156:157], v5 offset:768
  ds_read_b64_tr_b16 v[158:159], v5 offset:2816
  v_add_f32 v13, v13, v126
  v_add_f32 v14, v14, v127
  v_cvt_pk_bf16_f32 v123, v126, v127
  v_add_f32 v13, v13, v14
  v_cmp_nge_f32 vcc, 0x49800000, v13
  s_nop 0
  s_cbranch_vccnz K1_A1L0_SLOW
K1_A1L0_CONT:
  v_add_f32 v12, v12, v13
  s_waitcnt vmcnt(8)
  s_barrier
  v_add_u32 v160, s38, v10
  s_waitcnt lgkmcnt(6)
  v_mfma_f32_32x32x16_bf16 v[48:63], v[144:147], v[112:115], v[48:63]
  ds_read_b64_tr_b16 v[144:145], v5 offset:4096
  ds_read_b64_tr_b16 v[146:147], v5 offset:6144
  s_waitcnt lgkmcnt(6)
  v_mfma_f32_32x32x16_bf16 v[64:79], v[148:151], v[112:115], v[64:79]
  ds_read_b64_tr_b16 v[148:149], v5 offset:4352
  ds_read_b64_tr_b16 v[150:151], v5 offset:6400
  v_sub_f32 v128, v128, v0
  v_sub_f32 v129, v129, v0
  v_exp_f32 v128, v128
  v_exp_f32 v129, v129
  s_and_b32 s74, s26, 15
  s_lshl_b32 s74, s74, 13
  s_add_u32 s74, s74, s46
  s_add_u32 s26, s26, 1
  s_add_u32 s75, s25, s47
  s_add_u32 m0, s75, 0
  s_add_u32 s35, s74, 0
  buffer_load_dwordx4 v6, s[12:15], s35 offen nt lds
  s_waitcnt lgkmcnt(6)
  v_mfma_f32_32x32x16_bf16 v[80:95], v[152:155], v[112:115], v[80:95]
  ds_read_b64_tr_b16 v[152:153], v5 offset:4608
  ds_read_b64_tr_b16 v[154:155], v5 offset:6656
  v_add_f32 v13, v128, v129
  v_cvt_pk_bf16_f32 v128, v128, v129
  s_waitcnt lgkmcnt(6)
  v_mfma_f32_32x32x16_bf16 v[96:111], v[156:159], v[112:115], v[96:111]
  ds_read_b64_tr_b16 v[156:157], v5 offset:4864
  ds_read_b64_tr_b16 v[158:159], v5 offset:6912
  v_sub_f32 v130, v130, v0
  v_sub_f32 v131, v131, v0
  v_exp_f32 v130, v130
  v_exp_f32 v131, v131
  s_add_u32 m0, s75, 1024
  s_add_u32 s35, s74, 1024
  buffer_load_dwordx4 v7, s[12:15], s35 offen nt lds
  s_waitcnt lgkmcnt(6)
  v_mfma_f32_32x32x16_bf16 v[48:63], v[144:147], v[120:123], v[48:63]
  ds_read_b128 v[144:147], v160
  v_add_f32 v14, v130, v131
  v_cvt_pk_bf16_f32 v129, v130, v131
  s_waitcnt lgkmcnt(5)
  v_mfma_f32_32x32x16_bf16 v[64:79], v[148:151], v[120:123], v[64:79]
  v_xor_b32 v4, 32, v160
  ds_read_b128 v[148:151], v4
  v_sub_f32 v132, v132, v0
  v_sub_f32 v133, v133, v0
  v_exp_f32 v132, v132
  v_exp_f32 v133, v133
  s_add_u32 m0, s75, 2048
  s_add_u32 s35, s74, 2048
  buffer_load_dwordx4 v8, s[12:15], s35 offen nt lds
  s_waitcnt lgkmcnt(4)
  v_mfma_f32_32x32x16_bf16 v[80:95], v[152:155], v[120:123], v[80:95]
  v_xor_b32 v3, 64, v160
  ds_read_b128 v[152:155], v3
  v_add_f32 v13, v13, v132
  v_add_f32 v14, v14, v133
  v_cvt_pk_bf16_f32 v130, v132, v133
  s_waitcnt lgkmcnt(3)
  v_mfma_f32_32x32x16_bf16 v[96:111], v[156:159], v[120:123], v[96:111]
  v_xor_b32 v4, 96, v160
  ds_read_b128 v[156:159], v4
  v_sub_f32 v134, v134, v0
  v_sub_f32 v135, v135, v0
  v_exp_f32 v134, v134
  v_exp_f32 v135, v135
  s_add_u32 m0, s75, 3072
  s_add_u32 s35, s74, 3072
  buffer_load_dwordx4 v9, s[12:15], s35 offen nt lds
  v_add_f32 v13, v13, v134
  v_add_f32 v14, v14, v135
  v_cvt_pk_bf16_f32 v131, v134, v135
  s_add_u32 s25, s25, 32768
  s_cmp_eq_u32 s25, 163840
  s_cselect_b32 s25, 0, s25
  s_mov_b32 s24, s38
  s_add_u32 s38, s38, 32768
  s_cmp_eq_u32 s38, 163840
  s_cselect_b32 s38, 0, s38
  s_add_u32 s73, s73, 1
  s_setprio 1
  v_add_u32 v5, s24, v11
  s_waitcnt lgkmcnt(3)
  v_mfma_f32_32x32x16_bf16 v[112:127], v[144:147], v[16:19], 0
  v_xor_b32 v3, 128, v160
  ds_read_b128 v[144:147], v3
  v_sub_f32 v136, v136, v0
  v_sub_f32 v137, v137, v0
  v_exp_f32 v136, v136
  v_exp_f32 v137, v137
  s_waitcnt lgkmcnt(3)
  v_mfma_f32_32x32x16_bf16 v[112:127], v[148:151], v[20:23], v[112:127]
  v_xor_b32 v4, 160, v160
  ds_read_b128 v[148:151], v4
  v_add_f32 v13, v13, v136
  v_add_f32 v14, v14, v137
  v_cvt_pk_bf16_f32 v136, v136, v137
  s_waitcnt lgkmcnt(3)
  v_mfma_f32_32x32x16_bf16 v[112:127], v[152:155], v[24:27], v[112:127]
  v_xor_b32 v3, 192, v160
  ds_read_b128 v[152:155], v3
  v_sub_f32 v138, v138, v0
  v_sub_f32 v139, v139, v0
  v_exp_f32 v138, v138
  v_exp_f32 v139, v139
  s_waitcnt lgkmcnt(3)
  v_mfma_f32_32x32x16_bf16 v[112:127], v[156:159], v[28:31], v[112:127]
  v_xor_b32 v4, 224, v160
  ds_read_b128 v[156:159], v4
  v_add_f32 v13, v13, v138
  v_add_f32 v14, v14, v139
  v_cvt_pk_bf16_f32 v137, v138, v139
  s_waitcnt lgkmcnt(3)
  v_mfma_f32_32x32x16_bf16 v[112:127], v[144:147], v[32:35], v[112:127]
  ds_read_b64_tr_b16 v[144:145], v5 offset:0
  ds_read_b64_tr_b16 v[146:147], v5 offset:2048
  v_sub_f32 v140, v140, v0
  v_sub_f32 v141, v141, v0
  v_exp_f32 v140, v140
  v_exp_f32 v141, v141
  s_waitcnt lgkmcnt(4)
  v_mfma_f32_32x32x16_bf16 v[112:127], v[148:151], v[36:39], v[112:127]
  ds_read_b64_tr_b16 v[148:149], v5 offset:256
  ds_read_b64_tr_b16 v[150:151], v5 offset:2304
  v_add_f32 v13, v13, v140
  v_add_f32 v14, v14, v141
  v_cvt_pk_bf16_f32 v138, v140, v141
  s_waitcnt lgkmcnt(5)
  v_mfma_f32_32x32x16_bf16 v[112:127], v[152:155], v[40:43], v[112:127]
  ds_read_b64_tr_b16 v[152:153], v5 offset:512
  ds_read_b64_tr_b16 v[154:155], v5 offset:2560
  v_sub_f32 v142, v142, v0
  v_sub_f32 v143, v143, v0
  v_exp_f32 v142, v142
  v_exp_f32 v143, v143
  s_waitcnt lgkmcnt(6)
  v_mfma_f32_32x32x16_bf16 v[112:127], v[156:159], v[44:47], v[112:127]
  ds_read_b64_tr_b16 v[156:157], v5 offset:768
  ds_read_b64_tr_b16 v[158:159], v5 offset:2816
  v_add_f32 v13, v13, v142
  v_add_f32 v14, v14, v143
  v_cvt_pk_bf16_f32 v139, v142, v143
  v_add_f32 v13, v13, v14
  v_cmp_nge_f32 vcc, 0x49800000, v13
  s_nop 0
  s_cbranch_vccnz K1_A1L1_SLOW
K1_A1L1_CONT:
  v_add_f32 v12, v12, v13
  s_waitcnt vmcnt(8)
  s_barrier
  v_add_u32 v160, s38, v10
  s_waitcnt lgkmcnt(6)
  v_mfma_f32_32x32x16_bf16 v[48:63], v[144:147], v[128:131], v[48:63]
  ds_read_b64_tr_b16 v[144:145], v5 offset:4096
  ds_read_b64_tr_b16 v[146:147], v5 offset:6144
  s_waitcnt lgkmcnt(6)
  v_mfma_f32_32x32x16_bf16 v[64:79], v[148:151], v[128:131], v[64:79]
  ds_read_b64_tr_b16 v[148:149], v5 offset:4352
  ds_read_b64_tr_b16 v[150:151], v5 offset:6400
  v_sub_f32 v112, v112, v0
  v_sub_f32 v113, v113, v0
  v_exp_f32 v112, v112
  v_exp_f32 v113, v113
  s_and_b32 s74, s26, 15
  s_lshl_b32 s74, s74, 13
  s_add_u32 s74, s74, s46
  s_add_u32 s26, s26, 1
  s_add_u32 s75, s25, s47
  s_add_u32 m0, s75, 0
  s_add_u32 s35, s74, 0
  buffer_load_dwordx4 v6, s[12:15], s35 offen nt lds
  s_waitcnt lgkmcnt(6)
  v_mfma_f32_32x32x16_bf16 v[80:95], v[152:155], v[128:131], v[80:95]
  ds_read_b64_tr_b16 v[152:153], v5 offset:4608
  ds_read_b64_tr_b16 v[154:155], v5 offset:6656
  v_add_f32 v13, v112, v113
  v_cvt_pk_bf16_f32 v112, v112, v113
  s_waitcnt lgkmcnt(6)
  v_mfma_f32_32x32x16_bf16 v[96:111], v[156:159], v[128:131], v[96:111]
  ds_read_b64_tr_b16 v[156:157], v5 offset:4864
  ds_read_b64_tr_b16 v[158:159], v5 offset:6912
  v_sub_f32 v114, v114, v0
  v_sub_f32 v115, v115, v0
  v_exp_f32 v114, v114
  v_exp_f32 v115, v115
  s_add_u32 m0, s75, 1024
  s_add_u32 s35, s74, 1024
  buffer_load_dwordx4 v7, s[12:15], s35 offen nt lds
  s_waitcnt lgkmcnt(6)
  v_mfma_f32_32x32x16_bf16 v[48:63], v[144:147], v[136:139], v[48:63]
  ds_read_b128 v[144:147], v160
  v_add_f32 v14, v114, v115
  v_cvt_pk_bf16_f32 v113, v114, v115
  s_waitcnt lgkmcnt(5)
  v_mfma_f32_32x32x16_bf16 v[64:79], v[148:151], v[136:139], v[64:79]
  v_xor_b32 v4, 32, v160
  ds_read_b128 v[148:151], v4
  v_sub_f32 v116, v116, v0
  v_sub_f32 v117, v117, v0
  v_exp_f32 v116, v116
  v_exp_f32 v117, v117
  s_add_u32 m0, s75, 2048
  s_add_u32 s35, s74, 2048
  buffer_load_dwordx4 v8, s[12:15], s35 offen nt lds
  s_waitcnt lgkmcnt(4)
  v_mfma_f32_32x32x16_bf16 v[80:95], v[152:155], v[136:139], v[80:95]
  v_xor_b32 v3, 64, v160
  ds_read_b128 v[152:155], v3
  v_add_f32 v13, v13, v116
  v_add_f32 v14, v14, v117
  v_cvt_pk_bf16_f32 v114, v116, v117
  s_waitcnt lgkmcnt(3)
  v_mfma_f32_32x32x16_bf16 v[96:111], v[156:159], v[136:139], v[96:111]
  v_xor_b32 v4, 96, v160
  ds_read_b128 v[156:159], v4
  v_sub_f32 v118, v118, v0
  v_sub_f32 v119, v119, v0
  v_exp_f32 v118, v118
  v_exp_f32 v119, v119
  s_add_u32 m0, s75, 3072
  s_add_u32 s35, s74, 3072
  buffer_load_dwordx4 v9, s[12:15], s35 offen nt lds
  v_add_f32 v13, v13, v118
  v_add_f32 v14, v14, v119
  v_cvt_pk_bf16_f32 v115, v118, v119
  s_add_u32 s25, s25, 32768
  s_cmp_eq_u32 s25, 163840
  s_cselect_b32 s25, 0, s25
  s_mov_b32 s24, s38
  s_add_u32 s38, s38, 32768
  s_cmp_eq_u32 s38, 163840
  s_cselect_b32 s38, 0, s38
  s_add_u32 s73, s73, 1
  s_add_u32 s45, s45, 1
  s_cmp_lt_u32 s45, 6
  s_cbranch_scc1 K1_A1L
  s_setprio 1
  v_add_u32 v5, s24, v11
  s_waitcnt lgkmcnt(3)
  v_mfma_f32_32x32x16_bf16 v[128:143], v[144:147], v[16:19], 0
  v_xor_b32 v3, 128, v160
  ds_read_b128 v[144:147], v3
  v_sub_f32 v120, v120, v0
  v_sub_f32 v121, v121, v0
  v_exp_f32 v120, v120
  v_exp_f32 v121, v121
  s_waitcnt lgkmcnt(3)
  v_mfma_f32_32x32x16_bf16 v[128:143], v[148:151], v[20:23], v[128:143]
  v_xor_b32 v4, 160, v160
  ds_read_b128 v[148:151], v4
  v_add_f32 v13, v13, v120
  v_add_f32 v14, v14, v121
  v_cvt_pk_bf16_f32 v120, v120, v121
  s_waitcnt lgkmcnt(3)
  v_mfma_f32_32x32x16_bf16 v[128:143], v[152:155], v[24:27], v[128:143]
  v_xor_b32 v3, 192, v160
  ds_read_b128 v[152:155], v3
  v_sub_f32 v122, v122, v0
  v_sub_f32 v123, v123, v0
  v_exp_f32 v122, v122
  v_exp_f32 v123, v123
  s_waitcnt lgkmcnt(3)
  v_mfma_f32_32x32x16_bf16 v[128:143], v[156:159], v[28:31], v[128:143]
  v_xor_b32 v4, 224, v160
  ds_read_b128 v[156:159], v4
  v_add_f32 v13, v13, v122
  v_add_f32 v14, v14, v123
  v_cvt_pk_bf16_f32 v121, v122, v123
  s_waitcnt lgkmcnt(3)
  v_mfma_f32_32x32x16_bf16 v[128:143], v[144:147], v[32:35], v[128:143]
  ds_read_b64_tr_b16 v[144:145], v5 offset:0
  ds_read_b64_tr_b16 v[146:147], v5 offset:2048
  v_sub_f32 v124, v124, v0
  v_sub_f32 v125, v125, v0
  v_exp_f32 v124, v124
  v_exp_f32 v125, v125
  s_waitcnt lgkmcnt(4)
  v_mfma_f32_32x32x16_bf16 v[128:143], v[148:151], v[36:39], v[128:143]
  ds_read_b64_tr_b16 v[148:149], v5 offset:256
  ds_read_b64_tr_b16 v[150:151], v5 offset:2304
  v_add_f32 v13, v13, v124
  v_add_f32 v14, v14, v125
  v_cvt_pk_bf16_f32 v122, v124, v125
  s_waitcnt lgkmcnt(5)
  v_mfma_f32_32x32x16_bf16 v[128:143], v[152:155], v[40:43], v[128:143]
  ds_read_b64_tr_b16 v[152:153], v5 offset:512
  ds_read_b64_tr_b16 v[154:155], v5 offset:2560
  v_sub_f32 v126, v126, v0
  v_sub_f32 v127, v127, v0
  v_exp_f32 v126, v126
  v_exp_f32 v127, v127
  s_waitcnt lgkmcnt(6)
  v_mfma_f32_32x32x16_bf16 v[128:143], v[156:159], v[44:47], v[128:143]
  ds_read_b64_tr_b16 v[156:157], v5 offset:768
  ds_read_b64_tr_b16 v[158:159], v5 offset:2816
  v_add_f32 v13, v13, v126
  v_add_f32 v14, v14, v127
  v_cvt_pk_bf16_f32 v123, v126, v127
  v_add_f32 v13, v13, v14
  v_cmp_nge_f32 vcc, 0x49800000, v13
  s_nop 0
  s_cbranch_vccnz K1_A1T12_SLOW
K1_A1T12_CONT:
  v_add_f32 v12, v12, v13
  s_waitcnt vmcnt(8)
  s_barrier
  v_add_u32 v160, s38, v10
  s_waitcnt lgkmcnt(6)
  v_mfma_f32_32x32x16_bf16 v[48:63], v[144:147], v[112:115], v[48:63]
  ds_read_b64_tr_b16 v[144:145], v5 offset:4096
  ds_read_b64_tr_b16 v[146:147], v5 offset:6144
  s_waitcnt lgkmcnt(6)
  v_mfma_f32_32x32x16_bf16 v[64:79], v[148:151], v[112:115], v[64:79]
  ds_read_b64_tr_b16 v[148:149], v5 offset:4352
  ds_read_b64_tr_b16 v[150:151], v5 offset:6400
  v_sub_f32 v128, v128, v0
  v_sub_f32 v129, v129, v0
  v_exp_f32 v128, v128
  v_exp_f32 v129, v129
  s_waitcnt lgkmcnt(6)
  v_mfma_f32_32x32x16_bf16 v[80:95], v[152:155], v[112:115], v[80:95]
  ds_read_b64_tr_b16 v[152:153], v5 offset:4608
  ds_read_b64_tr_b16 v[154:155], v5 offset:6656
  v_add_f32 v13, v128, v129
  v_cvt_pk_bf16_f32 v128, v128, v129
  s_waitcnt lgkmcnt(6)
  v_mfma_f32_32x32x16_bf16 v[96:111], v[156:159], v[112:115], v[96:111]
  ds_read_b64_tr_b16 v[156:157], v5 offset:4864
  ds_read_b64_tr_b16 v[158:159], v5 offset:6912
  v_sub_f32 v130, v130, v0
  v_sub_f32 v131, v131, v0
  v_exp_f32 v130, v130
  v_exp_f32 v131, v131
  s_waitcnt lgkmcnt(6)
  v_mfma_f32_32x32x16_bf16 v[48:63], v[144:147], v[120:123], v[48:63]
  ds_read_b128 v[144:147], v160
  v_add_f32 v14, v130, v131
  v_cvt_pk_bf16_f32 v129, v130, v131
  s_waitcnt lgkmcnt(5)
  v_mfma_f32_32x32x16_bf16 v[64:79], v[148:151], v[120:123], v[64:79]
  v_xor_b32 v4, 32, v160
  ds_read_b128 v[148:151], v4
  v_sub_f32 v132, v132, v0
  v_sub_f32 v133, v133, v0
  v_exp_f32 v132, v132
  v_exp_f32 v133, v133
  s_waitcnt lgkmcnt(4)
  v_mfma_f32_32x32x16_bf16 v[80:95], v[152:155], v[120:123], v[80:95]
  v_xor_b32 v3, 64, v160
  ds_read_b128 v[152:155], v3
  v_add_f32 v13, v13, v132
  v_add_f32 v14, v14, v133
  v_cvt_pk_bf16_f32 v130, v132, v133
  s_waitcnt lgkmcnt(3)
  v_mfma_f32_32x32x16_bf16 v[96:111], v[156:159], v[120:123], v[96:111]
  v_xor_b32 v4, 96, v160
  ds_read_b128 v[156:159], v4
  v_sub_f32 v134, v134, v0
  v_sub_f32 v135, v135, v0
  v_exp_f32 v134, v134
  v_exp_f32 v135, v135
  v_add_f32 v13, v13, v134
  v_add_f32 v14, v14, v135
  v_cvt_pk_bf16_f32 v131, v134, v135
  s_mov_b32 s24, s38
  s_add_u32 s38, s38, 32768
  s_cmp_eq_u32 s38, 163840
  s_cselect_b32 s38, 0, s38
  s_add_u32 s73, s73, 1
  s_setprio 1
  v_add_u32 v5, s24, v11
  s_waitcnt lgkmcnt(3)
  v_mfma_f32_32x32x16_bf16 v[112:127], v[144:147], v[16:19], 0
  v_xor_b32 v3, 128, v160
  ds_read_b128 v[144:147], v3
  v_sub_f32 v136, v136, v0
  v_sub_f32 v137, v137, v0
  v_exp_f32 v136, v136
  v_exp_f32 v137, v137
  s_waitcnt lgkmcnt(3)
  v_mfma_f32_32x32x16_bf16 v[112:127], v[148:151], v[20:23], v[112:127]
  v_xor_b32 v4, 160, v160
  ds_read_b128 v[148:151], v4
  v_add_f32 v13, v13, v136
  v_add_f32 v14, v14, v137
  v_cvt_pk_bf16_f32 v136, v136, v137
  s_waitcnt lgkmcnt(3)
  v_mfma_f32_32x32x16_bf16 v[112:127], v[152:155], v[24:27], v[112:127]
  v_xor_b32 v3, 192, v160
  ds_read_b128 v[152:155], v3
  v_sub_f32 v138, v138, v0
  v_sub_f32 v139, v139, v0
  v_exp_f32 v138, v138
  v_exp_f32 v139, v139
  s_waitcnt lgkmcnt(3)
  v_mfma_f32_32x32x16_bf16 v[112:127], v[156:159], v[28:31], v[112:127]
  v_xor_b32 v4, 224, v160
  ds_read_b128 v[156:159], v4
  v_add_f32 v13, v13, v138
  v_add_f32 v14, v14, v139
  v_cvt_pk_bf16_f32 v137, v138, v139
  s_waitcnt lgkmcnt(3)
  v_mfma_f32_32x32x16_bf16 v[112:127], v[144:147], v[32:35], v[112:127]
  ds_read_b64_tr_b16 v[144:145], v5 offset:0
  ds_read_b64_tr_b16 v[146:147], v5 offset:2048
  v_sub_f32 v140, v140, v0
  v_sub_f32 v141, v141, v0
  v_exp_f32 v140, v140
  v_exp_f32 v141, v141
  s_waitcnt lgkmcnt(4)
  v_mfma_f32_32x32x16_bf16 v[112:127], v[148:151], v[36:39], v[112:127]
  ds_read_b64_tr_b16 v[148:149], v5 offset:256
  ds_read_b64_tr_b16 v[150:151], v5 offset:2304
  v_add_f32 v13, v13, v140
  v_add_f32 v14, v14, v141
  v_cvt_pk_bf16_f32 v138, v140, v141
  s_waitcnt lgkmcnt(5)
  v_mfma_f32_32x32x16_bf16 v[112:127], v[152:155], v[40:43], v[112:127]
  ds_read_b64_tr_b16 v[152:153], v5 offset:512
  ds_read_b64_tr_b16 v[154:155], v5 offset:2560
  v_sub_f32 v142, v142, v0
  v_sub_f32 v143, v143, v0
  v_exp_f32 v142, v142
  v_exp_f32 v143, v143
  s_waitcnt lgkmcnt(6)
  v_mfma_f32_32x32x16_bf16 v[112:127], v[156:159], v[44:47], v[112:127]
  ds_read_b64_tr_b16 v[156:157], v5 offset:768
  ds_read_b64_tr_b16 v[158:159], v5 offset:2816
  v_add_f32 v13, v13, v142
  v_add_f32 v14, v14, v143
  v_cvt_pk_bf16_f32 v139, v142, v143
  v_add_f32 v13, v13, v14
  v_cmp_nge_f32 vcc, 0x49800000, v13
  s_nop 0
  s_cbranch_vccnz K1_A1T13_SLOW
K1_A1T13_CONT:
  v_add_f32 v12, v12, v13
  s_waitcnt vmcnt(4)
  s_barrier
  v_add_u32 v160, s38, v10
  s_waitcnt lgkmcnt(6)
  v_mfma_f32_32x32x16_bf16 v[48:63], v[144:147], v[128:131], v[48:63]
  ds_read_b64_tr_b16 v[144:145], v5 offset:4096
  ds_read_b64_tr_b16 v[146:147], v5 offset:6144
  s_waitcnt lgkmcnt(6)
  v_mfma_f32_32x32x16_bf16 v[64:79], v[148:151], v[128:131], v[64:79]
  ds_read_b64_tr_b16 v[148:149], v5 offset:4352
  ds_read_b64_tr_b16 v[150:151], v5 offset:6400
  v_sub_f32 v112, v112, v0
  v_sub_f32 v113, v113, v0
  v_exp_f32 v112, v112
  v_exp_f32 v113, v113
  s_waitcnt lgkmcnt(6)
  v_mfma_f32_32x32x16_bf16 v[80:95], v[152:155], v[128:131], v[80:95]
  ds_read_b64_tr_b16 v[152:153], v5 offset:4608
  ds_read_b64_tr_b16 v[154:155], v5 offset:6656
  v_add_f32 v13, v112, v113
  v_cvt_pk_bf16_f32 v112, v112, v113
  s_waitcnt lgkmcnt(6)
  v_mfma_f32_32x32x16_bf16 v[96:111], v[156:159], v[128:131], v[96:111]
  ds_read_b64_tr_b16 v[156:157], v5 offset:4864
  ds_read_b64_tr_b16 v[158:159], v5 offset:6912
  v_sub_f32 v114, v114, v0
  v_sub_f32 v115, v115, v0
  v_exp_f32 v114, v114
  v_exp_f32 v115, v115
  s_waitcnt lgkmcnt(6)
  v_mfma_f32_32x32x16_bf16 v[48:63], v[144:147], v[136:139], v[48:63]
  ds_read_b128 v[144:147], v160
  v_add_f32 v14, v114, v115
  v_cvt_pk_bf16_f32 v113, v114, v115
  s_waitcnt lgkmcnt(5)
  v_mfma_f32_32x32x16_bf16 v[64:79], v[148:151], v[136:139], v[64:79]
  v_xor_b32 v4, 32, v160
  ds_read_b128 v[148:151], v4
  v_sub_f32 v116, v116, v0
  v_sub_f32 v117, v117, v0
  v_exp_f32 v116, v116
  v_exp_f32 v117, v117
  s_waitcnt lgkmcnt(4)
  v_mfma_f32_32x32x16_bf16 v[80:95], v[152:155], v[136:139], v[80:95]
  v_xor_b32 v3, 64, v160
  ds_read_b128 v[152:155], v3
  v_add_f32 v13, v13, v116
  v_add_f32 v14, v14, v117
  v_cvt_pk_bf16_f32 v114, v116, v117
  s_waitcnt lgkmcnt(3)
  v_mfma_f32_32x32x16_bf16 v[96:111], v[156:159], v[136:139], v[96:111]
  v_xor_b32 v4, 96, v160
  ds_read_b128 v[156:159], v4
  v_sub_f32 v118, v118, v0
  v_sub_f32 v119, v119, v0
  v_exp_f32 v118, v118
  v_exp_f32 v119, v119
  v_add_f32 v13, v13, v118
  v_add_f32 v14, v14, v119
  v_cvt_pk_bf16_f32 v115, v118, v119
  s_mov_b32 s24, s38
  s_add_u32 s38, s38, 32768
  s_cmp_eq_u32 s38, 163840
  s_cselect_b32 s38, 0, s38
  s_add_u32 s73, s73, 1
  s_setprio 1
  v_add_u32 v5, s24, v11
  s_waitcnt lgkmcnt(3)
  v_mfma_f32_32x32x16_bf16 v[128:143], v[144:147], v[16:19], 0
  v_xor_b32 v3, 128, v160
  ds_read_b128 v[144:147], v3
  v_sub_f32 v120, v120, v0
  v_sub_f32 v121, v121, v0
  v_exp_f32 v120, v120
  v_exp_f32 v121, v121
  s_waitcnt lgkmcnt(3)
  v_mfma_f32_32x32x16_bf16 v[128:143], v[148:151], v[20:23], v[128:143]
  v_xor_b32 v4, 160, v160
  ds_read_b128 v[148:151], v4
  v_add_f32 v13, v13, v120
  v_add_f32 v14, v14, v121
  v_cvt_pk_bf16_f32 v120, v120, v121
  s_waitcnt lgkmcnt(3)
  v_mfma_f32_32x32x16_bf16 v[128:143], v[152:155], v[24:27], v[128:143]
  v_xor_b32 v3, 192, v160
  ds_read_b128 v[152:155], v3
  v_sub_f32 v122, v122, v0
  v_sub_f32 v123, v123, v0
  v_exp_f32 v122, v122
  v_exp_f32 v123, v123
  s_waitcnt lgkmcnt(3)
  v_mfma_f32_32x32x16_bf16 v[128:143], v[156:159], v[28:31], v[128:143]
  v_xor_b32 v4, 224, v160
  ds_read_b128 v[156:159], v4
  v_add_f32 v13, v13, v122
  v_add_f32 v14, v14, v123
  v_cvt_pk_bf16_f32 v121, v122, v123
  s_waitcnt lgkmcnt(3)
  v_mfma_f32_32x32x16_bf16 v[128:143], v[144:147], v[32:35], v[128:143]
  ds_read_b64_tr_b16 v[144:145], v5 offset:0
  ds_read_b64_tr_b16 v[146:147], v5 offset:2048
  v_sub_f32 v124, v124, v0
  v_sub_f32 v125, v125, v0
  v_exp_f32 v124, v124
  v_exp_f32 v125, v125
  s_waitcnt lgkmcnt(4)
  v_mfma_f32_32x32x16_bf16 v[128:143], v[148:151], v[36:39], v[128:143]
  ds_read_b64_tr_b16 v[148:149], v5 offset:256
  ds_read_b64_tr_b16 v[150:151], v5 offset:2304
  v_add_f32 v13, v13, v124
  v_add_f32 v14, v14, v125
  v_cvt_pk_bf16_f32 v122, v124, v125
  s_waitcnt lgkmcnt(5)
  v_mfma_f32_32x32x16_bf16 v[128:143], v[152:155], v[40:43], v[128:143]
  ds_read_b64_tr_b16 v[152:153], v5 offset:512
  ds_read_b64_tr_b16 v[154:155], v5 offset:2560
  v_sub_f32 v126, v126, v0
  v_sub_f32 v127, v127, v0
  v_exp_f32 v126, v126
  v_exp_f32 v127, v127
  s_waitcnt lgkmcnt(6)
  v_mfma_f32_32x32x16_bf16 v[128:143], v[156:159], v[44:47], v[128:143]
  ds_read_b64_tr_b16 v[156:157], v5 offset:768
  ds_read_b64_tr_b16 v[158:159], v5 offset:2816
  v_add_f32 v13, v13, v126
  v_add_f32 v14, v14, v127
  v_cvt_pk_bf16_f32 v123, v126, v127
  v_add_f32 v13, v13, v14
  v_cmp_nge_f32 vcc, 0x49800000, v13
  s_nop 0
  s_cbranch_vccnz K1_A1T14_SLOW
K1_A1T14_CONT:
  v_add_f32 v12, v12, v13
  s_waitcnt vmcnt(0)
  s_barrier
  s_waitcnt lgkmcnt(6)
  v_mfma_f32_32x32x16_bf16 v[48:63], v[144:147], v[112:115], v[48:63]
  ds_read_b64_tr_b16 v[144:145], v5 offset:4096
  ds_read_b64_tr_b16 v[146:147], v5 offset:6144
  s_waitcnt lgkmcnt(6)
  v_mfma_f32_32x32x16_bf16 v[64:79], v[148:151], v[112:115], v[64:79]
  ds_read_b64_tr_b16 v[148:149], v5 offset:4352
  ds_read_b64_tr_b16 v[150:151], v5 offset:6400
  v_sub_f32 v128, v128, v0
  v_sub_f32 v129, v129, v0
  v_exp_f32 v128, v128
  v_exp_f32 v129, v129
  s_waitcnt lgkmcnt(6)
  v_mfma_f32_32x32x16_bf16 v[80:95], v[152:155], v[112:115], v[80:95]
  ds_read_b64_tr_b16 v[152:153], v5 offset:4608
  ds_read_b64_tr_b16 v[154:155], v5 offset:6656
  v_add_f32 v13, v128, v129
  v_cvt_pk_bf16_f32 v128, v128, v129
  s_waitcnt lgkmcnt(6)
  v_mfma_f32_32x32x16_bf16 v[96:111], v[156:159], v[112:115], v[96:111]
  ds_read_b64_tr_b16 v[156:157], v5 offset:4864
  ds_read_b64_tr_b16 v[158:159], v5 offset:6912
  v_sub_f32 v130, v130, v0
  v_sub_f32 v131, v131, v0
  v_exp_f32 v130, v130
  v_exp_f32 v131, v131
  s_waitcnt lgkmcnt(6)
  v_mfma_f32_32x32x16_bf16 v[48:63], v[144:147], v[120:123], v[48:63]
  v_add_f32 v14, v130, v131
  v_cvt_pk_bf16_f32 v129, v130, v131
  s_waitcnt lgkmcnt(4)
  v_mfma_f32_32x32x16_bf16 v[64:79], v[148:151], v[120:123], v[64:79]
  v_sub_f32 v132, v132, v0
  v_sub_f32 v133, v133, v0
  v_exp_f32 v132, v132
  v_exp_f32 v133, v133
  s_waitcnt lgkmcnt(2)
  v_mfma_f32_32x32x16_bf16 v[80:95], v[152:155], v[120:123], v[80:95]
  v_add_f32 v13, v13, v132
  v_add_f32 v14, v14, v133
  v_cvt_pk_bf16_f32 v130, v132, v133
  s_waitcnt lgkmcnt(0)
  v_mfma_f32_32x32x16_bf16 v[96:111], v[156:159], v[120:123], v[96:111]
  v_sub_f32 v134, v134, v0
  v_sub_f32 v135, v135, v0
  v_exp_f32 v134, v134
  v_exp_f32 v135, v135
  v_add_f32 v13, v13, v134
  v_add_f32 v14, v14, v135
  v_cvt_pk_bf16_f32 v131, v134, v135
  s_mov_b32 s24, s38
  s_add_u32 s38, s38, 32768
  s_cmp_eq_u32 s38, 163840
  s_cselect_b32 s38, 0, s38
  s_add_u32 s73, s73, 1
  s_setprio 1
  v_add_u32 v5, s24, v11
  v_sub_f32 v136, v136, v0
  v_sub_f32 v137, v137, v0
  v_exp_f32 v136, v136
  v_exp_f32 v137, v137
  v_add_f32 v13, v13, v136
  v_add_f32 v14, v14, v137
  v_cvt_pk_bf16_f32 v136, v136, v137
  v_sub_f32 v138, v138, v0
  v_sub_f32 v139, v139, v0
  v_exp_f32 v138, v138
  v_exp_f32 v139, v139
  v_add_f32 v13, v13, v138
  v_add_f32 v14, v14, v139
  v_cvt_pk_bf16_f32 v137, v138, v139
  ds_read_b64_tr_b16 v[144:145], v5 offset:0
  ds_read_b64_tr_b16 v[146:147], v5 offset:2048
  v_sub_f32 v140, v140, v0
  v_sub_f32 v141, v141, v0
  v_exp_f32 v140, v140
  v_exp_f32 v141, v141
  ds_read_b64_tr_b16 v[148:149], v5 offset:256
  ds_read_b64_tr_b16 v[150:151], v5 offset:2304
  v_add_f32 v13, v13, v140
  v_add_f32 v14, v14, v141
  v_cvt_pk_bf16_f32 v138, v140, v141
  ds_read_b64_tr_b16 v[152:153], v5 offset:512
  ds_read_b64_tr_b16 v[154:155], v5 offset:2560
  v_sub_f32 v142, v142, v0
  v_sub_f32 v143, v143, v0
  v_exp_f32 v142, v142
  v_exp_f32 v143, v143
  ds_read_b64_tr_b16 v[156:157], v5 offset:768
  ds_read_b64_tr_b16 v[158:159], v5 offset:2816
  v_add_f32 v13, v13, v142
  v_add_f32 v14, v14, v143
  v_cvt_pk_bf16_f32 v139, v142, v143
  v_add_f32 v13, v13, v14
  v_cmp_nge_f32 vcc, 0x49800000, v13
  s_nop 0
  s_cbranch_vccnz K1_A1T15_SLOW
K1_A1T15_CONT:
  v_add_f32 v12, v12, v13
  s_waitcnt vmcnt(0)
  s_barrier
  s_waitcnt lgkmcnt(6)
  v_mfma_f32_32x32x16_bf16 v[48:63], v[144:147], v[128:131], v[48:63]
  ds_read_b64_tr_b16 v[144:145], v5 offset:4096
  ds_read_b64_tr_b16 v[146:147], v5 offset:6144
  s_waitcnt lgkmcnt(6)
  v_mfma_f32_32x32x16_bf16 v[64:79], v[148:151], v[128:131], v[64:79]
  ds_read_b64_tr_b16 v[148:149], v5 offset:4352
  ds_read_b64_tr_b16 v[150:151], v5 offset:6400
  s_waitcnt lgkmcnt(6)
  v_mfma_f32_32x32x16_bf16 v[80:95], v[152:155], v[128:131], v[80:95]
  ds_read_b64_tr_b16 v[152:153], v5 offset:4608
  ds_read_b64_tr_b16 v[154:155], v5 offset:6656
  s_waitcnt lgkmcnt(6)
  v_mfma_f32_32x32x16_bf16 v[96:111], v[156:159], v[128:131], v[96:111]
  ds_read_b64_tr_b16 v[156:157], v5 offset:4864
  ds_read_b64_tr_b16 v[158:159], v5 offset:6912
  s_waitcnt lgkmcnt(6)
  v_mfma_f32_32x32x16_bf16 v[48:63], v[144:147], v[136:139], v[48:63]
  s_waitcnt lgkmcnt(4)
  v_mfma_f32_32x32x16_bf16 v[64:79], v[148:151], v[136:139], v[64:79]
  s_waitcnt lgkmcnt(2)
  v_mfma_f32_32x32x16_bf16 v[80:95], v[152:155], v[136:139], v[80:95]
  s_waitcnt lgkmcnt(0)
  v_mfma_f32_32x32x16_bf16 v[96:111], v[156:159], v[136:139], v[96:111]
  s_mov_b32 s24, s38
  s_add_u32 s38, s38, 32768
  s_cmp_eq_u32 s38, 163840
  s_cselect_b32 s38, 0, s38
  s_add_u32 s73, s73, 1
  s_branch K1_EPI
K1_A1L0_SLOW:
  s_waitcnt lgkmcnt(0)
  v_and_b32 v14, 31, v1
  v_lshlrev_b32 v14, 8, v14
  v_lshrrev_b32 v15, 5, v1
  v_lshl_add_u32 v14, v15, 4, v14
  s_and_b32 s34, s73, 15
  s_lshl_b32 s34, s34, 13
  s_lshl_b32 s35, s32, 17
  s_add_u32 s34, s34, s35
  buffer_load_dwordx4 v[144:147], v14, s[4:7], s34 offen offset:0
  buffer_load_dwordx4 v[148:151], v14, s[4:7], s34 offen offset:32
  buffer_load_dwordx4 v[152:155], v14, s[4:7], s34 offen offset:64
  buffer_load_dwordx4 v[156:159], v14, s[4:7], s34 offen offset:96
  s_waitcnt vmcnt(0)
  v_mfma_f32_32x32x16_bf16 v[112:127], v[144:147], v[16:19], 0
  v_mfma_f32_32x32x16_bf16 v[112:127], v[148:151], v[20:23], v[112:127]
  v_mfma_f32_32x32x16_bf16 v[112:127], v[152:155], v[24:27], v[112:127]
  v_mfma_f32_32x32x16_bf16 v[112:127], v[156:159], v[28:31], v[112:127]
  buffer_load_dwordx4 v[144:147], v14, s[4:7], s34 offen offset:128
  buffer_load_dwordx4 v[148:151], v14, s[4:7], s34 offen offset:160
  buffer_load_dwordx4 v[152:155], v14, s[4:7], s34 offen offset:192
  buffer_load_dwordx4 v[156:159], v14, s[4:7], s34 offen offset:224
  s_waitcnt vmcnt(0)
  v_mfma_f32_32x32x16_bf16 v[112:127], v[144:147], v[32:35], v[112:127]
  v_mfma_f32_32x32x16_bf16 v[112:127], v[148:151], v[36:39], v[112:127]
  v_mfma_f32_32x32x16_bf16 v[112:127], v[152:155], v[40:43], v[112:127]
  v_mfma_f32_32x32x16_bf16 v[112:127], v[156:159], v[44:47], v[112:127]
  s_nop 11
  v_max3_f32 v14, v112, v113, v114
  v_max3_f32 v14, v14, v115, v116
  v_max3_f32 v14, v14, v117, v118
  v_max3_f32 v14, v14, v119, v120
  v_max3_f32 v14, v14, v121, v122
  v_max3_f32 v14, v14, v123, v124
  v_max3_f32 v14, v14, v125, v126
  v_max_f32 v14, v14, v127
  v_mov_b32 v15, v14
  s_nop 1
  v_permlane32_swap_b32 v14, v15
  v_max_f32 v14, v14, v15
  v_max_f32 v14, v14, v0
  v_sub_f32 v15, v0, v14
  v_exp_f32 v15, v15
  v_mov_b32 v0, v14
  v_mul_f32 v12, v12, v15
  v_mul_f32 v48, v48, v15
  v_mul_f32 v49, v49, v15
  v_mul_f32 v50, v50, v15
  v_mul_f32 v51, v51, v15
  v_mul_f32 v52, v52, v15
  v_mul_f32 v53, v53, v15
  v_mul_f32 v54, v54, v15
  v_mul_f32 v55, v55, v15
  v_mul_f32 v56, v56, v15
  v_mul_f32 v57, v57, v15
  v_mul_f32 v58, v58, v15
  v_mul_f32 v59, v59, v15
  v_mul_f32 v60, v60, v15
  v_mul_f32 v61, v61, v15
  v_mul_f32 v62, v62, v15
  v_mul_f32 v63, v63, v15
  v_mul_f32 v64, v64, v15
  v_mul_f32 v65, v65, v15
  v_mul_f32 v66, v66, v15
  v_mul_f32 v67, v67, v15
  v_mul_f32 v68, v68, v15
  v_mul_f32 v69, v69, v15
  v_mul_f32 v70, v70, v15
  v_mul_f32 v71, v71, v15
  v_mul_f32 v72, v72, v15
  v_mul_f32 v73, v73, v15
  v_mul_f32 v74, v74, v15
  v_mul_f32 v75, v75, v15
  v_mul_f32 v76, v76, v15
  v_mul_f32 v77, v77, v15
  v_mul_f32 v78, v78, v15
  v_mul_f32 v79, v79, v15
  v_mul_f32 v80, v80, v15
  v_mul_f32 v81, v81, v15
  v_mul_f32 v82, v82, v15
  v_mul_f32 v83, v83, v15
  v_mul_f32 v84, v84, v15
  v_mul_f32 v85, v85, v15
  v_mul_f32 v86, v86, v15
  v_mul_f32 v87, v87, v15
  v_mul_f32 v88, v88, v15
  v_mul_f32 v89, v89, v15
  v_mul_f32 v90, v90, v15
  v_mul_f32 v91, v91, v15
  v_mul_f32 v92, v92, v15
  v_mul_f32 v93, v93, v15
  v_mul_f32 v94, v94, v15
  v_mul_f32 v95, v95, v15
  v_mul_f32 v96, v96, v15
  v_mul_f32 v97, v97, v15
  v_mul_f32 v98, v98, v15
  v_mul_f32 v99, v99, v15
  v_mul_f32 v100, v100, v15
  v_mul_f32 v101, v101, v15
  v_mul_f32 v102, v102, v15
  v_mul_f32 v103, v103, v15
  v_mul_f32 v104, v104, v15
  v_mul_f32 v105, v105, v15
  v_mul_f32 v106, v106, v15
  v_mul_f32 v107, v107, v15
  v_mul_f32 v108, v108, v15
  v_mul_f32 v109, v109, v15
  v_mul_f32 v110, v110, v15
  v_mul_f32 v111, v111, v15
  ds_read_b64_tr_b16 v[144:145], v5 offset:0
  ds_read_b64_tr_b16 v[146:147], v5 offset:2048
  ds_read_b64_tr_b16 v[148:149], v5 offset:256
  ds_read_b64_tr_b16 v[150:151], v5 offset:2304
  ds_read_b64_tr_b16 v[152:153], v5 offset:512
  ds_read_b64_tr_b16 v[154:155], v5 offset:2560
  ds_read_b64_tr_b16 v[156:157], v5 offset:768
  ds_read_b64_tr_b16 v[158:159], v5 offset:2816
  v_sub_f32 v112, v112, v0
  v_sub_f32 v113, v113, v0
  v_exp_f32 v112, v112
  v_exp_f32 v113, v113
  v_sub_f32 v114, v114, v0
  v_sub_f32 v115, v115, v0
  v_exp_f32 v114, v114
  v_exp_f32 v115, v115
  v_sub_f32 v116, v116, v0
  v_sub_f32 v117, v117, v0
  v_exp_f32 v116, v116
  v_exp_f32 v117, v117
  v_sub_f32 v118, v118, v0
  v_sub_f32 v119, v119, v0
  v_exp_f32 v118, v118
  v_exp_f32 v119, v119
  v_sub_f32 v120, v120, v0
  v_sub_f32 v121, v121, v0
  v_exp_f32 v120, v120
  v_exp_f32 v121, v121
  v_sub_f32 v122, v122, v0
  v_sub_f32 v123, v123, v0
  v_exp_f32 v122, v122
  v_exp_f32 v123, v123
  v_sub_f32 v124, v124, v0
  v_sub_f32 v125, v125, v0
  v_exp_f32 v124, v124
  v_exp_f32 v125, v125
  v_sub_f32 v126, v126, v0
  v_sub_f32 v127, v127, v0
  v_exp_f32 v126, v126
  v_exp_f32 v127, v127
  v_add_f32 v13, v112, v113
  v_cvt_pk_bf16_f32 v112, v112, v113
  v_add_f32 v14, v114, v115
  v_cvt_pk_bf16_f32 v113, v114, v115
  v_add_f32 v13, v13, v116
  v_add_f32 v14, v14, v117
  v_cvt_pk_bf16_f32 v114, v116, v117
  v_add_f32 v13, v13, v118
  v_add_f32 v14, v14, v119
  v_cvt_pk_bf16_f32 v115, v118, v119
  v_add_f32 v13, v13, v120
  v_add_f32 v14, v14, v121
  v_cvt_pk_bf16_f32 v120, v120, v121
  v_add_f32 v13, v13, v122
  v_add_f32 v14, v14, v123
  v_cvt_pk_bf16_f32 v121, v122, v123
  v_add_f32 v13, v13, v124
  v_add_f32 v14, v14, v125
  v_cvt_pk_bf16_f32 v122, v124, v125
  v_add_f32 v13, v13, v126
  v_add_f32 v14, v14, v127
  v_cvt_pk_bf16_f32 v123, v126, v127
  v_add_f32 v13, v13, v14
  s_nop 0
  s_branch K1_A1L0_CONT
K1_A1L1_SLOW:
  s_waitcnt lgkmcnt(0)
  v_and_b32 v14, 31, v1
  v_lshlrev_b32 v14, 8, v14
  v_lshrrev_b32 v15, 5, v1
  v_lshl_add_u32 v14, v15, 4, v14
  s_and_b32 s34, s73, 15
  s_lshl_b32 s34, s34, 13
  s_lshl_b32 s35, s32, 17
  s_add_u32 s34, s34, s35
  buffer_load_dwordx4 v[144:147], v14, s[4:7], s34 offen offset:0
  buffer_load_dwordx4 v[148:151], v14, s[4:7], s34 offen offset:32
  buffer_load_dwordx4 v[152:155], v14, s[4:7], s34 offen offset:64
  buffer_load_dwordx4 v[156:159], v14, s[4:7], s34 offen offset:96
  s_waitcnt vmcnt(0)
  v_mfma_f32_32x32x16_bf16 v[128:143], v[144:147], v[16:19], 0
  v_mfma_f32_32x32x16_bf16 v[128:143], v[148:151], v[20:23], v[128:143]
  v_mfma_f32_32x32x16_bf16 v[128:143], v[152:155], v[24:27], v[128:143]
  v_mfma_f32_32x32x16_bf16 v[128:143], v[156:159], v[28:31], v[128:143]
  buffer_load_dwordx4 v[144:147], v14, s[4:7], s34 offen offset:128
  buffer_load_dwordx4 v[148:151], v14, s[4:7], s34 offen offset:160
  buffer_load_dwordx4 v[152:155], v14, s[4:7], s34 offen offset:192
  buffer_load_dwordx4 v[156:159], v14, s[4:7], s34 offen offset:224
  s_waitcnt vmcnt(0)
  v_mfma_f32_32x32x16_bf16 v[128:143], v[144:147], v[32:35], v[128:143]
  v_mfma_f32_32x32x16_bf16 v[128:143], v[148:151], v[36:39], v[128:143]
  v_mfma_f32_32x32x16_bf16 v[128:143], v[152:155], v[40:43], v[128:143]
  v_mfma_f32_32x32x16_bf16 v[128:143], v[156:159], v[44:47], v[128:143]
  s_nop 11
  v_max3_f32 v14, v128, v129, v130
  v_max3_f32 v14, v14, v131, v132
  v_max3_f32 v14, v14, v133, v134
  v_max3_f32 v14, v14, v135, v136
  v_max3_f32 v14, v14, v137, v138
  v_max3_f32 v14, v14, v139, v140
  v_max3_f32 v14, v14, v141, v142
  v_max_f32 v14, v14, v143
  v_mov_b32 v15, v14
  s_nop 1
  v_permlane32_swap_b32 v14, v15
  v_max_f32 v14, v14, v15
  v_max_f32 v14, v14, v0
  v_sub_f32 v15, v0, v14
  v_exp_f32 v15, v15
  v_mov_b32 v0, v14
  v_mul_f32 v12, v12, v15
  v_mul_f32 v48, v48, v15
  v_mul_f32 v49, v49, v15
  v_mul_f32 v50, v50, v15
  v_mul_f32 v51, v51, v15
  v_mul_f32 v52, v52, v15
  v_mul_f32 v53, v53, v15
  v_mul_f32 v54, v54, v15
  v_mul_f32 v55, v55, v15
  v_mul_f32 v56, v56, v15
  v_mul_f32 v57, v57, v15
  v_mul_f32 v58, v58, v15
  v_mul_f32 v59, v59, v15
  v_mul_f32 v60, v60, v15
  v_mul_f32 v61, v61, v15
  v_mul_f32 v62, v62, v15
  v_mul_f32 v63, v63, v15
  v_mul_f32 v64, v64, v15
  v_mul_f32 v65, v65, v15
  v_mul_f32 v66, v66, v15
  v_mul_f32 v67, v67, v15
  v_mul_f32 v68, v68, v15
  v_mul_f32 v69, v69, v15
  v_mul_f32 v70, v70, v15
  v_mul_f32 v71, v71, v15
  v_mul_f32 v72, v72, v15
  v_mul_f32 v73, v73, v15
  v_mul_f32 v74, v74, v15
  v_mul_f32 v75, v75, v15
  v_mul_f32 v76, v76, v15
  v_mul_f32 v77, v77, v15
  v_mul_f32 v78, v78, v15
  v_mul_f32 v79, v79, v15
  v_mul_f32 v80, v80, v15
  v_mul_f32 v81, v81, v15
  v_mul_f32 v82, v82, v15
  v_mul_f32 v83, v83, v15
  v_mul_f32 v84, v84, v15
  v_mul_f32 v85, v85, v15
  v_mul_f32 v86, v86, v15
  v_mul_f32 v87, v87, v15
  v_mul_f32 v88, v88, v15
  v_mul_f32 v89, v89, v15
  v_mul_f32 v90, v90, v15
  v_mul_f32 v91, v91, v15
  v_mul_f32 v92, v92, v15
  v_mul_f32 v93, v93, v15
  v_mul_f32 v94, v94, v15
  v_mul_f32 v95, v95, v15
  v_mul_f32 v96, v96, v15
  v_mul_f32 v97, v97, v15
  v_mul_f32 v98, v98, v15
  v_mul_f32 v99, v99, v15
  v_mul_f32 v100, v100, v15
  v_mul_f32 v101, v101, v15
  v_mul_f32 v102, v102, v15
  v_mul_f32 v103, v103, v15
  v_mul_f32 v104, v104, v15
  v_mul_f32 v105, v105, v15
  v_mul_f32 v106, v106, v15
  v_mul_f32 v107, v107, v15
  v_mul_f32 v108, v108, v15
  v_mul_f32 v109, v109, v15
  v_mul_f32 v110, v110, v15
  v_mul_f32 v111, v111, v15
  ds_read_b64_tr_b16 v[144:145], v5 offset:0
  ds_read_b64_tr_b16 v[146:147], v5 offset:2048
  ds_read_b64_tr_b16 v[148:149], v5 offset:256
  ds_read_b64_tr_b16 v[150:151], v5 offset:2304
  ds_read_b64_tr_b16 v[152:153], v5 offset:512
  ds_read_b64_tr_b16 v[154:155], v5 offset:2560
  ds_read_b64_tr_b16 v[156:157], v5 offset:768
  ds_read_b64_tr_b16 v[158:159], v5 offset:2816
  v_sub_f32 v128, v128, v0
  v_sub_f32 v129, v129, v0
  v_exp_f32 v128, v128
  v_exp_f32 v129, v129
  v_sub_f32 v130, v130, v0
  v_sub_f32 v131, v131, v0
  v_exp_f32 v130, v130
  v_exp_f32 v131, v131
  v_sub_f32 v132, v132, v0
  v_sub_f32 v133, v133, v0
  v_exp_f32 v132, v132
  v_exp_f32 v133, v133
  v_sub_f32 v134, v134, v0
  v_sub_f32 v135, v135, v0
  v_exp_f32 v134, v134
  v_exp_f32 v135, v135
  v_sub_f32 v136, v136, v0
  v_sub_f32 v137, v137, v0
  v_exp_f32 v136, v136
  v_exp_f32 v137, v137
  v_sub_f32 v138, v138, v0
  v_sub_f32 v139, v139, v0
  v_exp_f32 v138, v138
  v_exp_f32 v139, v139
  v_sub_f32 v140, v140, v0
  v_sub_f32 v141, v141, v0
  v_exp_f32 v140, v140
  v_exp_f32 v141, v141
  v_sub_f32 v142, v142, v0
  v_sub_f32 v143, v143, v0
  v_exp_f32 v142, v142
  v_exp_f32 v143, v143
  v_add_f32 v13, v128, v129
  v_cvt_pk_bf16_f32 v128, v128, v129
  v_add_f32 v14, v130, v131
  v_cvt_pk_bf16_f32 v129, v130, v131
  v_add_f32 v13, v13, v132
  v_add_f32 v14, v14, v133
  v_cvt_pk_bf16_f32 v130, v132, v133
  v_add_f32 v13, v13, v134
  v_add_f32 v14, v14, v135
  v_cvt_pk_bf16_f32 v131, v134, v135
  v_add_f32 v13, v13, v136
  v_add_f32 v14, v14, v137
  v_cvt_pk_bf16_f32 v136, v136, v137
  v_add_f32 v13, v13, v138
  v_add_f32 v14, v14, v139
  v_cvt_pk_bf16_f32 v137, v138, v139
  v_add_f32 v13, v13, v140
  v_add_f32 v14, v14, v141
  v_cvt_pk_bf16_f32 v138, v140, v141
  v_add_f32 v13, v13, v142
  v_add_f32 v14, v14, v143
  v_cvt_pk_bf16_f32 v139, v142, v143
  v_add_f32 v13, v13, v14
  s_nop 0
  s_branch K1_A1L1_CONT
K1_A1T12_SLOW:
  s_waitcnt lgkmcnt(0)
  v_and_b32 v14, 31, v1
  v_lshlrev_b32 v14, 8, v14
  v_lshrrev_b32 v15, 5, v1
  v_lshl_add_u32 v14, v15, 4, v14
  s_and_b32 s34, s73, 15
  s_lshl_b32 s34, s34, 13
  s_lshl_b32 s35, s32, 17
  s_add_u32 s34, s34, s35
  buffer_load_dwordx4 v[144:147], v14, s[4:7], s34 offen offset:0
  buffer_load_dwordx4 v[148:151], v14, s[4:7], s34 offen offset:32
  buffer_load_dwordx4 v[152:155], v14, s[4:7], s34 offen offset:64
  buffer_load_dwordx4 v[156:159], v14, s[4:7], s34 offen offset:96
  s_waitcnt vmcnt(0)
  v_mfma_f32_32x32x16_bf16 v[112:127], v[144:147], v[16:19], 0
  v_mfma_f32_32x32x16_bf16 v[112:127], v[148:151], v[20:23], v[112:127]
  v_mfma_f32_32x32x16_bf16 v[112:127], v[152:155], v[24:27], v[112:127]
  v_mfma_f32_32x32x16_bf16 v[112:127], v[156:159], v[28:31], v[112:127]
  buffer_load_dwordx4 v[144:147], v14, s[4:7], s34 offen offset:128
  buffer_load_dwordx4 v[148:151], v14, s[4:7], s34 offen offset:160
  buffer_load_dwordx4 v[152:155], v14, s[4:7], s34 offen offset:192
  buffer_load_dwordx4 v[156:159], v14, s[4:7], s34 offen offset:224
  s_waitcnt vmcnt(0)
  v_mfma_f32_32x32x16_bf16 v[112:127], v[144:147], v[32:35], v[112:127]
  v_mfma_f32_32x32x16_bf16 v[112:127], v[148:151], v[36:39], v[112:127]
  v_mfma_f32_32x32x16_bf16 v[112:127], v[152:155], v[40:43], v[112:127]
  v_mfma_f32_32x32x16_bf16 v[112:127], v[156:159], v[44:47], v[112:127]
  s_nop 11
  v_max3_f32 v14, v112, v113, v114
  v_max3_f32 v14, v14, v115, v116
  v_max3_f32 v14, v14, v117, v118
  v_max3_f32 v14, v14, v119, v120
  v_max3_f32 v14, v14, v121, v122
  v_max3_f32 v14, v14, v123, v124
  v_max3_f32 v14, v14, v125, v126
  v_max_f32 v14, v14, v127
  v_mov_b32 v15, v14
  s_nop 1
  v_permlane32_swap_b32 v14, v15
  v_max_f32 v14, v14, v15
  v_max_f32 v14, v14, v0
  v_sub_f32 v15, v0, v14
  v_exp_f32 v15, v15
  v_mov_b32 v0, v14
  v_mul_f32 v12, v12, v15
  v_mul_f32 v48, v48, v15
  v_mul_f32 v49, v49, v15
  v_mul_f32 v50, v50, v15
  v_mul_f32 v51, v51, v15
  v_mul_f32 v52, v52, v15
  v_mul_f32 v53, v53, v15
  v_mul_f32 v54, v54, v15
  v_mul_f32 v55, v55, v15
  v_mul_f32 v56, v56, v15
  v_mul_f32 v57, v57, v15
  v_mul_f32 v58, v58, v15
  v_mul_f32 v59, v59, v15
  v_mul_f32 v60, v60, v15
  v_mul_f32 v61, v61, v15
  v_mul_f32 v62, v62, v15
  v_mul_f32 v63, v63, v15
  v_mul_f32 v64, v64, v15
  v_mul_f32 v65, v65, v15
  v_mul_f32 v66, v66, v15
  v_mul_f32 v67, v67, v15
  v_mul_f32 v68, v68, v15
  v_mul_f32 v69, v69, v15
  v_mul_f32 v70, v70, v15
  v_mul_f32 v71, v71, v15
  v_mul_f32 v72, v72, v15
  v_mul_f32 v73, v73, v15
  v_mul_f32 v74, v74, v15
  v_mul_f32 v75, v75, v15
  v_mul_f32 v76, v76, v15
  v_mul_f32 v77, v77, v15
  v_mul_f32 v78, v78, v15
  v_mul_f32 v79, v79, v15
  v_mul_f32 v80, v80, v15
  v_mul_f32 v81, v81, v15
  v_mul_f32 v82, v82, v15
  v_mul_f32 v83, v83, v15
  v_mul_f32 v84, v84, v15
  v_mul_f32 v85, v85, v15
  v_mul_f32 v86, v86, v15
  v_mul_f32 v87, v87, v15
  v_mul_f32 v88, v88, v15
  v_mul_f32 v89, v89, v15
  v_mul_f32 v90, v90, v15
  v_mul_f32 v91, v91, v15
  v_mul_f32 v92, v92, v15
  v_mul_f32 v93, v93, v15
  v_mul_f32 v94, v94, v15
  v_mul_f32 v95, v95, v15
  v_mul_f32 v96, v96, v15
  v_mul_f32 v97, v97, v15
  v_mul_f32 v98, v98, v15
  v_mul_f32 v99, v99, v15
  v_mul_f32 v100, v100, v15
  v_mul_f32 v101, v101, v15
  v_mul_f32 v102, v102, v15
  v_mul_f32 v103, v103, v15
  v_mul_f32 v104, v104, v15
  v_mul_f32 v105, v105, v15
  v_mul_f32 v106, v106, v15
  v_mul_f32 v107, v107, v15
  v_mul_f32 v108, v108, v15
  v_mul_f32 v109, v109, v15
  v_mul_f32 v110, v110, v15
  v_mul_f32 v111, v111, v15
  ds_read_b64_tr_b16 v[144:145], v5 offset:0
  ds_read_b64_tr_b16 v[146:147], v5 offset:2048
  ds_read_b64_tr_b16 v[148:149], v5 offset:256
  ds_read_b64_tr_b16 v[150:151], v5 offset:2304
  ds_read_b64_tr_b16 v[152:153], v5 offset:512
  ds_read_b64_tr_b16 v[154:155], v5 offset:2560
  ds_read_b64_tr_b16 v[156:157], v5 offset:768
  ds_read_b64_tr_b16 v[158:159], v5 offset:2816
  v_sub_f32 v112, v112, v0
  v_sub_f32 v113, v113, v0
  v_exp_f32 v112, v112
  v_exp_f32 v113, v113
  v_sub_f32 v114, v114, v0
  v_sub_f32 v115, v115, v0
  v_exp_f32 v114, v114
  v_exp_f32 v115, v115
  v_sub_f32 v116, v116, v0
  v_sub_f32 v117, v117, v0
  v_exp_f32 v116, v116
  v_exp_f32 v117, v117
  v_sub_f32 v118, v118, v0
  v_sub_f32 v119, v119, v0
  v_exp_f32 v118, v118
  v_exp_f32 v119, v119
  v_sub_f32 v120, v120, v0
  v_sub_f32 v121, v121, v0
  v_exp_f32 v120, v120
  v_exp_f32 v121, v121
  v_sub_f32 v122, v122, v0
  v_sub_f32 v123, v123, v0
  v_exp_f32 v122, v122
  v_exp_f32 v123, v123
  v_sub_f32 v124, v124, v0
  v_sub_f32 v125, v125, v0
  v_exp_f32 v124, v124
  v_exp_f32 v125, v125
  v_sub_f32 v126, v126, v0
  v_sub_f32 v127, v127, v0
  v_exp_f32 v126, v126
  v_exp_f32 v127, v127
  v_add_f32 v13, v112, v113
  v_cvt_pk_bf16_f32 v112, v112, v113
  v_add_f32 v14, v114, v115
  v_cvt_pk_bf16_f32 v113, v114, v115
  v_add_f32 v13, v13, v116
  v_add_f32 v14, v14, v117
  v_cvt_pk_bf16_f32 v114, v116, v117
  v_add_f32 v13, v13, v118
  v_add_f32 v14, v14, v119
  v_cvt_pk_bf16_f32 v115, v118, v119
  v_add_f32 v13, v13, v120
  v_add_f32 v14, v14, v121
  v_cvt_pk_bf16_f32 v120, v120, v121
  v_add_f32 v13, v13, v122
  v_add_f32 v14, v14, v123
  v_cvt_pk_bf16_f32 v121, v122, v123
  v_add_f32 v13, v13, v124
  v_add_f32 v14, v14, v125
  v_cvt_pk_bf16_f32 v122, v124, v125
  v_add_f32 v13, v13, v126
  v_add_f32 v14, v14, v127
  v_cvt_pk_bf16_f32 v123, v126, v127
  v_add_f32 v13, v13, v14
  s_nop 0
  s_branch K1_A1T12_CONT
K1_A1T13_SLOW:
  s_waitcnt lgkmcnt(0)
  v_and_b32 v14, 31, v1
  v_lshlrev_b32 v14, 8, v14
  v_lshrrev_b32 v15, 5, v1
  v_lshl_add_u32 v14, v15, 4, v14
  s_and_b32 s34, s73, 15
  s_lshl_b32 s34, s34, 13
  s_lshl_b32 s35, s32, 17
  s_add_u32 s34, s34, s35
  buffer_load_dwordx4 v[144:147], v14, s[4:7], s34 offen offset:0
  buffer_load_dwordx4 v[148:151], v14, s[4:7], s34 offen offset:32
  buffer_load_dwordx4 v[152:155], v14, s[4:7], s34 offen offset:64
  buffer_load_dwordx4 v[156:159], v14, s[4:7], s34 offen offset:96
  s_waitcnt vmcnt(0)
  v_mfma_f32_32x32x16_bf16 v[128:143], v[144:147], v[16:19], 0
  v_mfma_f32_32x32x16_bf16 v[128:143], v[148:151], v[20:23], v[128:143]
  v_mfma_f32_32x32x16_bf16 v[128:143], v[152:155], v[24:27], v[128:143]
  v_mfma_f32_32x32x16_bf16 v[128:143], v[156:159], v[28:31], v[128:143]
  buffer_load_dwordx4 v[144:147], v14, s[4:7], s34 offen offset:128
  buffer_load_dwordx4 v[148:151], v14, s[4:7], s34 offen offset:160
  buffer_load_dwordx4 v[152:155], v14, s[4:7], s34 offen offset:192
  buffer_load_dwordx4 v[156:159], v14, s[4:7], s34 offen offset:224
  s_waitcnt vmcnt(0)
  v_mfma_f32_32x32x16_bf16 v[128:143], v[144:147], v[32:35], v[128:143]
  v_mfma_f32_32x32x16_bf16 v[128:143], v[148:151], v[36:39], v[128:143]
  v_mfma_f32_32x32x16_bf16 v[128:143], v[152:155], v[40:43], v[128:143]
  v_mfma_f32_32x32x16_bf16 v[128:143], v[156:159], v[44:47], v[128:143]
  s_nop 11
  v_max3_f32 v14, v128, v129, v130
  v_max3_f32 v14, v14, v131, v132
  v_max3_f32 v14, v14, v133, v134
  v_max3_f32 v14, v14, v135, v136
  v_max3_f32 v14, v14, v137, v138
  v_max3_f32 v14, v14, v139, v140
  v_max3_f32 v14, v14, v141, v142
  v_max_f32 v14, v14, v143
  v_mov_b32 v15, v14
  s_nop 1
  v_permlane32_swap_b32 v14, v15
  v_max_f32 v14, v14, v15
  v_max_f32 v14, v14, v0
  v_sub_f32 v15, v0, v14
  v_exp_f32 v15, v15
  v_mov_b32 v0, v14
  v_mul_f32 v12, v12, v15
  v_mul_f32 v48, v48, v15
  v_mul_f32 v49, v49, v15
  v_mul_f32 v50, v50, v15
  v_mul_f32 v51, v51, v15
  v_mul_f32 v52, v52, v15
  v_mul_f32 v53, v53, v15
  v_mul_f32 v54, v54, v15
  v_mul_f32 v55, v55, v15
  v_mul_f32 v56, v56, v15
  v_mul_f32 v57, v57, v15
  v_mul_f32 v58, v58, v15
  v_mul_f32 v59, v59, v15
  v_mul_f32 v60, v60, v15
  v_mul_f32 v61, v61, v15
  v_mul_f32 v62, v62, v15
  v_mul_f32 v63, v63, v15
  v_mul_f32 v64, v64, v15
  v_mul_f32 v65, v65, v15
  v_mul_f32 v66, v66, v15
  v_mul_f32 v67, v67, v15
  v_mul_f32 v68, v68, v15
  v_mul_f32 v69, v69, v15
  v_mul_f32 v70, v70, v15
  v_mul_f32 v71, v71, v15
  v_mul_f32 v72, v72, v15
  v_mul_f32 v73, v73, v15
  v_mul_f32 v74, v74, v15
  v_mul_f32 v75, v75, v15
  v_mul_f32 v76, v76, v15
  v_mul_f32 v77, v77, v15
  v_mul_f32 v78, v78, v15
  v_mul_f32 v79, v79, v15
  v_mul_f32 v80, v80, v15
  v_mul_f32 v81, v81, v15
  v_mul_f32 v82, v82, v15
  v_mul_f32 v83, v83, v15
  v_mul_f32 v84, v84, v15
  v_mul_f32 v85, v85, v15
  v_mul_f32 v86, v86, v15
  v_mul_f32 v87, v87, v15
  v_mul_f32 v88, v88, v15
  v_mul_f32 v89, v89, v15
  v_mul_f32 v90, v90, v15
  v_mul_f32 v91, v91, v15
  v_mul_f32 v92, v92, v15
  v_mul_f32 v93, v93, v15
  v_mul_f32 v94, v94, v15
  v_mul_f32 v95, v95, v15
  v_mul_f32 v96, v96, v15
  v_mul_f32 v97, v97, v15
  v_mul_f32 v98, v98, v15
  v_mul_f32 v99, v99, v15
  v_mul_f32 v100, v100, v15
  v_mul_f32 v101, v101, v15
  v_mul_f32 v102, v102, v15
  v_mul_f32 v103, v103, v15
  v_mul_f32 v104, v104, v15
  v_mul_f32 v105, v105, v15
  v_mul_f32 v106, v106, v15
  v_mul_f32 v107, v107, v15
  v_mul_f32 v108, v108, v15
  v_mul_f32 v109, v109, v15
  v_mul_f32 v110, v110, v15
  v_mul_f32 v111, v111, v15
  ds_read_b64_tr_b16 v[144:145], v5 offset:0
  ds_read_b64_tr_b16 v[146:147], v5 offset:2048
  ds_read_b64_tr_b16 v[148:149], v5 offset:256
  ds_read_b64_tr_b16 v[150:151], v5 offset:2304
  ds_read_b64_tr_b16 v[152:153], v5 offset:512
  ds_read_b64_tr_b16 v[154:155], v5 offset:2560
  ds_read_b64_tr_b16 v[156:157], v5 offset:768
  ds_read_b64_tr_b16 v[158:159], v5 offset:2816
  v_sub_f32 v128, v128, v0
  v_sub_f32 v129, v129, v0
  v_exp_f32 v128, v128
  v_exp_f32 v129, v129
  v_sub_f32 v130, v130, v0
  v_sub_f32 v131, v131, v0
  v_exp_f32 v130, v130
  v_exp_f32 v131, v131
  v_sub_f32 v132, v132, v0
  v_sub_f32 v133, v133, v0
  v_exp_f32 v132, v132
  v_exp_f32 v133, v133
  v_sub_f32 v134, v134, v0
  v_sub_f32 v135, v135, v0
  v_exp_f32 v134, v134
  v_exp_f32 v135, v135
  v_sub_f32 v136, v136, v0
  v_sub_f32 v137, v137, v0
  v_exp_f32 v136, v136
  v_exp_f32 v137, v137
  v_sub_f32 v138, v138, v0
  v_sub_f32 v139, v139, v0
  v_exp_f32 v138, v138
  v_exp_f32 v139, v139
  v_sub_f32 v140, v140, v0
  v_sub_f32 v141, v141, v0
  v_exp_f32 v140, v140
  v_exp_f32 v141, v141
  v_sub_f32 v142, v142, v0
  v_sub_f32 v143, v143, v0
  v_exp_f32 v142, v142
  v_exp_f32 v143, v143
  v_add_f32 v13, v128, v129
  v_cvt_pk_bf16_f32 v128, v128, v129
  v_add_f32 v14, v130, v131
  v_cvt_pk_bf16_f32 v129, v130, v131
  v_add_f32 v13, v13, v132
  v_add_f32 v14, v14, v133
  v_cvt_pk_bf16_f32 v130, v132, v133
  v_add_f32 v13, v13, v134
  v_add_f32 v14, v14, v135
  v_cvt_pk_bf16_f32 v131, v134, v135
  v_add_f32 v13, v13, v136
  v_add_f32 v14, v14, v137
  v_cvt_pk_bf16_f32 v136, v136, v137
  v_add_f32 v13, v13, v138
  v_add_f32 v14, v14, v139
  v_cvt_pk_bf16_f32 v137, v138, v139
  v_add_f32 v13, v13, v140
  v_add_f32 v14, v14, v141
  v_cvt_pk_bf16_f32 v138, v140, v141
  v_add_f32 v13, v13, v142
  v_add_f32 v14, v14, v143
  v_cvt_pk_bf16_f32 v139, v142, v143
  v_add_f32 v13, v13, v14
  s_nop 0
  s_branch K1_A1T13_CONT
K1_A1T14_SLOW:
  s_waitcnt lgkmcnt(0)
  v_and_b32 v14, 31, v1
  v_lshlrev_b32 v14, 8, v14
  v_lshrrev_b32 v15, 5, v1
  v_lshl_add_u32 v14, v15, 4, v14
  s_and_b32 s34, s73, 15
  s_lshl_b32 s34, s34, 13
  s_lshl_b32 s35, s32, 17
  s_add_u32 s34, s34, s35
  buffer_load_dwordx4 v[144:147], v14, s[4:7], s34 offen offset:0
  buffer_load_dwordx4 v[148:151], v14, s[4:7], s34 offen offset:32
  buffer_load_dwordx4 v[152:155], v14, s[4:7], s34 offen offset:64
  buffer_load_dwordx4 v[156:159], v14, s[4:7], s34 offen offset:96
  s_waitcnt vmcnt(0)
  v_mfma_f32_32x32x16_bf16 v[112:127], v[144:147], v[16:19], 0
  v_mfma_f32_32x32x16_bf16 v[112:127], v[148:151], v[20:23], v[112:127]
  v_mfma_f32_32x32x16_bf16 v[112:127], v[152:155], v[24:27], v[112:127]
  v_mfma_f32_32x32x16_bf16 v[112:127], v[156:159], v[28:31], v[112:127]
  buffer_load_dwordx4 v[144:147], v14, s[4:7], s34 offen offset:128
  buffer_load_dwordx4 v[148:151], v14, s[4:7], s34 offen offset:160
  buffer_load_dwordx4 v[152:155], v14, s[4:7], s34 offen offset:192
  buffer_load_dwordx4 v[156:159], v14, s[4:7], s34 offen offset:224
  s_waitcnt vmcnt(0)
  v_mfma_f32_32x32x16_bf16 v[112:127], v[144:147], v[32:35], v[112:127]
  v_mfma_f32_32x32x16_bf16 v[112:127], v[148:151], v[36:39], v[112:127]
  v_mfma_f32_32x32x16_bf16 v[112:127], v[152:155], v[40:43], v[112:127]
  v_mfma_f32_32x32x16_bf16 v[112:127], v[156:159], v[44:47], v[112:127]
  s_nop 11
  v_max3_f32 v14, v112, v113, v114
  v_max3_f32 v14, v14, v115, v116
  v_max3_f32 v14, v14, v117, v118
  v_max3_f32 v14, v14, v119, v120
  v_max3_f32 v14, v14, v121, v122
  v_max3_f32 v14, v14, v123, v124
  v_max3_f32 v14, v14, v125, v126
  v_max_f32 v14, v14, v127
  v_mov_b32 v15, v14
  s_nop 1
  v_permlane32_swap_b32 v14, v15
  v_max_f32 v14, v14, v15
  v_max_f32 v14, v14, v0
  v_sub_f32 v15, v0, v14
  v_exp_f32 v15, v15
  v_mov_b32 v0, v14
  v_mul_f32 v12, v12, v15
  v_mul_f32 v48, v48, v15
  v_mul_f32 v49, v49, v15
  v_mul_f32 v50, v50, v15
  v_mul_f32 v51, v51, v15
  v_mul_f32 v52, v52, v15
  v_mul_f32 v53, v53, v15
  v_mul_f32 v54, v54, v15
  v_mul_f32 v55, v55, v15
  v_mul_f32 v56, v56, v15
  v_mul_f32 v57, v57, v15
  v_mul_f32 v58, v58, v15
  v_mul_f32 v59, v59, v15
  v_mul_f32 v60, v60, v15
  v_mul_f32 v61, v61, v15
  v_mul_f32 v62, v62, v15
  v_mul_f32 v63, v63, v15
  v_mul_f32 v64, v64, v15
  v_mul_f32 v65, v65, v15
  v_mul_f32 v66, v66, v15
  v_mul_f32 v67, v67, v15
  v_mul_f32 v68, v68, v15
  v_mul_f32 v69, v69, v15
  v_mul_f32 v70, v70, v15
  v_mul_f32 v71, v71, v15
  v_mul_f32 v72, v72, v15
  v_mul_f32 v73, v73, v15
  v_mul_f32 v74, v74, v15
  v_mul_f32 v75, v75, v15
  v_mul_f32 v76, v76, v15
  v_mul_f32 v77, v77, v15
  v_mul_f32 v78, v78, v15
  v_mul_f32 v79, v79, v15
  v_mul_f32 v80, v80, v15
  v_mul_f32 v81, v81, v15
  v_mul_f32 v82, v82, v15
  v_mul_f32 v83, v83, v15
  v_mul_f32 v84, v84, v15
  v_mul_f32 v85, v85, v15
  v_mul_f32 v86, v86, v15
  v_mul_f32 v87, v87, v15
  v_mul_f32 v88, v88, v15
  v_mul_f32 v89, v89, v15
  v_mul_f32 v90, v90, v15
  v_mul_f32 v91, v91, v15
  v_mul_f32 v92, v92, v15
  v_mul_f32 v93, v93, v15
  v_mul_f32 v94, v94, v15
  v_mul_f32 v95, v95, v15
  v_mul_f32 v96, v96, v15
  v_mul_f32 v97, v97, v15
  v_mul_f32 v98, v98, v15
  v_mul_f32 v99, v99, v15
  v_mul_f32 v100, v100, v15
  v_mul_f32 v101, v101, v15
  v_mul_f32 v102, v102, v15
  v_mul_f32 v103, v103, v15
  v_mul_f32 v104, v104, v15
  v_mul_f32 v105, v105, v15
  v_mul_f32 v106, v106, v15
  v_mul_f32 v107, v107, v15
  v_mul_f32 v108, v108, v15
  v_mul_f32 v109, v109, v15
  v_mul_f32 v110, v110, v15
  v_mul_f32 v111, v111, v15
  ds_read_b64_tr_b16 v[144:145], v5 offset:0
  ds_read_b64_tr_b16 v[146:147], v5 offset:2048
  ds_read_b64_tr_b16 v[148:149], v5 offset:256
  ds_read_b64_tr_b16 v[150:151], v5 offset:2304
  ds_read_b64_tr_b16 v[152:153], v5 offset:512
  ds_read_b64_tr_b16 v[154:155], v5 offset:2560
  ds_read_b64_tr_b16 v[156:157], v5 offset:768
  ds_read_b64_tr_b16 v[158:159], v5 offset:2816
  v_sub_f32 v112, v112, v0
  v_sub_f32 v113, v113, v0
  v_exp_f32 v112, v112
  v_exp_f32 v113, v113
  v_sub_f32 v114, v114, v0
  v_sub_f32 v115, v115, v0
  v_exp_f32 v114, v114
  v_exp_f32 v115, v115
  v_sub_f32 v116, v116, v0
  v_sub_f32 v117, v117, v0
  v_exp_f32 v116, v116
  v_exp_f32 v117, v117
  v_sub_f32 v118, v118, v0
  v_sub_f32 v119, v119, v0
  v_exp_f32 v118, v118
  v_exp_f32 v119, v119
  v_sub_f32 v120, v120, v0
  v_sub_f32 v121, v121, v0
  v_exp_f32 v120, v120
  v_exp_f32 v121, v121
  v_sub_f32 v122, v122, v0
  v_sub_f32 v123, v123, v0
  v_exp_f32 v122, v122
  v_exp_f32 v123, v123
  v_sub_f32 v124, v124, v0
  v_sub_f32 v125, v125, v0
  v_exp_f32 v124, v124
  v_exp_f32 v125, v125
  v_sub_f32 v126, v126, v0
  v_sub_f32 v127, v127, v0
  v_exp_f32 v126, v126
  v_exp_f32 v127, v127
  v_add_f32 v13, v112, v113
  v_cvt_pk_bf16_f32 v112, v112, v113
  v_add_f32 v14, v114, v115
  v_cvt_pk_bf16_f32 v113, v114, v115
  v_add_f32 v13, v13, v116
  v_add_f32 v14, v14, v117
  v_cvt_pk_bf16_f32 v114, v116, v117
  v_add_f32 v13, v13, v118
  v_add_f32 v14, v14, v119
  v_cvt_pk_bf16_f32 v115, v118, v119
  v_add_f32 v13, v13, v120
  v_add_f32 v14, v14, v121
  v_cvt_pk_bf16_f32 v120, v120, v121
  v_add_f32 v13, v13, v122
  v_add_f32 v14, v14, v123
  v_cvt_pk_bf16_f32 v121, v122, v123
  v_add_f32 v13, v13, v124
  v_add_f32 v14, v14, v125
  v_cvt_pk_bf16_f32 v122, v124, v125
  v_add_f32 v13, v13, v126
  v_add_f32 v14, v14, v127
  v_cvt_pk_bf16_f32 v123, v126, v127
  v_add_f32 v13, v13, v14
  s_nop 0
  s_branch K1_A1T14_CONT
K1_A1T15_SLOW:
  s_waitcnt lgkmcnt(0)
  v_and_b32 v14, 31, v1
  v_lshlrev_b32 v14, 8, v14
  v_lshrrev_b32 v15, 5, v1
  v_lshl_add_u32 v14, v15, 4, v14
  s_and_b32 s34, s73, 15
  s_lshl_b32 s34, s34, 13
  s_lshl_b32 s35, s32, 17
  s_add_u32 s34, s34, s35
  buffer_load_dwordx4 v[144:147], v14, s[4:7], s34 offen offset:0
  buffer_load_dwordx4 v[148:151], v14, s[4:7], s34 offen offset:32
  buffer_load_dwordx4 v[152:155], v14, s[4:7], s34 offen offset:64
  buffer_load_dwordx4 v[156:159], v14, s[4:7], s34 offen offset:96
  s_waitcnt vmcnt(0)
  v_mfma_f32_32x32x16_bf16 v[128:143], v[144:147], v[16:19], 0
  v_mfma_f32_32x32x16_bf16 v[128:143], v[148:151], v[20:23], v[128:143]
  v_mfma_f32_32x32x16_bf16 v[128:143], v[152:155], v[24:27], v[128:143]
  v_mfma_f32_32x32x16_bf16 v[128:143], v[156:159], v[28:31], v[128:143]
  buffer_load_dwordx4 v[144:147], v14, s[4:7], s34 offen offset:128
  buffer_load_dwordx4 v[148:151], v14, s[4:7], s34 offen offset:160
  buffer_load_dwordx4 v[152:155], v14, s[4:7], s34 offen offset:192
  buffer_load_dwordx4 v[156:159], v14, s[4:7], s34 offen offset:224
  s_waitcnt vmcnt(0)
  v_mfma_f32_32x32x16_bf16 v[128:143], v[144:147], v[32:35], v[128:143]
  v_mfma_f32_32x32x16_bf16 v[128:143], v[148:151], v[36:39], v[128:143]
  v_mfma_f32_32x32x16_bf16 v[128:143], v[152:155], v[40:43], v[128:143]
  v_mfma_f32_32x32x16_bf16 v[128:143], v[156:159], v[44:47], v[128:143]
  s_nop 11
  v_max3_f32 v14, v128, v129, v130
  v_max3_f32 v14, v14, v131, v132
  v_max3_f32 v14, v14, v133, v134
  v_max3_f32 v14, v14, v135, v136
  v_max3_f32 v14, v14, v137, v138
  v_max3_f32 v14, v14, v139, v140
  v_max3_f32 v14, v14, v141, v142
  v_max_f32 v14, v14, v143
  v_mov_b32 v15, v14
  s_nop 1
  v_permlane32_swap_b32 v14, v15
  v_max_f32 v14, v14, v15
  v_max_f32 v14, v14, v0
  v_sub_f32 v15, v0, v14
  v_exp_f32 v15, v15
  v_mov_b32 v0, v14
  v_mul_f32 v12, v12, v15
  v_mul_f32 v48, v48, v15
  v_mul_f32 v49, v49, v15
  v_mul_f32 v50, v50, v15
  v_mul_f32 v51, v51, v15
  v_mul_f32 v52, v52, v15
  v_mul_f32 v53, v53, v15
  v_mul_f32 v54, v54, v15
  v_mul_f32 v55, v55, v15
  v_mul_f32 v56, v56, v15
  v_mul_f32 v57, v57, v15
  v_mul_f32 v58, v58, v15
  v_mul_f32 v59, v59, v15
  v_mul_f32 v60, v60, v15
  v_mul_f32 v61, v61, v15
  v_mul_f32 v62, v62, v15
  v_mul_f32 v63, v63, v15
  v_mul_f32 v64, v64, v15
  v_mul_f32 v65, v65, v15
  v_mul_f32 v66, v66, v15
  v_mul_f32 v67, v67, v15
  v_mul_f32 v68, v68, v15
  v_mul_f32 v69, v69, v15
  v_mul_f32 v70, v70, v15
  v_mul_f32 v71, v71, v15
  v_mul_f32 v72, v72, v15
  v_mul_f32 v73, v73, v15
  v_mul_f32 v74, v74, v15
  v_mul_f32 v75, v75, v15
  v_mul_f32 v76, v76, v15
  v_mul_f32 v77, v77, v15
  v_mul_f32 v78, v78, v15
  v_mul_f32 v79, v79, v15
  v_mul_f32 v80, v80, v15
  v_mul_f32 v81, v81, v15
  v_mul_f32 v82, v82, v15
  v_mul_f32 v83, v83, v15
  v_mul_f32 v84, v84, v15
  v_mul_f32 v85, v85, v15
  v_mul_f32 v86, v86, v15
  v_mul_f32 v87, v87, v15
  v_mul_f32 v88, v88, v15
  v_mul_f32 v89, v89, v15
  v_mul_f32 v90, v90, v15
  v_mul_f32 v91, v91, v15
  v_mul_f32 v92, v92, v15
  v_mul_f32 v93, v93, v15
  v_mul_f32 v94, v94, v15
  v_mul_f32 v95, v95, v15
  v_mul_f32 v96, v96, v15
  v_mul_f32 v97, v97, v15
  v_mul_f32 v98, v98, v15
  v_mul_f32 v99, v99, v15
  v_mul_f32 v100, v100, v15
  v_mul_f32 v101, v101, v15
  v_mul_f32 v102, v102, v15
  v_mul_f32 v103, v103, v15
  v_mul_f32 v104, v104, v15
  v_mul_f32 v105, v105, v15
  v_mul_f32 v106, v106, v15
  v_mul_f32 v107, v107, v15
  v_mul_f32 v108, v108, v15
  v_mul_f32 v109, v109, v15
  v_mul_f32 v110, v110, v15
  v_mul_f32 v111, v111, v15
  ds_read_b64_tr_b16 v[144:145], v5 offset:0
  ds_read_b64_tr_b16 v[146:147], v5 offset:2048
  ds_read_b64_tr_b16 v[148:149], v5 offset:256
  ds_read_b64_tr_b16 v[150:151], v5 offset:2304
  ds_read_b64_tr_b16 v[152:153], v5 offset:512
  ds_read_b64_tr_b16 v[154:155], v5 offset:2560
  ds_read_b64_tr_b16 v[156:157], v5 offset:768
  ds_read_b64_tr_b16 v[158:159], v5 offset:2816
  v_sub_f32 v128, v128, v0
  v_sub_f32 v129, v129, v0
  v_exp_f32 v128, v128
  v_exp_f32 v129, v129
  v_sub_f32 v130, v130, v0
  v_sub_f32 v131, v131, v0
  v_exp_f32 v130, v130
  v_exp_f32 v131, v131
  v_sub_f32 v132, v132, v0
  v_sub_f32 v133, v133, v0
  v_exp_f32 v132, v132
  v_exp_f32 v133, v133
  v_sub_f32 v134, v134, v0
  v_sub_f32 v135, v135, v0
  v_exp_f32 v134, v134
  v_exp_f32 v135, v135
  v_sub_f32 v136, v136, v0
  v_sub_f32 v137, v137, v0
  v_exp_f32 v136, v136
  v_exp_f32 v137, v137
  v_sub_f32 v138, v138, v0
  v_sub_f32 v139, v139, v0
  v_exp_f32 v138, v138
  v_exp_f32 v139, v139
  v_sub_f32 v140, v140, v0
  v_sub_f32 v141, v141, v0
  v_exp_f32 v140, v140
  v_exp_f32 v141, v141
  v_sub_f32 v142, v142, v0
  v_sub_f32 v143, v143, v0
  v_exp_f32 v142, v142
  v_exp_f32 v143, v143
  v_add_f32 v13, v128, v129
  v_cvt_pk_bf16_f32 v128, v128, v129
  v_add_f32 v14, v130, v131
  v_cvt_pk_bf16_f32 v129, v130, v131
  v_add_f32 v13, v13, v132
  v_add_f32 v14, v14, v133
  v_cvt_pk_bf16_f32 v130, v132, v133
  v_add_f32 v13, v13, v134
  v_add_f32 v14, v14, v135
  v_cvt_pk_bf16_f32 v131, v134, v135
  v_add_f32 v13, v13, v136
  v_add_f32 v14, v14, v137
  v_cvt_pk_bf16_f32 v136, v136, v137
  v_add_f32 v13, v13, v138
  v_add_f32 v14, v14, v139
  v_cvt_pk_bf16_f32 v137, v138, v139
  v_add_f32 v13, v13, v140
  v_add_f32 v14, v14, v141
  v_cvt_pk_bf16_f32 v138, v140, v141
  v_add_f32 v13, v13, v142
  v_add_f32 v14, v14, v143
  v_cvt_pk_bf16_f32 v139, v142, v143
  v_add_f32 v13, v13, v14
  s_nop 0
  s_branch K1_A1T15_CONT
K1_A2:
  v_add_u32 v2, 147456, v10
  s_mov_b32 s24, 0
  s_mov_b32 s38, 32768
  s_waitcnt lgkmcnt(0)
  ds_read_b128 v[144:147], v2
  v_xor_b32 v4, 32, v2
  ds_read_b128 v[148:151], v4
  v_xor_b32 v3, 64, v2
  ds_read_b128 v[152:155], v3
  v_xor_b32 v4, 96, v2
  ds_read_b128 v[156:159], v4
  s_waitcnt lgkmcnt(3)
  v_mfma_f32_32x32x16_bf16 v[112:127], v[144:147], v[16:19], 0
  v_xor_b32 v3, 128, v2
  ds_read_b128 v[144:147], v3
  s_waitcnt lgkmcnt(3)
  v_mfma_f32_32x32x16_bf16 v[112:127], v[148:151], v[20:23], v[112:127]
  v_xor_b32 v4, 160, v2
  ds_read_b128 v[148:151], v4
  s_waitcnt lgkmcnt(3)
  v_mfma_f32_32x32x16_bf16 v[112:127], v[152:155], v[24:27], v[112:127]
  v_xor_b32 v3, 192, v2
  ds_read_b128 v[152:155], v3
  s_waitcnt lgkmcnt(3)
  v_mfma_f32_32x32x16_bf16 v[112:127], v[156:159], v[28:31], v[112:127]
  v_xor_b32 v4, 224, v2
  ds_read_b128 v[156:159], v4
  s_waitcnt lgkmcnt(3)
  v_mfma_f32_32x32x16_bf16 v[112:127], v[144:147], v[32:35], v[112:127]
  s_waitcnt lgkmcnt(2)
  v_mfma_f32_32x32x16_bf16 v[112:127], v[148:151], v[36:39], v[112:127]
  s_waitcnt lgkmcnt(1)
  v_mfma_f32_32x32x16_bf16 v[112:127], v[152:155], v[40:43], v[112:127]
  s_waitcnt lgkmcnt(0)
  v_mfma_f32_32x32x16_bf16 v[112:127], v[156:159], v[44:47], v[112:127]
  v_mov_b32 v160, v10
  ds_read_b128 v[144:147], v160
  v_xor_b32 v4, 32, v160
  ds_read_b128 v[148:151], v4
  v_xor_b32 v3, 64, v160
  ds_read_b128 v[152:155], v3
  v_xor_b32 v4, 96, v160
  ds_read_b128 v[156:159], v4
  s_nop 3
  v_max3_f32 v14, v112, v113, v114
  v_max3_f32 v14, v14, v115, v116
  v_max3_f32 v14, v14, v117, v118
  v_max3_f32 v14, v14, v119, v120
  v_max3_f32 v14, v14, v121, v122
  v_max3_f32 v14, v14, v123, v124
  v_max3_f32 v14, v14, v125, v126
  v_max_f32 v14, v14, v127
  v_mov_b32 v15, v14
  s_nop 1
  v_permlane32_swap_b32 v14, v15
  v_max_f32 v14, v14, v15
  v_mov_b32 v0, v14
  v_sub_f32 v112, v112, v0
  v_sub_f32 v113, v113, v0
  v_exp_f32 v112, v112
  v_exp_f32 v113, v113
  v_sub_f32 v114, v114, v0
  v_sub_f32 v115, v115, v0
  v_exp_f32 v114, v114
  v_exp_f32 v115, v115
  v_sub_f32 v116, v116, v0
  v_sub_f32 v117, v117, v0
  v_exp_f32 v116, v116
  v_exp_f32 v117, v117
  v_sub_f32 v118, v118, v0
  v_sub_f32 v119, v119, v0
  v_exp_f32 v118, v118
  v_exp_f32 v119, v119
  v_add_f32 v13, v112, v113
  v_cvt_pk_bf16_f32 v112, v112, v113
  v_add_f32 v14, v114, v115
  v_cvt_pk_bf16_f32 v113, v114, v115
  v_add_f32 v13, v13, v116
  v_add_f32 v14, v14, v117
  v_cvt_pk_bf16_f32 v114, v116, v117
  v_add_f32 v13, v13, v118
  v_add_f32 v14, v14, v119
  v_cvt_pk_bf16_f32 v115, v118, v119
K1_A2L:
  s_setprio 1
  v_add_u32 v5, s24, v11
  s_waitcnt lgkmcnt(3)
  v_mfma_f32_32x32x16_bf16 v[128:143], v[144:147], v[16:19], 0
  v_xor_b32 v3, 128, v160
  ds_read_b128 v[144:147], v3
  v_sub_f32 v120, v120, v0
  v_sub_f32 v121, v121, v0
  v_exp_f32 v120, v120
  v_exp_f32 v121, v121
  s_waitcnt lgkmcnt(3)
  v_mfma_f32_32x32x16_bf16 v[128:143], v[148:151], v[20:23], v[128:143]
  v_xor_b32 v4, 160, v160
  ds_read_b128 v[148:151], v4
  v_add_f32 v13, v13, v120
  v_add_f32 v14, v14, v121
  v_cvt_pk_bf16_f32 v120, v120, v121
  s_waitcnt lgkmcnt(3)
  v_mfma_f32_32x32x16_bf16 v[128:143], v[152:155], v[24:27], v[128:143]
  v_xor_b32 v3, 192, v160
  ds_read_b128 v[152:155], v3
  v_sub_f32 v122, v122, v0
  v_sub_f32 v123, v123, v0
  v_exp_f32 v122, v122
  v_exp_f32 v123, v123
  s_waitcnt lgkmcnt(3)
  v_mfma_f32_32x32x16_bf16 v[128:143], v[156:159], v[28:31], v[128:143]
  v_xor_b32 v4, 224, v160
  ds_read_b128 v[156:159], v4
  v_add_f32 v13, v13, v122
  v_add_f32 v14, v14, v123
  v_cvt_pk_bf16_f32 v121, v122, v123
  s_barrier
  s_waitcnt lgkmcnt(3)
  v_mfma_f32_32x32x16_bf16 v[128:143], v[144:147], v[32:35], v[128:143]
  ds_read_b64_tr_b16 v[144:145], v5 offset:0
  ds_read_b64_tr_b16 v[146:147], v5 offset:2048
  v_sub_f32 v124, v124, v0
  v_sub_f32 v125, v125, v0
  v_exp_f32 v124, v124
  v_exp_f32 v125, v125
  s_waitcnt lgkmcnt(4)
  v_mfma_f32_32x32x16_bf16 v[128:143], v[148:151], v[36:39], v[128:143]
  ds_read_b64_tr_b16 v[148:149], v5 offset:256
  ds_read_b64_tr_b16 v[150:151], v5 offset:2304
  v_add_f32 v13, v13, v124
  v_add_f32 v14, v14, v125
  v_cvt_pk_bf16_f32 v122, v124, v125
  s_waitcnt lgkmcnt(5)
  v_mfma_f32_32x32x16_bf16 v[128:143], v[152:155], v[40:43], v[128:143]
  ds_read_b64_tr_b16 v[152:153], v5 offset:512
  ds_read_b64_tr_b16 v[154:155], v5 offset:2560
  v_sub_f32 v126, v126, v0
  v_sub_f32 v127, v127, v0
  v_exp_f32 v126, v126
  v_exp_f32 v127, v127
  s_waitcnt lgkmcnt(6)
  v_mfma_f32_32x32x16_bf16 v[128:143], v[156:159], v[44:47], v[128:143]
  ds_read_b64_tr_b16 v[156:157], v5 offset:768
  ds_read_b64_tr_b16 v[158:159], v5 offset:2816
  v_add_f32 v13, v13, v126
  v_add_f32 v14, v14, v127
  v_cvt_pk_bf16_f32 v123, v126, v127
  v_add_f32 v13, v13, v14
  v_cmp_nge_f32 vcc, 0x49800000, v13
  s_nop 0
  s_cbranch_vccnz K1_A2L0_SLOW
K1_A2L0_CONT:
  v_add_f32 v12, v12, v13
  v_add_u32 v160, s38, v10
  s_waitcnt lgkmcnt(6)
  v_mfma_f32_32x32x16_bf16 v[48:63], v[144:147], v[112:115], v[48:63]
  ds_read_b64_tr_b16 v[144:145], v5 offset:4096
  ds_read_b64_tr_b16 v[146:147], v5 offset:6144
  s_waitcnt lgkmcnt(6)
  v_mfma_f32_32x32x16_bf16 v[64:79], v[148:151], v[112:115], v[64:79]
  ds_read_b64_tr_b16 v[148:149], v5 offset:4352
  ds_read_b64_tr_b16 v[150:151], v5 offset:6400
  v_sub_f32 v128, v128, v0
  v_sub_f32 v129, v129, v0
  v_exp_f32 v128, v128
  v_exp_f32 v129, v129
  s_waitcnt lgkmcnt(6)
  v_mfma_f32_32x32x16_bf16 v[80:95], v[152:155], v[112:115], v[80:95]
  ds_read_b64_tr_b16 v[152:153], v5 offset:4608
  ds_read_b64_tr_b16 v[154:155], v5 offset:6656
  v_add_f32 v13, v128, v129
  v_cvt_pk_bf16_f32 v128, v128, v129
  s_waitcnt lgkmcnt(6)
  v_mfma_f32_32x32x16_bf16 v[96:111], v[156:159], v[112:115], v[96:111]
  ds_read_b64_tr_b16 v[156:157], v5 offset:4864
  ds_read_b64_tr_b16 v[158:159], v5 offset:6912
  v_sub_f32 v130, v130, v0
  v_sub_f32 v131, v131, v0
  v_exp_f32 v130, v130
  v_exp_f32 v131, v131
  s_waitcnt lgkmcnt(6)
  v_mfma_f32_32x32x16_bf16 v[48:63], v[144:147], v[120:123], v[48:63]
  ds_read_b128 v[144:147], v160
  v_add_f32 v14, v130, v131
  v_cvt_pk_bf16_f32 v129, v130, v131
  s_waitcnt lgkmcnt(5)
  v_mfma_f32_32x32x16_bf16 v[64:79], v[148:151], v[120:123], v[64:79]
  v_xor_b32 v4, 32, v160
  ds_read_b128 v[148:151], v4
  v_sub_f32 v132, v132, v0
  v_sub_f32 v133, v133, v0
  v_exp_f32 v132, v132
  v_exp_f32 v133, v133
  s_waitcnt lgkmcnt(4)
  v_mfma_f32_32x32x16_bf16 v[80:95], v[152:155], v[120:123], v[80:95]
  v_xor_b32 v3, 64, v160
  ds_read_b128 v[152:155], v3
  v_add_f32 v13, v13, v132
  v_add_f32 v14, v14, v133
  v_cvt_pk_bf16_f32 v130, v132, v133
  s_waitcnt lgkmcnt(3)
  v_mfma_f32_32x32x16_bf16 v[96:111], v[156:159], v[120:123], v[96:111]
  v_xor_b32 v4, 96, v160
  ds_read_b128 v[156:159], v4
  v_sub_f32 v134, v134, v0
  v_sub_f32 v135, v135, v0
  v_exp_f32 v134, v134
  v_exp_f32 v135, v135
  v_add_f32 v13, v13, v134
  v_add_f32 v14, v14, v135
  v_cvt_pk_bf16_f32 v131, v134, v135
  s_mov_b32 s24, s38
  s_add_u32 s38, s38, 32768
  s_cmp_eq_u32 s38, 163840
  s_cselect_b32 s38, 0, s38
  s_add_u32 s73, s73, 1
  s_setprio 1
  v_add_u32 v5, s24, v11
  s_waitcnt lgkmcnt(3)
  v_mfma_f32_32x32x16_bf16 v[112:127], v[144:147], v[16:19], 0
  v_xor_b32 v3, 128, v160
  ds_read_b128 v[144:147], v3
  v_sub_f32 v136, v136, v0
  v_sub_f32 v137, v137, v0
  v_exp_f32 v136, v136
  v_exp_f32 v137, v137
  s_waitcnt lgkmcnt(3)
  v_mfma_f32_32x32x16_bf16 v[112:127], v[148:151], v[20:23], v[112:127]
  v_xor_b32 v4, 160, v160
  ds_read_b128 v[148:151], v4
  v_add_f32 v13, v13, v136
  v_add_f32 v14, v14, v137
  v_cvt_pk_bf16_f32 v136, v136, v137
  s_waitcnt lgkmcnt(3)
  v_mfma_f32_32x32x16_bf16 v[112:127], v[152:155], v[24:27], v[112:127]
  v_xor_b32 v3, 192, v160
  ds_read_b128 v[152:155], v3
  v_sub_f32 v138, v138, v0
  v_sub_f32 v139, v139, v0
  v_exp_f32 v138, v138
  v_exp_f32 v139, v139
  s_waitcnt lgkmcnt(3)
  v_mfma_f32_32x32x16_bf16 v[112:127], v[156:159], v[28:31], v[112:127]
  v_xor_b32 v4, 224, v160
  ds_read_b128 v[156:159], v4
  v_add_f32 v13, v13, v138
  v_add_f32 v14, v14, v139
  v_cvt_pk_bf16_f32 v137, v138, v139
  s_barrier
  s_waitcnt lgkmcnt(3)
  v_mfma_f32_32x32x16_bf16 v[112:127], v[144:147], v[32:35], v[112:127]
  ds_read_b64_tr_b16 v[144:145], v5 offset:0
  ds_read_b64_tr_b16 v[146:147], v5 offset:2048
  v_sub_f32 v140, v140, v0
  v_sub_f32 v141, v141, v0
  v_exp_f32 v140, v140
  v_exp_f32 v141, v141
  s_waitcnt lgkmcnt(4)
  v_mfma_f32_32x32x16_bf16 v[112:127], v[148:151], v[36:39], v[112:127]
  ds_read_b64_tr_b16 v[148:149], v5 offset:256
  ds_read_b64_tr_b16 v[150:151], v5 offset:2304
  v_add_f32 v13, v13, v140
  v_add_f32 v14, v14, v141
  v_cvt_pk_bf16_f32 v138, v140, v141
  s_waitcnt lgkmcnt(5)
  v_mfma_f32_32x32x16_bf16 v[112:127], v[152:155], v[40:43], v[112:127]
  ds_read_b64_tr_b16 v[152:153], v5 offset:512
  ds_read_b64_tr_b16 v[154:155], v5 offset:2560
  v_sub_f32 v142, v142, v0
  v_sub_f32 v143, v143, v0
  v_exp_f32 v142, v142
  v_exp_f32 v143, v143
  s_waitcnt lgkmcnt(6)
  v_mfma_f32_32x32x16_bf16 v[112:127], v[156:159], v[44:47], v[112:127]
  ds_read_b64_tr_b16 v[156:157], v5 offset:768
  ds_read_b64_tr_b16 v[158:159], v5 offset:2816
  v_add_f32 v13, v13, v142
  v_add_f32 v14, v14, v143
  v_cvt_pk_bf16_f32 v139, v142, v143
  v_add_f32 v13, v13, v14
  v_cmp_nge_f32 vcc, 0x49800000, v13
  s_nop 0
  s_cbranch_vccnz K1_A2L1_SLOW
K1_A2L1_CONT:
  v_add_f32 v12, v12, v13
  v_add_u32 v160, s38, v10
  s_waitcnt lgkmcnt(6)
  v_mfma_f32_32x32x16_bf16 v[48:63], v[144:147], v[128:131], v[48:63]
  ds_read_b64_tr_b16 v[144:145], v5 offset:4096
  ds_read_b64_tr_b16 v[146:147], v5 offset:6144
  s_waitcnt lgkmcnt(6)
  v_mfma_f32_32x32x16_bf16 v[64:79], v[148:151], v[128:131], v[64:79]
  ds_read_b64_tr_b16 v[148:149], v5 offset:4352
  ds_read_b64_tr_b16 v[150:151], v5 offset:6400
  v_sub_f32 v112, v112, v0
  v_sub_f32 v113, v113, v0
  v_exp_f32 v112, v112
  v_exp_f32 v113, v113
  s_waitcnt lgkmcnt(6)
  v_mfma_f32_32x32x16_bf16 v[80:95], v[152:155], v[128:131], v[80:95]
  ds_read_b64_tr_b16 v[152:153], v5 offset:4608
  ds_read_b64_tr_b16 v[154:155], v5 offset:6656
  v_add_f32 v13, v112, v113
  v_cvt_pk_bf16_f32 v112, v112, v113
  s_waitcnt lgkmcnt(6)
  v_mfma_f32_32x32x16_bf16 v[96:111], v[156:159], v[128:131], v[96:111]
  ds_read_b64_tr_b16 v[156:157], v5 offset:4864
  ds_read_b64_tr_b16 v[158:159], v5 offset:6912
  v_sub_f32 v114, v114, v0
  v_sub_f32 v115, v115, v0
  v_exp_f32 v114, v114
  v_exp_f32 v115, v115
  s_waitcnt lgkmcnt(6)
  v_mfma_f32_32x32x16_bf16 v[48:63], v[144:147], v[136:139], v[48:63]
  ds_read_b128 v[144:147], v160
  v_add_f32 v14, v114, v115
  v_cvt_pk_bf16_f32 v113, v114, v115
  s_waitcnt lgkmcnt(5)
  v_mfma_f32_32x32x16_bf16 v[64:79], v[148:151], v[136:139], v[64:79]
  v_xor_b32 v4, 32, v160
  ds_read_b128 v[148:151], v4
  v_sub_f32 v116, v116, v0
  v_sub_f32 v117, v117, v0
  v_exp_f32 v116, v116
  v_exp_f32 v117, v117
  s_waitcnt lgkmcnt(4)
  v_mfma_f32_32x32x16_bf16 v[80:95], v[152:155], v[136:139], v[80:95]
  v_xor_b32 v3, 64, v160
  ds_read_b128 v[152:155], v3
  v_add_f32 v13, v13, v116
  v_add_f32 v14, v14, v117
  v_cvt_pk_bf16_f32 v114, v116, v117
  s_waitcnt lgkmcnt(3)
  v_mfma_f32_32x32x16_bf16 v[96:111], v[156:159], v[136:139], v[96:111]
  v_xor_b32 v4, 96, v160
  ds_read_b128 v[156:159], v4
  v_sub_f32 v118, v118, v0
  v_sub_f32 v119, v119, v0
  v_exp_f32 v118, v118
  v_exp_f32 v119, v119
  v_add_f32 v13, v13, v118
  v_add_f32 v14, v14, v119
  v_cvt_pk_bf16_f32 v115, v118, v119
  s_mov_b32 s24, s38
  s_add_u32 s38, s38, 32768
  s_cmp_eq_u32 s38, 163840
  s_cselect_b32 s38, 0, s38
  s_add_u32 s73, s73, 1
  s_add_u32 s45, s45, 1
  s_cmp_lt_u32 s45, 6
  s_cbranch_scc1 K1_A2L
  s_setprio 1
  v_add_u32 v5, s24, v11
  s_waitcnt lgkmcnt(3)
  v_mfma_f32_32x32x16_bf16 v[128:143], v[144:147], v[16:19], 0
  v_xor_b32 v3, 128, v160
  ds_read_b128 v[144:147], v3
  v_sub_f32 v120, v120, v0
  v_sub_f32 v121, v121, v0
  v_exp_f32 v120, v120
  v_exp_f32 v121, v121
  s_waitcnt lgkmcnt(3)
  v_mfma_f32_32x32x16_bf16 v[128:143], v[148:151], v[20:23], v[128:143]
  v_xor_b32 v4, 160, v160
  ds_read_b128 v[148:151], v4
  v_add_f32 v13, v13, v120
  v_add_f32 v14, v14, v121
  v_cvt_pk_bf16_f32 v120, v120, v121
  s_waitcnt lgkmcnt(3)
  v_mfma_f32_32x32x16_bf16 v[128:143], v[152:155], v[24:27], v[128:143]
  v_xor_b32 v3, 192, v160
  ds_read_b128 v[152:155], v3
  v_sub_f32 v122, v122, v0
  v_sub_f32 v123, v123, v0
  v_exp_f32 v122, v122
  v_exp_f32 v123, v123
  s_waitcnt lgkmcnt(3)
  v_mfma_f32_32x32x16_bf16 v[128:143], v[156:159], v[28:31], v[128:143]
  v_xor_b32 v4, 224, v160
  ds_read_b128 v[156:159], v4
  v_add_f32 v13, v13, v122
  v_add_f32 v14, v14, v123
  v_cvt_pk_bf16_f32 v121, v122, v123
  s_barrier
  s_sub_u32 s35, s28, 8
  s_mul_i32 s34, s35, 5120
  s_add_u32 s34, s34, 32768
  s_add_u32 s35, s35, 0
  s_mul_i32 s35, s35, 40960
  s_mul_i32 s36, s31, 327680
  s_add_u32 s35, s35, s36
  s_mul_i32 s36, s30, 160
  s_add_u32 s35, s35, s36
  s_mov_b32 s37, 6554
  v_add_u32 v162, 0, v1
  v_mul_lo_u32 v163, v162, s37
  v_lshrrev_b32 v163, 16, v163
  v_mul_u32_u24 v166, 10, v163
  v_sub_u32 v166, v162, v166
  v_mul_u32_u24 v163, 1280, v163
  v_lshl_add_u32 v163, v166, 4, v163
  s_add_u32 m0, s34, 0
  s_nop 0
  buffer_load_dwordx4 v163, s[16:19], s35 offen lds
  v_add_u32 v162, 64, v1
  v_mul_lo_u32 v163, v162, s37
  v_lshrrev_b32 v163, 16, v163
  v_mul_u32_u24 v166, 10, v163
  v_sub_u32 v166, v162, v166
  v_mul_u32_u24 v163, 1280, v163
  v_lshl_add_u32 v163, v166, 4, v163
  s_add_u32 m0, s34, 1024
  s_nop 0
  buffer_load_dwordx4 v163, s[16:19], s35 offen lds
  v_add_u32 v162, 128, v1
  v_mul_lo_u32 v163, v162, s37
  v_lshrrev_b32 v163, 16, v163
  v_mul_u32_u24 v166, 10, v163
  v_sub_u32 v166, v162, v166
  v_mul_u32_u24 v163, 1280, v163
  v_lshl_add_u32 v163, v166, 4, v163
  s_add_u32 m0, s34, 2048
  s_nop 0
  buffer_load_dwordx4 v163, s[16:19], s35 offen lds
  v_add_u32 v162, 192, v1
  v_mul_lo_u32 v163, v162, s37
  v_lshrrev_b32 v163, 16, v163
  v_mul_u32_u24 v166, 10, v163
  v_sub_u32 v166, v162, v166
  v_mul_u32_u24 v163, 1280, v163
  v_lshl_add_u32 v163, v166, 4, v163
  s_add_u32 m0, s34, 3072
  s_nop 0
  buffer_load_dwordx4 v163, s[16:19], s35 offen lds
  v_add_u32 v162, 256, v1
  v_mul_lo_u32 v163, v162, s37
  v_lshrrev_b32 v163, 16, v163
  v_mul_u32_u24 v166, 10, v163
  v_sub_u32 v166, v162, v166
  v_mul_u32_u24 v163, 1280, v163
  v_lshl_add_u32 v163, v166, 4, v163
  s_add_u32 m0, s34, 4096
  s_nop 0
  buffer_load_dwordx4 v163, s[16:19], s35 offen lds
  s_waitcnt lgkmcnt(3)
  v_mfma_f32_32x32x16_bf16 v[128:143], v[144:147], v[32:35], v[128:143]
  ds_read_b64_tr_b16 v[144:145], v5 offset:0
  ds_read_b64_tr_b16 v[146:147], v5 offset:2048
  v_sub_f32 v124, v124, v0
  v_sub_f32 v125, v125, v0
  v_exp_f32 v124, v124
  v_exp_f32 v125, v125
  s_waitcnt lgkmcnt(4)
  v_mfma_f32_32x32x16_bf16 v[128:143], v[148:151], v[36:39], v[128:143]
  ds_read_b64_tr_b16 v[148:149], v5 offset:256
  ds_read_b64_tr_b16 v[150:151], v5 offset:2304
  v_add_f32 v13, v13, v124
  v_add_f32 v14, v14, v125
  v_cvt_pk_bf16_f32 v122, v124, v125
  s_waitcnt lgkmcnt(5)
  v_mfma_f32_32x32x16_bf16 v[128:143], v[152:155], v[40:43], v[128:143]
  ds_read_b64_tr_b16 v[152:153], v5 offset:512
  ds_read_b64_tr_b16 v[154:155], v5 offset:2560
  v_sub_f32 v126, v126, v0
  v_sub_f32 v127, v127, v0
  v_exp_f32 v126, v126
  v_exp_f32 v127, v127
  s_waitcnt lgkmcnt(6)
  v_mfma_f32_32x32x16_bf16 v[128:143], v[156:159], v[44:47], v[128:143]
  ds_read_b64_tr_b16 v[156:157], v5 offset:768
  ds_read_b64_tr_b16 v[158:159], v5 offset:2816
  v_add_f32 v13, v13, v126
  v_add_f32 v14, v14, v127
  v_cvt_pk_bf16_f32 v123, v126, v127
  v_add_f32 v13, v13, v14
  v_cmp_nge_f32 vcc, 0x49800000, v13
  s_nop 0
  s_cbranch_vccnz K1_A2T12_SLOW
K1_A2T12_CONT:
  v_add_f32 v12, v12, v13
  v_add_u32 v160, s38, v10
  s_waitcnt lgkmcnt(6)
  v_mfma_f32_32x32x16_bf16 v[48:63], v[144:147], v[112:115], v[48:63]
  ds_read_b64_tr_b16 v[144:145], v5 offset:4096
  ds_read_b64_tr_b16 v[146:147], v5 offset:6144
  s_waitcnt lgkmcnt(6)
  v_mfma_f32_32x32x16_bf16 v[64:79], v[148:151], v[112:115], v[64:79]
  ds_read_b64_tr_b16 v[148:149], v5 offset:4352
  ds_read_b64_tr_b16 v[150:151], v5 offset:6400
  v_sub_f32 v128, v128, v0
  v_sub_f32 v129, v129, v0
  v_exp_f32 v128, v128
  v_exp_f32 v129, v129
  s_waitcnt lgkmcnt(6)
  v_mfma_f32_32x32x16_bf16 v[80:95], v[152:155], v[112:115], v[80:95]
  ds_read_b64_tr_b16 v[152:153], v5 offset:4608
  ds_read_b64_tr_b16 v[154:155], v5 offset:6656
  v_add_f32 v13, v128, v129
  v_cvt_pk_bf16_f32 v128, v128, v129
  s_waitcnt lgkmcnt(6)
  v_mfma_f32_32x32x16_bf16 v[96:111], v[156:159], v[112:115], v[96:111]
  ds_read_b64_tr_b16 v[156:157], v5 offset:4864
  ds_read_b64_tr_b16 v[158:159], v5 offset:6912
  v_sub_f32 v130, v130, v0
  v_sub_f32 v131, v131, v0
  v_exp_f32 v130, v130
  v_exp_f32 v131, v131
  s_waitcnt lgkmcnt(6)
  v_mfma_f32_32x32x16_bf16 v[48:63], v[144:147], v[120:123], v[48:63]
  ds_read_b128 v[144:147], v160
  v_add_f32 v14, v130, v131
  v_cvt_pk_bf16_f32 v129, v130, v131
  s_waitcnt lgkmcnt(5)
  v_mfma_f32_32x32x16_bf16 v[64:79], v[148:151], v[120:123], v[64:79]
  v_xor_b32 v4, 32, v160
  ds_read_b128 v[148:151], v4
  v_sub_f32 v132, v132, v0
  v_sub_f32 v133, v133, v0
  v_exp_f32 v132, v132
  v_exp_f32 v133, v133
  s_waitcnt lgkmcnt(4)
  v_mfma_f32_32x32x16_bf16 v[80:95], v[152:155], v[120:123], v[80:95]
  v_xor_b32 v3, 64, v160
  ds_read_b128 v[152:155], v3
  v_add_f32 v13, v13, v132
  v_add_f32 v14, v14, v133
  v_cvt_pk_bf16_f32 v130, v132, v133
  s_waitcnt lgkmcnt(3)
  v_mfma_f32_32x32x16_bf16 v[96:111], v[156:159], v[120:123], v[96:111]
  v_xor_b32 v4, 96, v160
  ds_read_b128 v[156:159], v4
  v_sub_f32 v134, v134, v0
  v_sub_f32 v135, v135, v0
  v_exp_f32 v134, v134
  v_exp_f32 v135, v135
  v_add_f32 v13, v13, v134
  v_add_f32 v14, v14, v135
  v_cvt_pk_bf16_f32 v131, v134, v135
  s_mov_b32 s24, s38
  s_add_u32 s38, s38, 32768
  s_cmp_eq_u32 s38, 163840
  s_cselect_b32 s38, 0, s38
  s_add_u32 s73, s73, 1
  s_setprio 1
  v_add_u32 v5, s24, v11
  s_waitcnt lgkmcnt(3)
  v_mfma_f32_32x32x16_bf16 v[112:127], v[144:147], v[16:19], 0
  v_xor_b32 v3, 128, v160
  ds_read_b128 v[144:147], v3
  v_sub_f32 v136, v136, v0
  v_sub_f32 v137, v137, v0
  v_exp_f32 v136, v136
  v_exp_f32 v137, v137
  s_waitcnt lgkmcnt(3)
  v_mfma_f32_32x32x16_bf16 v[112:127], v[148:151], v[20:23], v[112:127]
  v_xor_b32 v4, 160, v160
  ds_read_b128 v[148:151], v4
  v_add_f32 v13, v13, v136
  v_add_f32 v14, v14, v137
  v_cvt_pk_bf16_f32 v136, v136, v137
  s_waitcnt lgkmcnt(3)
  v_mfma_f32_32x32x16_bf16 v[112:127], v[152:155], v[24:27], v[112:127]
  v_xor_b32 v3, 192, v160
  ds_read_b128 v[152:155], v3
  v_sub_f32 v138, v138, v0
  v_sub_f32 v139, v139, v0
  v_exp_f32 v138, v138
  v_exp_f32 v139, v139
  s_waitcnt lgkmcnt(3)
  v_mfma_f32_32x32x16_bf16 v[112:127], v[156:159], v[28:31], v[112:127]
  v_xor_b32 v4, 224, v160
  ds_read_b128 v[156:159], v4
  v_add_f32 v13, v13, v138
  v_add_f32 v14, v14, v139
  v_cvt_pk_bf16_f32 v137, v138, v139
  s_barrier
  s_sub_u32 s35, s28, 8
  s_mul_i32 s34, s35, 5120
  s_add_u32 s34, s34, 65536
  s_add_u32 s35, s35, 4
  s_mul_i32 s35, s35, 40960
  s_mul_i32 s36, s31, 327680
  s_add_u32 s35, s35, s36
  s_mul_i32 s36, s30, 160
  s_add_u32 s35, s35, s36
  s_mov_b32 s37, 6554
  v_add_u32 v162, 0, v1
  v_mul_lo_u32 v163, v162, s37
  v_lshrrev_b32 v163, 16, v163
  v_mul_u32_u24 v166, 10, v163
  v_sub_u32 v166, v162, v166
  v_mul_u32_u24 v163, 1280, v163
  v_lshl_add_u32 v163, v166, 4, v163
  s_add_u32 m0, s34, 0
  s_nop 0
  buffer_load_dwordx4 v163, s[16:19], s35 offen lds
  v_add_u32 v162, 64, v1
  v_mul_lo_u32 v163, v162, s37
  v_lshrrev_b32 v163, 16, v163
  v_mul_u32_u24 v166, 10, v163
  v_sub_u32 v166, v162, v166
  v_mul_u32_u24 v163, 1280, v163
  v_lshl_add_u32 v163, v166, 4, v163
  s_add_u32 m0, s34, 1024
  s_nop 0
  buffer_load_dwordx4 v163, s[16:19], s35 offen lds
  v_add_u32 v162, 128, v1
  v_mul_lo_u32 v163, v162, s37
  v_lshrrev_b32 v163, 16, v163
  v_mul_u32_u24 v166, 10, v163
  v_sub_u32 v166, v162, v166
  v_mul_u32_u24 v163, 1280, v163
  v_lshl_add_u32 v163, v166, 4, v163
  s_add_u32 m0, s34, 2048
  s_nop 0
  buffer_load_dwordx4 v163, s[16:19], s35 offen lds
  v_add_u32 v162, 192, v1
  v_mul_lo_u32 v163, v162, s37
  v_lshrrev_b32 v163, 16, v163
  v_mul_u32_u24 v166, 10, v163
  v_sub_u32 v166, v162, v166
  v_mul_u32_u24 v163, 1280, v163
  v_lshl_add_u32 v163, v166, 4, v163
  s_add_u32 m0, s34, 3072
  s_nop 0
  buffer_load_dwordx4 v163, s[16:19], s35 offen lds
  v_add_u32 v162, 256, v1
  v_mul_lo_u32 v163, v162, s37
  v_lshrrev_b32 v163, 16, v163
  v_mul_u32_u24 v166, 10, v163
  v_sub_u32 v166, v162, v166
  v_mul_u32_u24 v163, 1280, v163
  v_lshl_add_u32 v163, v166, 4, v163
  s_add_u32 m0, s34, 4096
  s_nop 0
  buffer_load_dwordx4 v163, s[16:19], s35 offen lds
  s_waitcnt lgkmcnt(3)
  v_mfma_f32_32x32x16_bf16 v[112:127], v[144:147], v[32:35], v[112:127]
  ds_read_b64_tr_b16 v[144:145], v5 offset:0
  ds_read_b64_tr_b16 v[146:147], v5 offset:2048
  v_sub_f32 v140, v140, v0
  v_sub_f32 v141, v141, v0
  v_exp_f32 v140, v140
  v_exp_f32 v141, v141
  s_waitcnt lgkmcnt(4)
  v_mfma_f32_32x32x16_bf16 v[112:127], v[148:151], v[36:39], v[112:127]
  ds_read_b64_tr_b16 v[148:149], v5 offset:256
  ds_read_b64_tr_b16 v[150:151], v5 offset:2304
  v_add_f32 v13, v13, v140
  v_add_f32 v14, v14, v141
  v_cvt_pk_bf16_f32 v138, v140, v141
  s_waitcnt lgkmcnt(5)
  v_mfma_f32_32x32x16_bf16 v[112:127], v[152:155], v[40:43], v[112:127]
  ds_read_b64_tr_b16 v[152:153], v5 offset:512
  ds_read_b64_tr_b16 v[154:155], v5 offset:2560
  v_sub_f32 v142, v142, v0
  v_sub_f32 v143, v143, v0
  v_exp_f32 v142, v142
  v_exp_f32 v143, v143
  s_waitcnt lgkmcnt(6)
  v_mfma_f32_32x32x16_bf16 v[112:127], v[156:159], v[44:47], v[112:127]
  ds_read_b64_tr_b16 v[156:157], v5 offset:768
  ds_read_b64_tr_b16 v[158:159], v5 offset:2816
  v_add_f32 v13, v13, v142
  v_add_f32 v14, v14, v143
  v_cvt_pk_bf16_f32 v139, v142, v143
  v_add_f32 v13, v13, v14
  v_cmp_nge_f32 vcc, 0x49800000, v13
  s_nop 0
  s_cbranch_vccnz K1_A2T13_SLOW
K1_A2T13_CONT:
  v_add_f32 v12, v12, v13
  v_add_u32 v160, s38, v10
  s_waitcnt lgkmcnt(6)
  v_mfma_f32_32x32x16_bf16 v[48:63], v[144:147], v[128:131], v[48:63]
  ds_read_b64_tr_b16 v[144:145], v5 offset:4096
  ds_read_b64_tr_b16 v[146:147], v5 offset:6144
  s_waitcnt lgkmcnt(6)
  v_mfma_f32_32x32x16_bf16 v[64:79], v[148:151], v[128:131], v[64:79]
  ds_read_b64_tr_b16 v[148:149], v5 offset:4352
  ds_read_b64_tr_b16 v[150:151], v5 offset:6400
  v_sub_f32 v112, v112, v0
  v_sub_f32 v113, v113, v0
  v_exp_f32 v112, v112
  v_exp_f32 v113, v113
  s_waitcnt lgkmcnt(6)
  v_mfma_f32_32x32x16_bf16 v[80:95], v[152:155], v[128:131], v[80:95]
  ds_read_b64_tr_b16 v[152:153], v5 offset:4608
  ds_read_b64_tr_b16 v[154:155], v5 offset:6656
  v_add_f32 v13, v112, v113
  v_cvt_pk_bf16_f32 v112, v112, v113
  s_waitcnt lgkmcnt(6)
  v_mfma_f32_32x32x16_bf16 v[96:111], v[156:159], v[128:131], v[96:111]
  ds_read_b64_tr_b16 v[156:157], v5 offset:4864
  ds_read_b64_tr_b16 v[158:159], v5 offset:6912
  v_sub_f32 v114, v114, v0
  v_sub_f32 v115, v115, v0
  v_exp_f32 v114, v114
  v_exp_f32 v115, v115
  s_waitcnt lgkmcnt(6)
  v_mfma_f32_32x32x16_bf16 v[48:63], v[144:147], v[136:139], v[48:63]
  ds_read_b128 v[144:147], v160
  v_add_f32 v14, v114, v115
  v_cvt_pk_bf16_f32 v113, v114, v115
  s_waitcnt lgkmcnt(5)
  v_mfma_f32_32x32x16_bf16 v[64:79], v[148:151], v[136:139], v[64:79]
  v_xor_b32 v4, 32, v160
  ds_read_b128 v[148:151], v4
  v_sub_f32 v116, v116, v0
  v_sub_f32 v117, v117, v0
  v_exp_f32 v116, v116
  v_exp_f32 v117, v117
  s_waitcnt lgkmcnt(4)
  v_mfma_f32_32x32x16_bf16 v[80:95], v[152:155], v[136:139], v[80:95]
  v_xor_b32 v3, 64, v160
  ds_read_b128 v[152:155], v3
  v_add_f32 v13, v13, v116
  v_add_f32 v14, v14, v117
  v_cvt_pk_bf16_f32 v114, v116, v117
  s_waitcnt lgkmcnt(3)
  v_mfma_f32_32x32x16_bf16 v[96:111], v[156:159], v[136:139], v[96:111]
  v_xor_b32 v4, 96, v160
  ds_read_b128 v[156:159], v4
  v_sub_f32 v118, v118, v0
  v_sub_f32 v119, v119, v0
  v_exp_f32 v118, v118
  v_exp_f32 v119, v119
  v_add_f32 v13, v13, v118
  v_add_f32 v14, v14, v119
  v_cvt_pk_bf16_f32 v115, v118, v119
  s_mov_b32 s24, s38
  s_add_u32 s38, s38, 32768
  s_cmp_eq_u32 s38, 163840
  s_cselect_b32 s38, 0, s38
  s_add_u32 s73, s73, 1
  s_setprio 1
  v_add_u32 v5, s24, v11
  s_waitcnt lgkmcnt(3)
  v_mfma_f32_32x32x16_bf16 v[128:143], v[144:147], v[16:19], 0
  v_xor_b32 v3, 128, v160
  ds_read_b128 v[144:147], v3
  v_sub_f32 v120, v120, v0
  v_sub_f32 v121, v121, v0
  v_exp_f32 v120, v120
  v_exp_f32 v121, v121
  s_waitcnt lgkmcnt(3)
  v_mfma_f32_32x32x16_bf16 v[128:143], v[148:151], v[20:23], v[128:143]
  v_xor_b32 v4, 160, v160
  ds_read_b128 v[148:151], v4
  v_add_f32 v13, v13, v120
  v_add_f32 v14, v14, v121
  v_cvt_pk_bf16_f32 v120, v120, v121
  s_waitcnt lgkmcnt(3)
  v_mfma_f32_32x32x16_bf16 v[128:143], v[152:155], v[24:27], v[128:143]
  v_xor_b32 v3, 192, v160
  ds_read_b128 v[152:155], v3
  v_sub_f32 v122, v122, v0
  v_sub_f32 v123, v123, v0
  v_exp_f32 v122, v122
  v_exp_f32 v123, v123
  s_waitcnt lgkmcnt(3)
  v_mfma_f32_32x32x16_bf16 v[128:143], v[156:159], v[28:31], v[128:143]
  v_xor_b32 v4, 224, v160
  ds_read_b128 v[156:159], v4
  v_add_f32 v13, v13, v122
  v_add_f32 v14, v14, v123
  v_cvt_pk_bf16_f32 v121, v122, v123
  s_waitcnt vmcnt(0)
  s_barrier
  s_waitcnt lgkmcnt(3)
  v_mfma_f32_32x32x16_bf16 v[128:143], v[144:147], v[32:35], v[128:143]
  ds_read_b64_tr_b16 v[144:145], v5 offset:0
  ds_read_b64_tr_b16 v[146:147], v5 offset:2048
  v_sub_f32 v124, v124, v0
  v_sub_f32 v125, v125, v0
  v_exp_f32 v124, v124
  v_exp_f32 v125, v125
  s_waitcnt lgkmcnt(4)
  v_mfma_f32_32x32x16_bf16 v[128:143], v[148:151], v[36:39], v[128:143]
  ds_read_b64_tr_b16 v[148:149], v5 offset:256
  ds_read_b64_tr_b16 v[150:151], v5 offset:2304
  v_add_f32 v13, v13, v124
  v_add_f32 v14, v14, v125
  v_cvt_pk_bf16_f32 v122, v124, v125
  s_waitcnt lgkmcnt(5)
  v_mfma_f32_32x32x16_bf16 v[128:143], v[152:155], v[40:43], v[128:143]
  ds_read_b64_tr_b16 v[152:153], v5 offset:512
  ds_read_b64_tr_b16 v[154:155], v5 offset:2560
  v_sub_f32 v126, v126, v0
  v_sub_f32 v127, v127, v0
  v_exp_f32 v126, v126
  v_exp_f32 v127, v127
  s_waitcnt lgkmcnt(6)
  v_mfma_f32_32x32x16_bf16 v[128:143], v[156:159], v[44:47], v[128:143]
  ds_read_b64_tr_b16 v[156:157], v5 offset:768
  ds_read_b64_tr_b16 v[158:159], v5 offset:2816
  v_add_f32 v13, v13, v126
  v_add_f32 v14, v14, v127
  v_cvt_pk_bf16_f32 v123, v126, v127
  v_add_f32 v13, v13, v14
  v_cmp_nge_f32 vcc, 0x49800000, v13
  s_nop 0
  s_cbranch_vccnz K1_A2T14_SLOW
K1_A2T14_CONT:
  v_add_f32 v12, v12, v13
  s_waitcnt lgkmcnt(6)
  v_mfma_f32_32x32x16_bf16 v[48:63], v[144:147], v[112:115], v[48:63]
  ds_read_b64_tr_b16 v[144:145], v5 offset:4096
  ds_read_b64_tr_b16 v[146:147], v5 offset:6144
  s_waitcnt lgkmcnt(6)
  v_mfma_f32_32x32x16_bf16 v[64:79], v[148:151], v[112:115], v[64:79]
  ds_read_b64_tr_b16 v[148:149], v5 offset:4352
  ds_read_b64_tr_b16 v[150:151], v5 offset:6400
  v_sub_f32 v128, v128, v0
  v_sub_f32 v129, v129, v0
  v_exp_f32 v128, v128
  v_exp_f32 v129, v129
  s_waitcnt lgkmcnt(6)
  v_mfma_f32_32x32x16_bf16 v[80:95], v[152:155], v[112:115], v[80:95]
  ds_read_b64_tr_b16 v[152:153], v5 offset:4608
  ds_read_b64_tr_b16 v[154:155], v5 offset:6656
  v_add_f32 v13, v128, v129
  v_cvt_pk_bf16_f32 v128, v128, v129
  s_waitcnt lgkmcnt(6)
  v_mfma_f32_32x32x16_bf16 v[96:111], v[156:159], v[112:115], v[96:111]
  ds_read_b64_tr_b16 v[156:157], v5 offset:4864
  ds_read_b64_tr_b16 v[158:159], v5 offset:6912
  v_sub_f32 v130, v130, v0
  v_sub_f32 v131, v131, v0
  v_exp_f32 v130, v130
  v_exp_f32 v131, v131
  s_waitcnt lgkmcnt(6)
  v_mfma_f32_32x32x16_bf16 v[48:63], v[144:147], v[120:123], v[48:63]
  v_add_f32 v14, v130, v131
  v_cvt_pk_bf16_f32 v129, v130, v131
  s_waitcnt lgkmcnt(4)
  v_mfma_f32_32x32x16_bf16 v[64:79], v[148:151], v[120:123], v[64:79]
  v_sub_f32 v132, v132, v0
  v_sub_f32 v133, v133, v0
  v_exp_f32 v132, v132
  v_exp_f32 v133, v133
  s_waitcnt lgkmcnt(2)
  v_mfma_f32_32x32x16_bf16 v[80:95], v[152:155], v[120:123], v[80:95]
  v_add_f32 v13, v13, v132
  v_add_f32 v14, v14, v133
  v_cvt_pk_bf16_f32 v130, v132, v133
  s_waitcnt lgkmcnt(0)
  v_mfma_f32_32x32x16_bf16 v[96:111], v[156:159], v[120:123], v[96:111]
  v_sub_f32 v134, v134, v0
  v_sub_f32 v135, v135, v0
  v_exp_f32 v134, v134
  v_exp_f32 v135, v135
  v_add_f32 v13, v13, v134
  v_add_f32 v14, v14, v135
  v_cvt_pk_bf16_f32 v131, v134, v135
  s_mov_b32 s24, s38
  s_add_u32 s38, s38, 32768
  s_cmp_eq_u32 s38, 163840
  s_cselect_b32 s38, 0, s38
  s_add_u32 s73, s73, 1
  s_setprio 1
  v_add_u32 v5, s24, v11
  v_sub_f32 v136, v136, v0
  v_sub_f32 v137, v137, v0
  v_exp_f32 v136, v136
  v_exp_f32 v137, v137
  v_add_f32 v13, v13, v136
  v_add_f32 v14, v14, v137
  v_cvt_pk_bf16_f32 v136, v136, v137
  v_sub_f32 v138, v138, v0
  v_sub_f32 v139, v139, v0
  v_exp_f32 v138, v138
  v_exp_f32 v139, v139
  v_add_f32 v13, v13, v138
  v_add_f32 v14, v14, v139
  v_cvt_pk_bf16_f32 v137, v138, v139
  s_barrier
  ds_read_b64_tr_b16 v[144:145], v5 offset:0
  ds_read_b64_tr_b16 v[146:147], v5 offset:2048
  v_sub_f32 v140, v140, v0
  v_sub_f32 v141, v141, v0
  v_exp_f32 v140, v140
  v_exp_f32 v141, v141
  ds_read_b64_tr_b16 v[148:149], v5 offset:256
  ds_read_b64_tr_b16 v[150:151], v5 offset:2304
  v_add_f32 v13, v13, v140
  v_add_f32 v14, v14, v141
  v_cvt_pk_bf16_f32 v138, v140, v141
  ds_read_b64_tr_b16 v[152:153], v5 offset:512
  ds_read_b64_tr_b16 v[154:155], v5 offset:2560
  v_sub_f32 v142, v142, v0
  v_sub_f32 v143, v143, v0
  v_exp_f32 v142, v142
  v_exp_f32 v143, v143
  ds_read_b64_tr_b16 v[156:157], v5 offset:768
  ds_read_b64_tr_b16 v[158:159], v5 offset:2816
  v_add_f32 v13, v13, v142
  v_add_f32 v14, v14, v143
  v_cvt_pk_bf16_f32 v139, v142, v143
  v_add_f32 v13, v13, v14
  v_cmp_nge_f32 vcc, 0x49800000, v13
  s_nop 0
  s_cbranch_vccnz K1_A2T15_SLOW
K1_A2T15_CONT:
  v_add_f32 v12, v12, v13
  s_waitcnt lgkmcnt(6)
  v_mfma_f32_32x32x16_bf16 v[48:63], v[144:147], v[128:131], v[48:63]
  ds_read_b64_tr_b16 v[144:145], v5 offset:4096
  ds_read_b64_tr_b16 v[146:147], v5 offset:6144
  s_waitcnt lgkmcnt(6)
  v_mfma_f32_32x32x16_bf16 v[64:79], v[148:151], v[128:131], v[64:79]
  ds_read_b64_tr_b16 v[148:149], v5 offset:4352
  ds_read_b64_tr_b16 v[150:151], v5 offset:6400
  s_waitcnt lgkmcnt(6)
  v_mfma_f32_32x32x16_bf16 v[80:95], v[152:155], v[128:131], v[80:95]
  ds_read_b64_tr_b16 v[152:153], v5 offset:4608
  ds_read_b64_tr_b16 v[154:155], v5 offset:6656
  s_waitcnt lgkmcnt(6)
  v_mfma_f32_32x32x16_bf16 v[96:111], v[156:159], v[128:131], v[96:111]
  ds_read_b64_tr_b16 v[156:157], v5 offset:4864
  ds_read_b64_tr_b16 v[158:159], v5 offset:6912
  s_waitcnt lgkmcnt(6)
  v_mfma_f32_32x32x16_bf16 v[48:63], v[144:147], v[136:139], v[48:63]
  s_waitcnt lgkmcnt(4)
  v_mfma_f32_32x32x16_bf16 v[64:79], v[148:151], v[136:139], v[64:79]
  s_waitcnt lgkmcnt(2)
  v_mfma_f32_32x32x16_bf16 v[80:95], v[152:155], v[136:139], v[80:95]
  s_waitcnt lgkmcnt(0)
  v_mfma_f32_32x32x16_bf16 v[96:111], v[156:159], v[136:139], v[96:111]
  s_mov_b32 s24, s38
  s_add_u32 s38, s38, 32768
  s_cmp_eq_u32 s38, 163840
  s_cselect_b32 s38, 0, s38
  s_add_u32 s73, s73, 1
  s_branch K1_EPI
K1_A2L0_SLOW:
  s_waitcnt lgkmcnt(0)
  v_and_b32 v14, 31, v1
  v_lshlrev_b32 v14, 8, v14
  v_lshrrev_b32 v15, 5, v1
  v_lshl_add_u32 v14, v15, 4, v14
  s_and_b32 s34, s73, 15
  s_lshl_b32 s34, s34, 13
  s_lshl_b32 s35, s32, 17
  s_add_u32 s34, s34, s35
  buffer_load_dwordx4 v[144:147], v14, s[4:7], s34 offen offset:0
  buffer_load_dwordx4 v[148:151], v14, s[4:7], s34 offen offset:32
  buffer_load_dwordx4 v[152:155], v14, s[4:7], s34 offen offset:64
  buffer_load_dwordx4 v[156:159], v14, s[4:7], s34 offen offset:96
  s_waitcnt vmcnt(0)
  v_mfma_f32_32x32x16_bf16 v[112:127], v[144:147], v[16:19], 0
  v_mfma_f32_32x32x16_bf16 v[112:127], v[148:151], v[20:23], v[112:127]
  v_mfma_f32_32x32x16_bf16 v[112:127], v[152:155], v[24:27], v[112:127]
  v_mfma_f32_32x32x16_bf16 v[112:127], v[156:159], v[28:31], v[112:127]
  buffer_load_dwordx4 v[144:147], v14, s[4:7], s34 offen offset:128
  buffer_load_dwordx4 v[148:151], v14, s[4:7], s34 offen offset:160
  buffer_load_dwordx4 v[152:155], v14, s[4:7], s34 offen offset:192
  buffer_load_dwordx4 v[156:159], v14, s[4:7], s34 offen offset:224
  s_waitcnt vmcnt(0)
  v_mfma_f32_32x32x16_bf16 v[112:127], v[144:147], v[32:35], v[112:127]
  v_mfma_f32_32x32x16_bf16 v[112:127], v[148:151], v[36:39], v[112:127]
  v_mfma_f32_32x32x16_bf16 v[112:127], v[152:155], v[40:43], v[112:127]
  v_mfma_f32_32x32x16_bf16 v[112:127], v[156:159], v[44:47], v[112:127]
  s_nop 11
  v_max3_f32 v14, v112, v113, v114
  v_max3_f32 v14, v14, v115, v116
  v_max3_f32 v14, v14, v117, v118
  v_max3_f32 v14, v14, v119, v120
  v_max3_f32 v14, v14, v121, v122
  v_max3_f32 v14, v14, v123, v124
  v_max3_f32 v14, v14, v125, v126
  v_max_f32 v14, v14, v127
  v_mov_b32 v15, v14
  s_nop 1
  v_permlane32_swap_b32 v14, v15
  v_max_f32 v14, v14, v15
  v_max_f32 v14, v14, v0
  v_sub_f32 v15, v0, v14
  v_exp_f32 v15, v15
  v_mov_b32 v0, v14
  v_mul_f32 v12, v12, v15
  v_mul_f32 v48, v48, v15
  v_mul_f32 v49, v49, v15
  v_mul_f32 v50, v50, v15
  v_mul_f32 v51, v51, v15
  v_mul_f32 v52, v52, v15
  v_mul_f32 v53, v53, v15
  v_mul_f32 v54, v54, v15
  v_mul_f32 v55, v55, v15
  v_mul_f32 v56, v56, v15
  v_mul_f32 v57, v57, v15
  v_mul_f32 v58, v58, v15
  v_mul_f32 v59, v59, v15
  v_mul_f32 v60, v60, v15
  v_mul_f32 v61, v61, v15
  v_mul_f32 v62, v62, v15
  v_mul_f32 v63, v63, v15
  v_mul_f32 v64, v64, v15
  v_mul_f32 v65, v65, v15
  v_mul_f32 v66, v66, v15
  v_mul_f32 v67, v67, v15
  v_mul_f32 v68, v68, v15
  v_mul_f32 v69, v69, v15
  v_mul_f32 v70, v70, v15
  v_mul_f32 v71, v71, v15
  v_mul_f32 v72, v72, v15
  v_mul_f32 v73, v73, v15
  v_mul_f32 v74, v74, v15
  v_mul_f32 v75, v75, v15
  v_mul_f32 v76, v76, v15
  v_mul_f32 v77, v77, v15
  v_mul_f32 v78, v78, v15
  v_mul_f32 v79, v79, v15
  v_mul_f32 v80, v80, v15
  v_mul_f32 v81, v81, v15
  v_mul_f32 v82, v82, v15
  v_mul_f32 v83, v83, v15
  v_mul_f32 v84, v84, v15
  v_mul_f32 v85, v85, v15
  v_mul_f32 v86, v86, v15
  v_mul_f32 v87, v87, v15
  v_mul_f32 v88, v88, v15
  v_mul_f32 v89, v89, v15
  v_mul_f32 v90, v90, v15
  v_mul_f32 v91, v91, v15
  v_mul_f32 v92, v92, v15
  v_mul_f32 v93, v93, v15
  v_mul_f32 v94, v94, v15
  v_mul_f32 v95, v95, v15
  v_mul_f32 v96, v96, v15
  v_mul_f32 v97, v97, v15
  v_mul_f32 v98, v98, v15
  v_mul_f32 v99, v99, v15
  v_mul_f32 v100, v100, v15
  v_mul_f32 v101, v101, v15
  v_mul_f32 v102, v102, v15
  v_mul_f32 v103, v103, v15
  v_mul_f32 v104, v104, v15
  v_mul_f32 v105, v105, v15
  v_mul_f32 v106, v106, v15
  v_mul_f32 v107, v107, v15
  v_mul_f32 v108, v108, v15
  v_mul_f32 v109, v109, v15
  v_mul_f32 v110, v110, v15
  v_mul_f32 v111, v111, v15
  ds_read_b64_tr_b16 v[144:145], v5 offset:0
  ds_read_b64_tr_b16 v[146:147], v5 offset:2048
  ds_read_b64_tr_b16 v[148:149], v5 offset:256
  ds_read_b64_tr_b16 v[150:151], v5 offset:2304
  ds_read_b64_tr_b16 v[152:153], v5 offset:512
  ds_read_b64_tr_b16 v[154:155], v5 offset:2560
  ds_read_b64_tr_b16 v[156:157], v5 offset:768
  ds_read_b64_tr_b16 v[158:159], v5 offset:2816
  v_sub_f32 v112, v112, v0
  v_sub_f32 v113, v113, v0
  v_exp_f32 v112, v112
  v_exp_f32 v113, v113
  v_sub_f32 v114, v114, v0
  v_sub_f32 v115, v115, v0
  v_exp_f32 v114, v114
  v_exp_f32 v115, v115
  v_sub_f32 v116, v116, v0
  v_sub_f32 v117, v117, v0
  v_exp_f32 v116, v116
  v_exp_f32 v117, v117
  v_sub_f32 v118, v118, v0
  v_sub_f32 v119, v119, v0
  v_exp_f32 v118, v118
  v_exp_f32 v119, v119
  v_sub_f32 v120, v120, v0
  v_sub_f32 v121, v121, v0
  v_exp_f32 v120, v120
  v_exp_f32 v121, v121
  v_sub_f32 v122, v122, v0
  v_sub_f32 v123, v123, v0
  v_exp_f32 v122, v122
  v_exp_f32 v123, v123
  v_sub_f32 v124, v124, v0
  v_sub_f32 v125, v125, v0
  v_exp_f32 v124, v124
  v_exp_f32 v125, v125
  v_sub_f32 v126, v126, v0
  v_sub_f32 v127, v127, v0
  v_exp_f32 v126, v126
  v_exp_f32 v127, v127
  v_add_f32 v13, v112, v113
  v_cvt_pk_bf16_f32 v112, v112, v113
  v_add_f32 v14, v114, v115
  v_cvt_pk_bf16_f32 v113, v114, v115
  v_add_f32 v13, v13, v116
  v_add_f32 v14, v14, v117
  v_cvt_pk_bf16_f32 v114, v116, v117
  v_add_f32 v13, v13, v118
  v_add_f32 v14, v14, v119
  v_cvt_pk_bf16_f32 v115, v118, v119
  v_add_f32 v13, v13, v120
  v_add_f32 v14, v14, v121
  v_cvt_pk_bf16_f32 v120, v120, v121
  v_add_f32 v13, v13, v122
  v_add_f32 v14, v14, v123
  v_cvt_pk_bf16_f32 v121, v122, v123
  v_add_f32 v13, v13, v124
  v_add_f32 v14, v14, v125
  v_cvt_pk_bf16_f32 v122, v124, v125
  v_add_f32 v13, v13, v126
  v_add_f32 v14, v14, v127
  v_cvt_pk_bf16_f32 v123, v126, v127
  v_add_f32 v13, v13, v14
  s_nop 0
  s_branch K1_A2L0_CONT
K1_A2L1_SLOW:
  s_waitcnt lgkmcnt(0)
  v_and_b32 v14, 31, v1
  v_lshlrev_b32 v14, 8, v14
  v_lshrrev_b32 v15, 5, v1
  v_lshl_add_u32 v14, v15, 4, v14
  s_and_b32 s34, s73, 15
  s_lshl_b32 s34, s34, 13
  s_lshl_b32 s35, s32, 17
  s_add_u32 s34, s34, s35
  buffer_load_dwordx4 v[144:147], v14, s[4:7], s34 offen offset:0
  buffer_load_dwordx4 v[148:151], v14, s[4:7], s34 offen offset:32
  buffer_load_dwordx4 v[152:155], v14, s[4:7], s34 offen offset:64
  buffer_load_dwordx4 v[156:159], v14, s[4:7], s34 offen offset:96
  s_waitcnt vmcnt(0)
  v_mfma_f32_32x32x16_bf16 v[128:143], v[144:147], v[16:19], 0
  v_mfma_f32_32x32x16_bf16 v[128:143], v[148:151], v[20:23], v[128:143]
  v_mfma_f32_32x32x16_bf16 v[128:143], v[152:155], v[24:27], v[128:143]
  v_mfma_f32_32x32x16_bf16 v[128:143], v[156:159], v[28:31], v[128:143]
  buffer_load_dwordx4 v[144:147], v14, s[4:7], s34 offen offset:128
  buffer_load_dwordx4 v[148:151], v14, s[4:7], s34 offen offset:160
  buffer_load_dwordx4 v[152:155], v14, s[4:7], s34 offen offset:192
  buffer_load_dwordx4 v[156:159], v14, s[4:7], s34 offen offset:224
  s_waitcnt vmcnt(0)
  v_mfma_f32_32x32x16_bf16 v[128:143], v[144:147], v[32:35], v[128:143]
  v_mfma_f32_32x32x16_bf16 v[128:143], v[148:151], v[36:39], v[128:143]
  v_mfma_f32_32x32x16_bf16 v[128:143], v[152:155], v[40:43], v[128:143]
  v_mfma_f32_32x32x16_bf16 v[128:143], v[156:159], v[44:47], v[128:143]
  s_nop 11
  v_max3_f32 v14, v128, v129, v130
  v_max3_f32 v14, v14, v131, v132
  v_max3_f32 v14, v14, v133, v134
  v_max3_f32 v14, v14, v135, v136
  v_max3_f32 v14, v14, v137, v138
  v_max3_f32 v14, v14, v139, v140
  v_max3_f32 v14, v14, v141, v142
  v_max_f32 v14, v14, v143
  v_mov_b32 v15, v14
  s_nop 1
  v_permlane32_swap_b32 v14, v15
  v_max_f32 v14, v14, v15
  v_max_f32 v14, v14, v0
  v_sub_f32 v15, v0, v14
  v_exp_f32 v15, v15
  v_mov_b32 v0, v14
  v_mul_f32 v12, v12, v15
  v_mul_f32 v48, v48, v15
  v_mul_f32 v49, v49, v15
  v_mul_f32 v50, v50, v15
  v_mul_f32 v51, v51, v15
  v_mul_f32 v52, v52, v15
  v_mul_f32 v53, v53, v15
  v_mul_f32 v54, v54, v15
  v_mul_f32 v55, v55, v15
  v_mul_f32 v56, v56, v15
  v_mul_f32 v57, v57, v15
  v_mul_f32 v58, v58, v15
  v_mul_f32 v59, v59, v15
  v_mul_f32 v60, v60, v15
  v_mul_f32 v61, v61, v15
  v_mul_f32 v62, v62, v15
  v_mul_f32 v63, v63, v15
  v_mul_f32 v64, v64, v15
  v_mul_f32 v65, v65, v15
  v_mul_f32 v66, v66, v15
  v_mul_f32 v67, v67, v15
  v_mul_f32 v68, v68, v15
  v_mul_f32 v69, v69, v15
  v_mul_f32 v70, v70, v15
  v_mul_f32 v71, v71, v15
  v_mul_f32 v72, v72, v15
  v_mul_f32 v73, v73, v15
  v_mul_f32 v74, v74, v15
  v_mul_f32 v75, v75, v15
  v_mul_f32 v76, v76, v15
  v_mul_f32 v77, v77, v15
  v_mul_f32 v78, v78, v15
  v_mul_f32 v79, v79, v15
  v_mul_f32 v80, v80, v15
  v_mul_f32 v81, v81, v15
  v_mul_f32 v82, v82, v15
  v_mul_f32 v83, v83, v15
  v_mul_f32 v84, v84, v15
  v_mul_f32 v85, v85, v15
  v_mul_f32 v86, v86, v15
  v_mul_f32 v87, v87, v15
  v_mul_f32 v88, v88, v15
  v_mul_f32 v89, v89, v15
  v_mul_f32 v90, v90, v15
  v_mul_f32 v91, v91, v15
  v_mul_f32 v92, v92, v15
  v_mul_f32 v93, v93, v15
  v_mul_f32 v94, v94, v15
  v_mul_f32 v95, v95, v15
  v_mul_f32 v96, v96, v15
  v_mul_f32 v97, v97, v15
  v_mul_f32 v98, v98, v15
  v_mul_f32 v99, v99, v15
  v_mul_f32 v100, v100, v15
  v_mul_f32 v101, v101, v15
  v_mul_f32 v102, v102, v15
  v_mul_f32 v103, v103, v15
  v_mul_f32 v104, v104, v15
  v_mul_f32 v105, v105, v15
  v_mul_f32 v106, v106, v15
  v_mul_f32 v107, v107, v15
  v_mul_f32 v108, v108, v15
  v_mul_f32 v109, v109, v15
  v_mul_f32 v110, v110, v15
  v_mul_f32 v111, v111, v15
  ds_read_b64_tr_b16 v[144:145], v5 offset:0
  ds_read_b64_tr_b16 v[146:147], v5 offset:2048
  ds_read_b64_tr_b16 v[148:149], v5 offset:256
  ds_read_b64_tr_b16 v[150:151], v5 offset:2304
  ds_read_b64_tr_b16 v[152:153], v5 offset:512
  ds_read_b64_tr_b16 v[154:155], v5 offset:2560
  ds_read_b64_tr_b16 v[156:157], v5 offset:768
  ds_read_b64_tr_b16 v[158:159], v5 offset:2816
  v_sub_f32 v128, v128, v0
  v_sub_f32 v129, v129, v0
  v_exp_f32 v128, v128
  v_exp_f32 v129, v129
  v_sub_f32 v130, v130, v0
  v_sub_f32 v131, v131, v0
  v_exp_f32 v130, v130
  v_exp_f32 v131, v131
  v_sub_f32 v132, v132, v0
  v_sub_f32 v133, v133, v0
  v_exp_f32 v132, v132
  v_exp_f32 v133, v133
  v_sub_f32 v134, v134, v0
  v_sub_f32 v135, v135, v0
  v_exp_f32 v134, v134
  v_exp_f32 v135, v135
  v_sub_f32 v136, v136, v0
  v_sub_f32 v137, v137, v0
  v_exp_f32 v136, v136
  v_exp_f32 v137, v137
  v_sub_f32 v138, v138, v0
  v_sub_f32 v139, v139, v0
  v_exp_f32 v138, v138
  v_exp_f32 v139, v139
  v_sub_f32 v140, v140, v0
  v_sub_f32 v141, v141, v0
  v_exp_f32 v140, v140
  v_exp_f32 v141, v141
  v_sub_f32 v142, v142, v0
  v_sub_f32 v143, v143, v0
  v_exp_f32 v142, v142
  v_exp_f32 v143, v143
  v_add_f32 v13, v128, v129
  v_cvt_pk_bf16_f32 v128, v128, v129
  v_add_f32 v14, v130, v131
  v_cvt_pk_bf16_f32 v129, v130, v131
  v_add_f32 v13, v13, v132
  v_add_f32 v14, v14, v133
  v_cvt_pk_bf16_f32 v130, v132, v133
  v_add_f32 v13, v13, v134
  v_add_f32 v14, v14, v135
  v_cvt_pk_bf16_f32 v131, v134, v135
  v_add_f32 v13, v13, v136
  v_add_f32 v14, v14, v137
  v_cvt_pk_bf16_f32 v136, v136, v137
  v_add_f32 v13, v13, v138
  v_add_f32 v14, v14, v139
  v_cvt_pk_bf16_f32 v137, v138, v139
  v_add_f32 v13, v13, v140
  v_add_f32 v14, v14, v141
  v_cvt_pk_bf16_f32 v138, v140, v141
  v_add_f32 v13, v13, v142
  v_add_f32 v14, v14, v143
  v_cvt_pk_bf16_f32 v139, v142, v143
  v_add_f32 v13, v13, v14
  s_nop 0
  s_branch K1_A2L1_CONT
K1_A2T12_SLOW:
  s_waitcnt lgkmcnt(0)
  v_and_b32 v14, 31, v1
  v_lshlrev_b32 v14, 8, v14
  v_lshrrev_b32 v15, 5, v1
  v_lshl_add_u32 v14, v15, 4, v14
  s_and_b32 s34, s73, 15
  s_lshl_b32 s34, s34, 13
  s_lshl_b32 s35, s32, 17
  s_add_u32 s34, s34, s35
  buffer_load_dwordx4 v[144:147], v14, s[4:7], s34 offen offset:0
  buffer_load_dwordx4 v[148:151], v14, s[4:7], s34 offen offset:32
  buffer_load_dwordx4 v[152:155], v14, s[4:7], s34 offen offset:64
  buffer_load_dwordx4 v[156:159], v14, s[4:7], s34 offen offset:96
  s_waitcnt vmcnt(0)
  v_mfma_f32_32x32x16_bf16 v[112:127], v[144:147], v[16:19], 0
  v_mfma_f32_32x32x16_bf16 v[112:127], v[148:151], v[20:23], v[112:127]
  v_mfma_f32_32x32x16_bf16 v[112:127], v[152:155], v[24:27], v[112:127]
  v_mfma_f32_32x32x16_bf16 v[112:127], v[156:159], v[28:31], v[112:127]
  buffer_load_dwordx4 v[144:147], v14, s[4:7], s34 offen offset:128
  buffer_load_dwordx4 v[148:151], v14, s[4:7], s34 offen offset:160
  buffer_load_dwordx4 v[152:155], v14, s[4:7], s34 offen offset:192
  buffer_load_dwordx4 v[156:159], v14, s[4:7], s34 offen offset:224
  s_waitcnt vmcnt(0)
  v_mfma_f32_32x32x16_bf16 v[112:127], v[144:147], v[32:35], v[112:127]
  v_mfma_f32_32x32x16_bf16 v[112:127], v[148:151], v[36:39], v[112:127]
  v_mfma_f32_32x32x16_bf16 v[112:127], v[152:155], v[40:43], v[112:127]
  v_mfma_f32_32x32x16_bf16 v[112:127], v[156:159], v[44:47], v[112:127]
  s_nop 11
  v_max3_f32 v14, v112, v113, v114
  v_max3_f32 v14, v14, v115, v116
  v_max3_f32 v14, v14, v117, v118
  v_max3_f32 v14, v14, v119, v120
  v_max3_f32 v14, v14, v121, v122
  v_max3_f32 v14, v14, v123, v124
  v_max3_f32 v14, v14, v125, v126
  v_max_f32 v14, v14, v127
  v_mov_b32 v15, v14
  s_nop 1
  v_permlane32_swap_b32 v14, v15
  v_max_f32 v14, v14, v15
  v_max_f32 v14, v14, v0
  v_sub_f32 v15, v0, v14
  v_exp_f32 v15, v15
  v_mov_b32 v0, v14
  v_mul_f32 v12, v12, v15
  v_mul_f32 v48, v48, v15
  v_mul_f32 v49, v49, v15
  v_mul_f32 v50, v50, v15
  v_mul_f32 v51, v51, v15
  v_mul_f32 v52, v52, v15
  v_mul_f32 v53, v53, v15
  v_mul_f32 v54, v54, v15
  v_mul_f32 v55, v55, v15
  v_mul_f32 v56, v56, v15
  v_mul_f32 v57, v57, v15
  v_mul_f32 v58, v58, v15
  v_mul_f32 v59, v59, v15
  v_mul_f32 v60, v60, v15
  v_mul_f32 v61, v61, v15
  v_mul_f32 v62, v62, v15
  v_mul_f32 v63, v63, v15
  v_mul_f32 v64, v64, v15
  v_mul_f32 v65, v65, v15
  v_mul_f32 v66, v66, v15
  v_mul_f32 v67, v67, v15
  v_mul_f32 v68, v68, v15
  v_mul_f32 v69, v69, v15
  v_mul_f32 v70, v70, v15
  v_mul_f32 v71, v71, v15
  v_mul_f32 v72, v72, v15
  v_mul_f32 v73, v73, v15
  v_mul_f32 v74, v74, v15
  v_mul_f32 v75, v75, v15
  v_mul_f32 v76, v76, v15
  v_mul_f32 v77, v77, v15
  v_mul_f32 v78, v78, v15
  v_mul_f32 v79, v79, v15
  v_mul_f32 v80, v80, v15
  v_mul_f32 v81, v81, v15
  v_mul_f32 v82, v82, v15
  v_mul_f32 v83, v83, v15
  v_mul_f32 v84, v84, v15
  v_mul_f32 v85, v85, v15
  v_mul_f32 v86, v86, v15
  v_mul_f32 v87, v87, v15
  v_mul_f32 v88, v88, v15
  v_mul_f32 v89, v89, v15
  v_mul_f32 v90, v90, v15
  v_mul_f32 v91, v91, v15
  v_mul_f32 v92, v92, v15
  v_mul_f32 v93, v93, v15
  v_mul_f32 v94, v94, v15
  v_mul_f32 v95, v95, v15
  v_mul_f32 v96, v96, v15
  v_mul_f32 v97, v97, v15
  v_mul_f32 v98, v98, v15
  v_mul_f32 v99, v99, v15
  v_mul_f32 v100, v100, v15
  v_mul_f32 v101, v101, v15
  v_mul_f32 v102, v102, v15
  v_mul_f32 v103, v103, v15
  v_mul_f32 v104, v104, v15
  v_mul_f32 v105, v105, v15
  v_mul_f32 v106, v106, v15
  v_mul_f32 v107, v107, v15
  v_mul_f32 v108, v108, v15
  v_mul_f32 v109, v109, v15
  v_mul_f32 v110, v110, v15
  v_mul_f32 v111, v111, v15
  ds_read_b64_tr_b16 v[144:145], v5 offset:0
  ds_read_b64_tr_b16 v[146:147], v5 offset:2048
  ds_read_b64_tr_b16 v[148:149], v5 offset:256
  ds_read_b64_tr_b16 v[150:151], v5 offset:2304
  ds_read_b64_tr_b16 v[152:153], v5 offset:512
  ds_read_b64_tr_b16 v[154:155], v5 offset:2560
  ds_read_b64_tr_b16 v[156:157], v5 offset:768
  ds_read_b64_tr_b16 v[158:159], v5 offset:2816
  v_sub_f32 v112, v112, v0
  v_sub_f32 v113, v113, v0
  v_exp_f32 v112, v112
  v_exp_f32 v113, v113
  v_sub_f32 v114, v114, v0
  v_sub_f32 v115, v115, v0
  v_exp_f32 v114, v114
  v_exp_f32 v115, v115
  v_sub_f32 v116, v116, v0
  v_sub_f32 v117, v117, v0
  v_exp_f32 v116, v116
  v_exp_f32 v117, v117
  v_sub_f32 v118, v118, v0
  v_sub_f32 v119, v119, v0
  v_exp_f32 v118, v118
  v_exp_f32 v119, v119
  v_sub_f32 v120, v120, v0
  v_sub_f32 v121, v121, v0
  v_exp_f32 v120, v120
  v_exp_f32 v121, v121
  v_sub_f32 v122, v122, v0
  v_sub_f32 v123, v123, v0
  v_exp_f32 v122, v122
  v_exp_f32 v123, v123
  v_sub_f32 v124, v124, v0
  v_sub_f32 v125, v125, v0
  v_exp_f32 v124, v124
  v_exp_f32 v125, v125
  v_sub_f32 v126, v126, v0
  v_sub_f32 v127, v127, v0
  v_exp_f32 v126, v126
  v_exp_f32 v127, v127
  v_add_f32 v13, v112, v113
  v_cvt_pk_bf16_f32 v112, v112, v113
  v_add_f32 v14, v114, v115
  v_cvt_pk_bf16_f32 v113, v114, v115
  v_add_f32 v13, v13, v116
  v_add_f32 v14, v14, v117
  v_cvt_pk_bf16_f32 v114, v116, v117
  v_add_f32 v13, v13, v118
  v_add_f32 v14, v14, v119
  v_cvt_pk_bf16_f32 v115, v118, v119
  v_add_f32 v13, v13, v120
  v_add_f32 v14, v14, v121
  v_cvt_pk_bf16_f32 v120, v120, v121
  v_add_f32 v13, v13, v122
  v_add_f32 v14, v14, v123
  v_cvt_pk_bf16_f32 v121, v122, v123
  v_add_f32 v13, v13, v124
  v_add_f32 v14, v14, v125
  v_cvt_pk_bf16_f32 v122, v124, v125
  v_add_f32 v13, v13, v126
  v_add_f32 v14, v14, v127
  v_cvt_pk_bf16_f32 v123, v126, v127
  v_add_f32 v13, v13, v14
  s_nop 0
  s_branch K1_A2T12_CONT
K1_A2T13_SLOW:
  s_waitcnt lgkmcnt(0)
  v_and_b32 v14, 31, v1
  v_lshlrev_b32 v14, 8, v14
  v_lshrrev_b32 v15, 5, v1
  v_lshl_add_u32 v14, v15, 4, v14
  s_and_b32 s34, s73, 15
  s_lshl_b32 s34, s34, 13
  s_lshl_b32 s35, s32, 17
  s_add_u32 s34, s34, s35
  buffer_load_dwordx4 v[144:147], v14, s[4:7], s34 offen offset:0
  buffer_load_dwordx4 v[148:151], v14, s[4:7], s34 offen offset:32
  buffer_load_dwordx4 v[152:155], v14, s[4:7], s34 offen offset:64
  buffer_load_dwordx4 v[156:159], v14, s[4:7], s34 offen offset:96
  s_waitcnt vmcnt(0)
  v_mfma_f32_32x32x16_bf16 v[128:143], v[144:147], v[16:19], 0
  v_mfma_f32_32x32x16_bf16 v[128:143], v[148:151], v[20:23], v[128:143]
  v_mfma_f32_32x32x16_bf16 v[128:143], v[152:155], v[24:27], v[128:143]
  v_mfma_f32_32x32x16_bf16 v[128:143], v[156:159], v[28:31], v[128:143]
  buffer_load_dwordx4 v[144:147], v14, s[4:7], s34 offen offset:128
  buffer_load_dwordx4 v[148:151], v14, s[4:7], s34 offen offset:160
  buffer_load_dwordx4 v[152:155], v14, s[4:7], s34 offen offset:192
  buffer_load_dwordx4 v[156:159], v14, s[4:7], s34 offen offset:224
  s_waitcnt vmcnt(0)
  v_mfma_f32_32x32x16_bf16 v[128:143], v[144:147], v[32:35], v[128:143]
  v_mfma_f32_32x32x16_bf16 v[128:143], v[148:151], v[36:39], v[128:143]
  v_mfma_f32_32x32x16_bf16 v[128:143], v[152:155], v[40:43], v[128:143]
  v_mfma_f32_32x32x16_bf16 v[128:143], v[156:159], v[44:47], v[128:143]
  s_nop 11
  v_max3_f32 v14, v128, v129, v130
  v_max3_f32 v14, v14, v131, v132
  v_max3_f32 v14, v14, v133, v134
  v_max3_f32 v14, v14, v135, v136
  v_max3_f32 v14, v14, v137, v138
  v_max3_f32 v14, v14, v139, v140
  v_max3_f32 v14, v14, v141, v142
  v_max_f32 v14, v14, v143
  v_mov_b32 v15, v14
  s_nop 1
  v_permlane32_swap_b32 v14, v15
  v_max_f32 v14, v14, v15
  v_max_f32 v14, v14, v0
  v_sub_f32 v15, v0, v14
  v_exp_f32 v15, v15
  v_mov_b32 v0, v14
  v_mul_f32 v12, v12, v15
  v_mul_f32 v48, v48, v15
  v_mul_f32 v49, v49, v15
  v_mul_f32 v50, v50, v15
  v_mul_f32 v51, v51, v15
  v_mul_f32 v52, v52, v15
  v_mul_f32 v53, v53, v15
  v_mul_f32 v54, v54, v15
  v_mul_f32 v55, v55, v15
  v_mul_f32 v56, v56, v15
  v_mul_f32 v57, v57, v15
  v_mul_f32 v58, v58, v15
  v_mul_f32 v59, v59, v15
  v_mul_f32 v60, v60, v15
  v_mul_f32 v61, v61, v15
  v_mul_f32 v62, v62, v15
  v_mul_f32 v63, v63, v15
  v_mul_f32 v64, v64, v15
  v_mul_f32 v65, v65, v15
  v_mul_f32 v66, v66, v15
  v_mul_f32 v67, v67, v15
  v_mul_f32 v68, v68, v15
  v_mul_f32 v69, v69, v15
  v_mul_f32 v70, v70, v15
  v_mul_f32 v71, v71, v15
  v_mul_f32 v72, v72, v15
  v_mul_f32 v73, v73, v15
  v_mul_f32 v74, v74, v15
  v_mul_f32 v75, v75, v15
  v_mul_f32 v76, v76, v15
  v_mul_f32 v77, v77, v15
  v_mul_f32 v78, v78, v15
  v_mul_f32 v79, v79, v15
  v_mul_f32 v80, v80, v15
  v_mul_f32 v81, v81, v15
  v_mul_f32 v82, v82, v15
  v_mul_f32 v83, v83, v15
  v_mul_f32 v84, v84, v15
  v_mul_f32 v85, v85, v15
  v_mul_f32 v86, v86, v15
  v_mul_f32 v87, v87, v15
  v_mul_f32 v88, v88, v15
  v_mul_f32 v89, v89, v15
  v_mul_f32 v90, v90, v15
  v_mul_f32 v91, v91, v15
  v_mul_f32 v92, v92, v15
  v_mul_f32 v93, v93, v15
  v_mul_f32 v94, v94, v15
  v_mul_f32 v95, v95, v15
  v_mul_f32 v96, v96, v15
  v_mul_f32 v97, v97, v15
  v_mul_f32 v98, v98, v15
  v_mul_f32 v99, v99, v15
  v_mul_f32 v100, v100, v15
  v_mul_f32 v101, v101, v15
  v_mul_f32 v102, v102, v15
  v_mul_f32 v103, v103, v15
  v_mul_f32 v104, v104, v15
  v_mul_f32 v105, v105, v15
  v_mul_f32 v106, v106, v15
  v_mul_f32 v107, v107, v15
  v_mul_f32 v108, v108, v15
  v_mul_f32 v109, v109, v15
  v_mul_f32 v110, v110, v15
  v_mul_f32 v111, v111, v15
  ds_read_b64_tr_b16 v[144:145], v5 offset:0
  ds_read_b64_tr_b16 v[146:147], v5 offset:2048
  ds_read_b64_tr_b16 v[148:149], v5 offset:256
  ds_read_b64_tr_b16 v[150:151], v5 offset:2304
  ds_read_b64_tr_b16 v[152:153], v5 offset:512
  ds_read_b64_tr_b16 v[154:155], v5 offset:2560
  ds_read_b64_tr_b16 v[156:157], v5 offset:768
  ds_read_b64_tr_b16 v[158:159], v5 offset:2816
  v_sub_f32 v128, v128, v0
  v_sub_f32 v129, v129, v0
  v_exp_f32 v128, v128
  v_exp_f32 v129, v129
  v_sub_f32 v130, v130, v0
  v_sub_f32 v131, v131, v0
  v_exp_f32 v130, v130
  v_exp_f32 v131, v131
  v_sub_f32 v132, v132, v0
  v_sub_f32 v133, v133, v0
  v_exp_f32 v132, v132
  v_exp_f32 v133, v133
  v_sub_f32 v134, v134, v0
  v_sub_f32 v135, v135, v0
  v_exp_f32 v134, v134
  v_exp_f32 v135, v135
  v_sub_f32 v136, v136, v0
  v_sub_f32 v137, v137, v0
  v_exp_f32 v136, v136
  v_exp_f32 v137, v137
  v_sub_f32 v138, v138, v0
  v_sub_f32 v139, v139, v0
  v_exp_f32 v138, v138
  v_exp_f32 v139, v139
  v_sub_f32 v140, v140, v0
  v_sub_f32 v141, v141, v0
  v_exp_f32 v140, v140
  v_exp_f32 v141, v141
  v_sub_f32 v142, v142, v0
  v_sub_f32 v143, v143, v0
  v_exp_f32 v142, v142
  v_exp_f32 v143, v143
  v_add_f32 v13, v128, v129
  v_cvt_pk_bf16_f32 v128, v128, v129
  v_add_f32 v14, v130, v131
  v_cvt_pk_bf16_f32 v129, v130, v131
  v_add_f32 v13, v13, v132
  v_add_f32 v14, v14, v133
  v_cvt_pk_bf16_f32 v130, v132, v133
  v_add_f32 v13, v13, v134
  v_add_f32 v14, v14, v135
  v_cvt_pk_bf16_f32 v131, v134, v135
  v_add_f32 v13, v13, v136
  v_add_f32 v14, v14, v137
  v_cvt_pk_bf16_f32 v136, v136, v137
  v_add_f32 v13, v13, v138
  v_add_f32 v14, v14, v139
  v_cvt_pk_bf16_f32 v137, v138, v139
  v_add_f32 v13, v13, v140
  v_add_f32 v14, v14, v141
  v_cvt_pk_bf16_f32 v138, v140, v141
  v_add_f32 v13, v13, v142
  v_add_f32 v14, v14, v143
  v_cvt_pk_bf16_f32 v139, v142, v143
  v_add_f32 v13, v13, v14
  s_nop 0
  s_branch K1_A2T13_CONT
K1_A2T14_SLOW:
  s_waitcnt lgkmcnt(0)
  v_and_b32 v14, 31, v1
  v_lshlrev_b32 v14, 8, v14
  v_lshrrev_b32 v15, 5, v1
  v_lshl_add_u32 v14, v15, 4, v14
  s_and_b32 s34, s73, 15
  s_lshl_b32 s34, s34, 13
  s_lshl_b32 s35, s32, 17
  s_add_u32 s34, s34, s35
  buffer_load_dwordx4 v[144:147], v14, s[4:7], s34 offen offset:0
  buffer_load_dwordx4 v[148:151], v14, s[4:7], s34 offen offset:32
  buffer_load_dwordx4 v[152:155], v14, s[4:7], s34 offen offset:64
  buffer_load_dwordx4 v[156:159], v14, s[4:7], s34 offen offset:96
  s_waitcnt vmcnt(0)
  v_mfma_f32_32x32x16_bf16 v[112:127], v[144:147], v[16:19], 0
  v_mfma_f32_32x32x16_bf16 v[112:127], v[148:151], v[20:23], v[112:127]
  v_mfma_f32_32x32x16_bf16 v[112:127], v[152:155], v[24:27], v[112:127]
  v_mfma_f32_32x32x16_bf16 v[112:127], v[156:159], v[28:31], v[112:127]
  buffer_load_dwordx4 v[144:147], v14, s[4:7], s34 offen offset:128
  buffer_load_dwordx4 v[148:151], v14, s[4:7], s34 offen offset:160
  buffer_load_dwordx4 v[152:155], v14, s[4:7], s34 offen offset:192
  buffer_load_dwordx4 v[156:159], v14, s[4:7], s34 offen offset:224
  s_waitcnt vmcnt(0)
  v_mfma_f32_32x32x16_bf16 v[112:127], v[144:147], v[32:35], v[112:127]
  v_mfma_f32_32x32x16_bf16 v[112:127], v[148:151], v[36:39], v[112:127]
  v_mfma_f32_32x32x16_bf16 v[112:127], v[152:155], v[40:43], v[112:127]
  v_mfma_f32_32x32x16_bf16 v[112:127], v[156:159], v[44:47], v[112:127]
  s_nop 11
  v_max3_f32 v14, v112, v113, v114
  v_max3_f32 v14, v14, v115, v116
  v_max3_f32 v14, v14, v117, v118
  v_max3_f32 v14, v14, v119, v120
  v_max3_f32 v14, v14, v121, v122
  v_max3_f32 v14, v14, v123, v124
  v_max3_f32 v14, v14, v125, v126
  v_max_f32 v14, v14, v127
  v_mov_b32 v15, v14
  s_nop 1
  v_permlane32_swap_b32 v14, v15
  v_max_f32 v14, v14, v15
  v_max_f32 v14, v14, v0
  v_sub_f32 v15, v0, v14
  v_exp_f32 v15, v15
  v_mov_b32 v0, v14
  v_mul_f32 v12, v12, v15
  v_mul_f32 v48, v48, v15
  v_mul_f32 v49, v49, v15
  v_mul_f32 v50, v50, v15
  v_mul_f32 v51, v51, v15
  v_mul_f32 v52, v52, v15
  v_mul_f32 v53, v53, v15
  v_mul_f32 v54, v54, v15
  v_mul_f32 v55, v55, v15
  v_mul_f32 v56, v56, v15
  v_mul_f32 v57, v57, v15
  v_mul_f32 v58, v58, v15
  v_mul_f32 v59, v59, v15
  v_mul_f32 v60, v60, v15
  v_mul_f32 v61, v61, v15
  v_mul_f32 v62, v62, v15
  v_mul_f32 v63, v63, v15
  v_mul_f32 v64, v64, v15
  v_mul_f32 v65, v65, v15
  v_mul_f32 v66, v66, v15
  v_mul_f32 v67, v67, v15
  v_mul_f32 v68, v68, v15
  v_mul_f32 v69, v69, v15
  v_mul_f32 v70, v70, v15
  v_mul_f32 v71, v71, v15
  v_mul_f32 v72, v72, v15
  v_mul_f32 v73, v73, v15
  v_mul_f32 v74, v74, v15
  v_mul_f32 v75, v75, v15
  v_mul_f32 v76, v76, v15
  v_mul_f32 v77, v77, v15
  v_mul_f32 v78, v78, v15
  v_mul_f32 v79, v79, v15
  v_mul_f32 v80, v80, v15
  v_mul_f32 v81, v81, v15
  v_mul_f32 v82, v82, v15
  v_mul_f32 v83, v83, v15
  v_mul_f32 v84, v84, v15
  v_mul_f32 v85, v85, v15
  v_mul_f32 v86, v86, v15
  v_mul_f32 v87, v87, v15
  v_mul_f32 v88, v88, v15
  v_mul_f32 v89, v89, v15
  v_mul_f32 v90, v90, v15
  v_mul_f32 v91, v91, v15
  v_mul_f32 v92, v92, v15
  v_mul_f32 v93, v93, v15
  v_mul_f32 v94, v94, v15
  v_mul_f32 v95, v95, v15
  v_mul_f32 v96, v96, v15
  v_mul_f32 v97, v97, v15
  v_mul_f32 v98, v98, v15
  v_mul_f32 v99, v99, v15
  v_mul_f32 v100, v100, v15
  v_mul_f32 v101, v101, v15
  v_mul_f32 v102, v102, v15
  v_mul_f32 v103, v103, v15
  v_mul_f32 v104, v104, v15
  v_mul_f32 v105, v105, v15
  v_mul_f32 v106, v106, v15
  v_mul_f32 v107, v107, v15
  v_mul_f32 v108, v108, v15
  v_mul_f32 v109, v109, v15
  v_mul_f32 v110, v110, v15
  v_mul_f32 v111, v111, v15
  ds_read_b64_tr_b16 v[144:145], v5 offset:0
  ds_read_b64_tr_b16 v[146:147], v5 offset:2048
  ds_read_b64_tr_b16 v[148:149], v5 offset:256
  ds_read_b64_tr_b16 v[150:151], v5 offset:2304
  ds_read_b64_tr_b16 v[152:153], v5 offset:512
  ds_read_b64_tr_b16 v[154:155], v5 offset:2560
  ds_read_b64_tr_b16 v[156:157], v5 offset:768
  ds_read_b64_tr_b16 v[158:159], v5 offset:2816
  v_sub_f32 v112, v112, v0
  v_sub_f32 v113, v113, v0
  v_exp_f32 v112, v112
  v_exp_f32 v113, v113
  v_sub_f32 v114, v114, v0
  v_sub_f32 v115, v115, v0
  v_exp_f32 v114, v114
  v_exp_f32 v115, v115
  v_sub_f32 v116, v116, v0
  v_sub_f32 v117, v117, v0
  v_exp_f32 v116, v116
  v_exp_f32 v117, v117
  v_sub_f32 v118, v118, v0
  v_sub_f32 v119, v119, v0
  v_exp_f32 v118, v118
  v_exp_f32 v119, v119
  v_sub_f32 v120, v120, v0
  v_sub_f32 v121, v121, v0
  v_exp_f32 v120, v120
  v_exp_f32 v121, v121
  v_sub_f32 v122, v122, v0
  v_sub_f32 v123, v123, v0
  v_exp_f32 v122, v122
  v_exp_f32 v123, v123
  v_sub_f32 v124, v124, v0
  v_sub_f32 v125, v125, v0
  v_exp_f32 v124, v124
  v_exp_f32 v125, v125
  v_sub_f32 v126, v126, v0
  v_sub_f32 v127, v127, v0
  v_exp_f32 v126, v126
  v_exp_f32 v127, v127
  v_add_f32 v13, v112, v113
  v_cvt_pk_bf16_f32 v112, v112, v113
  v_add_f32 v14, v114, v115
  v_cvt_pk_bf16_f32 v113, v114, v115
  v_add_f32 v13, v13, v116
  v_add_f32 v14, v14, v117
  v_cvt_pk_bf16_f32 v114, v116, v117
  v_add_f32 v13, v13, v118
  v_add_f32 v14, v14, v119
  v_cvt_pk_bf16_f32 v115, v118, v119
  v_add_f32 v13, v13, v120
  v_add_f32 v14, v14, v121
  v_cvt_pk_bf16_f32 v120, v120, v121
  v_add_f32 v13, v13, v122
  v_add_f32 v14, v14, v123
  v_cvt_pk_bf16_f32 v121, v122, v123
  v_add_f32 v13, v13, v124
  v_add_f32 v14, v14, v125
  v_cvt_pk_bf16_f32 v122, v124, v125
  v_add_f32 v13, v13, v126
  v_add_f32 v14, v14, v127
  v_cvt_pk_bf16_f32 v123, v126, v127
  v_add_f32 v13, v13, v14
  s_nop 0
  s_branch K1_A2T14_CONT
K1_A2T15_SLOW:
  s_waitcnt lgkmcnt(0)
  v_and_b32 v14, 31, v1
  v_lshlrev_b32 v14, 8, v14
  v_lshrrev_b32 v15, 5, v1
  v_lshl_add_u32 v14, v15, 4, v14
  s_and_b32 s34, s73, 15
  s_lshl_b32 s34, s34, 13
  s_lshl_b32 s35, s32, 17
  s_add_u32 s34, s34, s35
  buffer_load_dwordx4 v[144:147], v14, s[4:7], s34 offen offset:0
  buffer_load_dwordx4 v[148:151], v14, s[4:7], s34 offen offset:32
  buffer_load_dwordx4 v[152:155], v14, s[4:7], s34 offen offset:64
  buffer_load_dwordx4 v[156:159], v14, s[4:7], s34 offen offset:96
  s_waitcnt vmcnt(0)
  v_mfma_f32_32x32x16_bf16 v[128:143], v[144:147], v[16:19], 0
  v_mfma_f32_32x32x16_bf16 v[128:143], v[148:151], v[20:23], v[128:143]
  v_mfma_f32_32x32x16_bf16 v[128:143], v[152:155], v[24:27], v[128:143]
  v_mfma_f32_32x32x16_bf16 v[128:143], v[156:159], v[28:31], v[128:143]
  buffer_load_dwordx4 v[144:147], v14, s[4:7], s34 offen offset:128
  buffer_load_dwordx4 v[148:151], v14, s[4:7], s34 offen offset:160
  buffer_load_dwordx4 v[152:155], v14, s[4:7], s34 offen offset:192
  buffer_load_dwordx4 v[156:159], v14, s[4:7], s34 offen offset:224
  s_waitcnt vmcnt(0)
  v_mfma_f32_32x32x16_bf16 v[128:143], v[144:147], v[32:35], v[128:143]
  v_mfma_f32_32x32x16_bf16 v[128:143], v[148:151], v[36:39], v[128:143]
  v_mfma_f32_32x32x16_bf16 v[128:143], v[152:155], v[40:43], v[128:143]
  v_mfma_f32_32x32x16_bf16 v[128:143], v[156:159], v[44:47], v[128:143]
  s_nop 11
  v_max3_f32 v14, v128, v129, v130
  v_max3_f32 v14, v14, v131, v132
  v_max3_f32 v14, v14, v133, v134
  v_max3_f32 v14, v14, v135, v136
  v_max3_f32 v14, v14, v137, v138
  v_max3_f32 v14, v14, v139, v140
  v_max3_f32 v14, v14, v141, v142
  v_max_f32 v14, v14, v143
  v_mov_b32 v15, v14
  s_nop 1
  v_permlane32_swap_b32 v14, v15
  v_max_f32 v14, v14, v15
  v_max_f32 v14, v14, v0
  v_sub_f32 v15, v0, v14
  v_exp_f32 v15, v15
  v_mov_b32 v0, v14
  v_mul_f32 v12, v12, v15
  v_mul_f32 v48, v48, v15
  v_mul_f32 v49, v49, v15
  v_mul_f32 v50, v50, v15
  v_mul_f32 v51, v51, v15
  v_mul_f32 v52, v52, v15
  v_mul_f32 v53, v53, v15
  v_mul_f32 v54, v54, v15
  v_mul_f32 v55, v55, v15
  v_mul_f32 v56, v56, v15
  v_mul_f32 v57, v57, v15
  v_mul_f32 v58, v58, v15
  v_mul_f32 v59, v59, v15
  v_mul_f32 v60, v60, v15
  v_mul_f32 v61, v61, v15
  v_mul_f32 v62, v62, v15
  v_mul_f32 v63, v63, v15
  v_mul_f32 v64, v64, v15
  v_mul_f32 v65, v65, v15
  v_mul_f32 v66, v66, v15
  v_mul_f32 v67, v67, v15
  v_mul_f32 v68, v68, v15
  v_mul_f32 v69, v69, v15
  v_mul_f32 v70, v70, v15
  v_mul_f32 v71, v71, v15
  v_mul_f32 v72, v72, v15
  v_mul_f32 v73, v73, v15
  v_mul_f32 v74, v74, v15
  v_mul_f32 v75, v75, v15
  v_mul_f32 v76, v76, v15
  v_mul_f32 v77, v77, v15
  v_mul_f32 v78, v78, v15
  v_mul_f32 v79, v79, v15
  v_mul_f32 v80, v80, v15
  v_mul_f32 v81, v81, v15
  v_mul_f32 v82, v82, v15
  v_mul_f32 v83, v83, v15
  v_mul_f32 v84, v84, v15
  v_mul_f32 v85, v85, v15
  v_mul_f32 v86, v86, v15
  v_mul_f32 v87, v87, v15
  v_mul_f32 v88, v88, v15
  v_mul_f32 v89, v89, v15
  v_mul_f32 v90, v90, v15
  v_mul_f32 v91, v91, v15
  v_mul_f32 v92, v92, v15
  v_mul_f32 v93, v93, v15
  v_mul_f32 v94, v94, v15
  v_mul_f32 v95, v95, v15
  v_mul_f32 v96, v96, v15
  v_mul_f32 v97, v97, v15
  v_mul_f32 v98, v98, v15
  v_mul_f32 v99, v99, v15
  v_mul_f32 v100, v100, v15
  v_mul_f32 v101, v101, v15
  v_mul_f32 v102, v102, v15
  v_mul_f32 v103, v103, v15
  v_mul_f32 v104, v104, v15
  v_mul_f32 v105, v105, v15
  v_mul_f32 v106, v106, v15
  v_mul_f32 v107, v107, v15
  v_mul_f32 v108, v108, v15
  v_mul_f32 v109, v109, v15
  v_mul_f32 v110, v110, v15
  v_mul_f32 v111, v111, v15
  ds_read_b64_tr_b16 v[144:145], v5 offset:0
  ds_read_b64_tr_b16 v[146:147], v5 offset:2048
  ds_read_b64_tr_b16 v[148:149], v5 offset:256
  ds_read_b64_tr_b16 v[150:151], v5 offset:2304
  ds_read_b64_tr_b16 v[152:153], v5 offset:512
  ds_read_b64_tr_b16 v[154:155], v5 offset:2560
  ds_read_b64_tr_b16 v[156:157], v5 offset:768
  ds_read_b64_tr_b16 v[158:159], v5 offset:2816
  v_sub_f32 v128, v128, v0
  v_sub_f32 v129, v129, v0
  v_exp_f32 v128, v128
  v_exp_f32 v129, v129
  v_sub_f32 v130, v130, v0
  v_sub_f32 v131, v131, v0
  v_exp_f32 v130, v130
  v_exp_f32 v131, v131
  v_sub_f32 v132, v132, v0
  v_sub_f32 v133, v133, v0
  v_exp_f32 v132, v132
  v_exp_f32 v133, v133
  v_sub_f32 v134, v134, v0
  v_sub_f32 v135, v135, v0
  v_exp_f32 v134, v134
  v_exp_f32 v135, v135
  v_sub_f32 v136, v136, v0
  v_sub_f32 v137, v137, v0
  v_exp_f32 v136, v136
  v_exp_f32 v137, v137
  v_sub_f32 v138, v138, v0
  v_sub_f32 v139, v139, v0
  v_exp_f32 v138, v138
  v_exp_f32 v139, v139
  v_sub_f32 v140, v140, v0
  v_sub_f32 v141, v141, v0
  v_exp_f32 v140, v140
  v_exp_f32 v141, v141
  v_sub_f32 v142, v142, v0
  v_sub_f32 v143, v143, v0
  v_exp_f32 v142, v142
  v_exp_f32 v143, v143
  v_add_f32 v13, v128, v129
  v_cvt_pk_bf16_f32 v128, v128, v129
  v_add_f32 v14, v130, v131
  v_cvt_pk_bf16_f32 v129, v130, v131
  v_add_f32 v13, v13, v132
  v_add_f32 v14, v14, v133
  v_cvt_pk_bf16_f32 v130, v132, v133
  v_add_f32 v13, v13, v134
  v_add_f32 v14, v14, v135
  v_cvt_pk_bf16_f32 v131, v134, v135
  v_add_f32 v13, v13, v136
  v_add_f32 v14, v14, v137
  v_cvt_pk_bf16_f32 v136, v136, v137
  v_add_f32 v13, v13, v138
  v_add_f32 v14, v14, v139
  v_cvt_pk_bf16_f32 v137, v138, v139
  v_add_f32 v13, v13, v140
  v_add_f32 v14, v14, v141
  v_cvt_pk_bf16_f32 v138, v140, v141
  v_add_f32 v13, v13, v142
  v_add_f32 v14, v14, v143
  v_cvt_pk_bf16_f32 v139, v142, v143
  v_add_f32 v13, v13, v14
  s_nop 0
  s_branch K1_A2T15_CONT
K1_EPI:
  v_mov_b32 v14, v12
  s_nop 1
  v_permlane32_swap_b32 v12, v14
  v_add_f32 v12, v12, v14
  v_rcp_f32 v12, v12
  v_bfe_u32 v14, v1, 4, 1
  v_lshlrev_b32 v14, 17, v14
  v_and_b32 v15, 15, v1
  v_lshl_add_u32 v14, v15, 4, v14
  v_lshrrev_b32 v15, 5, v1
  v_lshl_add_u32 v14, v15, 9, v14
  s_mul_i32 s34, s29, 96
  s_mul_i32 s35, s30, 12
  s_add_u32 s34, s34, s35
  s_lshl_b32 s35, s33, 1
  s_add_u32 s34, s34, s35
  s_lshl_b32 s34, s34, 7
  s_lshl_b32 s35, s31, 3
  s_add_u32 s34, s34, s35
  s_lshl_b32 s35, s32, 2
  s_add_u32 s34, s34, s35
  s_lshl_b32 s34, s34, 10
  v_mul_f32 v48, v48, v12
  v_mul_f32 v49, v49, v12
  v_mul_f32 v50, v50, v12
  v_mul_f32 v51, v51, v12
  v_mul_f32 v52, v52, v12
  v_mul_f32 v53, v53, v12
  v_mul_f32 v54, v54, v12
  v_mul_f32 v55, v55, v12
  v_mul_f32 v56, v56, v12
  v_mul_f32 v57, v57, v12
  v_mul_f32 v58, v58, v12
  v_mul_f32 v59, v59, v12
  v_mul_f32 v60, v60, v12
  v_mul_f32 v61, v61, v12
  v_mul_f32 v62, v62, v12
  v_mul_f32 v63, v63, v12
  v_cvt_pk_bf16_f32 v16, v48, v49
  v_cvt_pk_bf16_f32 v17, v50, v51
  v_cvt_pk_bf16_f32 v18, v52, v53
  v_cvt_pk_bf16_f32 v19, v54, v55
  buffer_store_dwordx4 v[16:19], v14, s[20:23], s34 offen offset:0
  v_cvt_pk_bf16_f32 v20, v56, v57
  v_cvt_pk_bf16_f32 v21, v58, v59
  v_cvt_pk_bf16_f32 v22, v60, v61
  v_cvt_pk_bf16_f32 v23, v62, v63
  buffer_store_dwordx4 v[20:23], v14, s[20:23], s34 offen offset:256
  v_mul_f32 v64, v64, v12
  v_mul_f32 v65, v65, v12
  v_mul_f32 v66, v66, v12
  v_mul_f32 v67, v67, v12
  v_mul_f32 v68, v68, v12
  v_mul_f32 v69, v69, v12
  v_mul_f32 v70, v70, v12
  v_mul_f32 v71, v71, v12
  v_mul_f32 v72, v72, v12
  v_mul_f32 v73, v73, v12
  v_mul_f32 v74, v74, v12
  v_mul_f32 v75, v75, v12
  v_mul_f32 v76, v76, v12
  v_mul_f32 v77, v77, v12
  v_mul_f32 v78, v78, v12
  v_mul_f32 v79, v79, v12
  v_cvt_pk_bf16_f32 v24, v64, v65
  v_cvt_pk_bf16_f32 v25, v66, v67
  v_cvt_pk_bf16_f32 v26, v68, v69
  v_cvt_pk_bf16_f32 v27, v70, v71
  buffer_store_dwordx4 v[24:27], v14, s[20:23], s34 offen offset:1024
  v_cvt_pk_bf16_f32 v28, v72, v73
  v_cvt_pk_bf16_f32 v29, v74, v75
  v_cvt_pk_bf16_f32 v30, v76, v77
  v_cvt_pk_bf16_f32 v31, v78, v79
  buffer_store_dwordx4 v[28:31], v14, s[20:23], s34 offen offset:1280
  v_mul_f32 v80, v80, v12
  v_mul_f32 v81, v81, v12
  v_mul_f32 v82, v82, v12
  v_mul_f32 v83, v83, v12
  v_mul_f32 v84, v84, v12
  v_mul_f32 v85, v85, v12
  v_mul_f32 v86, v86, v12
  v_mul_f32 v87, v87, v12
  v_mul_f32 v88, v88, v12
  v_mul_f32 v89, v89, v12
  v_mul_f32 v90, v90, v12
  v_mul_f32 v91, v91, v12
  v_mul_f32 v92, v92, v12
  v_mul_f32 v93, v93, v12
  v_mul_f32 v94, v94, v12
  v_mul_f32 v95, v95, v12
  v_cvt_pk_bf16_f32 v32, v80, v81
  v_cvt_pk_bf16_f32 v33, v82, v83
  v_cvt_pk_bf16_f32 v34, v84, v85
  v_cvt_pk_bf16_f32 v35, v86, v87
  buffer_store_dwordx4 v[32:35], v14, s[20:23], s34 offen offset:2048
  v_cvt_pk_bf16_f32 v36, v88, v89
  v_cvt_pk_bf16_f32 v37, v90, v91
  v_cvt_pk_bf16_f32 v38, v92, v93
  v_cvt_pk_bf16_f32 v39, v94, v95
  buffer_store_dwordx4 v[36:39], v14, s[20:23], s34 offen offset:2304
  v_mul_f32 v96, v96, v12
  v_mul_f32 v97, v97, v12
  v_mul_f32 v98, v98, v12
  v_mul_f32 v99, v99, v12
  v_mul_f32 v100, v100, v12
  v_mul_f32 v101, v101, v12
  v_mul_f32 v102, v102, v12
  v_mul_f32 v103, v103, v12
  v_mul_f32 v104, v104, v12
  v_mul_f32 v105, v105, v12
  v_mul_f32 v106, v106, v12
  v_mul_f32 v107, v107, v12
  v_mul_f32 v108, v108, v12
  v_mul_f32 v109, v109, v12
  v_mul_f32 v110, v110, v12
  v_mul_f32 v111, v111, v12
  v_cvt_pk_bf16_f32 v40, v96, v97
  v_cvt_pk_bf16_f32 v41, v98, v99
  v_cvt_pk_bf16_f32 v42, v100, v101
  v_cvt_pk_bf16_f32 v43, v102, v103
  buffer_store_dwordx4 v[40:43], v14, s[20:23], s34 offen offset:3072
  v_cvt_pk_bf16_f32 v44, v104, v105
  v_cvt_pk_bf16_f32 v45, v106, v107
  v_cvt_pk_bf16_f32 v46, v108, v109
  v_cvt_pk_bf16_f32 v47, v110, v111
  buffer_store_dwordx4 v[44:47], v14, s[20:23], s34 offen offset:3328
  s_add_u32 s34, s28, 0
  s_mul_i32 s35, s34, 52
  s_lshr_b32 s35, s35, 8
  s_mul_i32 s36, s35, 5
  s_sub_u32 s36, s34, s36
  s_and_b32 s37, s35, 3
  s_mul_i32 s37, s37, 5120
  s_lshr_b32 s34, s35, 2
  s_lshl_b32 s34, s34, 15
  s_add_u32 s37, s37, s34
  s_lshl_b32 s34, s36, 5
  s_add_u32 s37, s37, s34
  s_add_u32 s37, s37, 32768
  v_add_u32 v162, s37, v164
  ds_read_b64_tr_b16 v[48:49], v162
  ds_read_b64_tr_b16 v[50:51], v162 offset:1280
  s_mul_i32 s34, s29, 40
  s_mul_i32 s37, s30, 5
  s_add_u32 s37, s37, s34
  s_add_u32 s37, s37, s36
  s_lshl_b32 s37, s37, 7
  s_add_u32 s37, s37, s35
  s_lshl_b32 s36, s31, 3
  s_add_u32 s37, s37, s36
  s_lshl_b32 s37, s37, 10
  s_add_u32 s37, s37, 25165824
  s_waitcnt lgkmcnt(0)
  buffer_store_dwordx4 v[48:51], v165, s[20:23], s37 offen
  s_add_u32 s34, s28, 12
  s_mul_i32 s35, s34, 52
  s_lshr_b32 s35, s35, 8
  s_mul_i32 s36, s35, 5
  s_sub_u32 s36, s34, s36
  s_and_b32 s37, s35, 3
  s_mul_i32 s37, s37, 5120
  s_lshr_b32 s34, s35, 2
  s_lshl_b32 s34, s34, 15
  s_add_u32 s37, s37, s34
  s_lshl_b32 s34, s36, 5
  s_add_u32 s37, s37, s34
  s_add_u32 s37, s37, 32768
  v_add_u32 v162, s37, v164
  ds_read_b64_tr_b16 v[52:53], v162
  ds_read_b64_tr_b16 v[54:55], v162 offset:1280
  s_mul_i32 s34, s29, 40
  s_mul_i32 s37, s30, 5
  s_add_u32 s37, s37, s34
  s_add_u32 s37, s37, s36
  s_lshl_b32 s37, s37, 7
  s_add_u32 s37, s37, s35
  s_lshl_b32 s36, s31, 3
  s_add_u32 s37, s37, s36
  s_lshl_b32 s37, s37, 10
  s_add_u32 s37, s37, 25165824
  s_waitcnt lgkmcnt(0)
  buffer_store_dwordx4 v[52:55], v165, s[20:23], s37 offen
  s_add_u32 s34, s28, 24
  s_mul_i32 s35, s34, 52
  s_lshr_b32 s35, s35, 8
  s_mul_i32 s36, s35, 5
  s_sub_u32 s36, s34, s36
  s_and_b32 s37, s35, 3
  s_mul_i32 s37, s37, 5120
  s_lshr_b32 s34, s35, 2
  s_lshl_b32 s34, s34, 15
  s_add_u32 s37, s37, s34
  s_lshl_b32 s34, s36, 5
  s_add_u32 s37, s37, s34
  s_add_u32 s37, s37, 32768
  v_add_u32 v162, s37, v164
  ds_read_b64_tr_b16 v[56:57], v162
  ds_read_b64_tr_b16 v[58:59], v162 offset:1280
  s_mul_i32 s34, s29, 40
  s_mul_i32 s37, s30, 5
  s_add_u32 s37, s37, s34
  s_add_u32 s37, s37, s36
  s_lshl_b32 s37, s37, 7
  s_add_u32 s37, s37, s35
  s_lshl_b32 s36, s31, 3
  s_add_u32 s37, s37, s36
  s_lshl_b32 s37, s37, 10
  s_add_u32 s37, s37, 25165824
  s_waitcnt lgkmcnt(0)
  buffer_store_dwordx4 v[56:59], v165, s[20:23], s37 offen
  s_cmp_ge_u32 s28, 4
  s_cbranch_scc1 K1_NOPS
  s_add_u32 s34, s28, 36
  s_mul_i32 s35, s34, 52
  s_lshr_b32 s35, s35, 8
  s_mul_i32 s36, s35, 5
  s_sub_u32 s36, s34, s36
  s_and_b32 s37, s35, 3
  s_mul_i32 s37, s37, 5120
  s_lshr_b32 s34, s35, 2
  s_lshl_b32 s34, s34, 15
  s_add_u32 s37, s37, s34
  s_lshl_b32 s34, s36, 5
  s_add_u32 s37, s37, s34
  s_add_u32 s37, s37, 32768
  v_add_u32 v162, s37, v164
  ds_read_b64_tr_b16 v[60:61], v162
  ds_read_b64_tr_b16 v[62:63], v162 offset:1280
  s_mul_i32 s34, s29, 40
  s_mul_i32 s37, s30, 5
  s_add_u32 s37, s37, s34
  s_add_u32 s37, s37, s36
  s_lshl_b32 s37, s37, 7
  s_add_u32 s37, s37, s35
  s_lshl_b32 s36, s31, 3
  s_add_u32 s37, s37, s36
  s_lshl_b32 s37, s37, 10
  s_add_u32 s37, s37, 25165824
  s_waitcnt lgkmcnt(0)
  buffer_store_dwordx4 v[60:63], v165, s[20:23], s37 offen
K1_NOPS:
K1_END:
  s_endpgm
.globl outproj_kernel
.p2align 8
.type outproj_kernel,@function
outproj_kernel:
  s_cmp_ge_u32 s2, 256
  s_cbranch_scc1 K2_END
  s_load_dwordx2 s[4:5], s[0:1], 80
  s_load_dwordx2 s[6:7], s[0:1], 96
  v_and_b32 v2, 63, v0
  v_lshrrev_b32 v3, 6, v0
  s_nop 0
  v_readfirstlane_b32 s16, v3
  v_lshlrev_b32 v1, 4, v2
  s_and_b32 s20, s2, 7
  s_lshr_b32 s21, s2, 3
  s_lshr_b32 s17, s20, 2
  s_and_b32 s20, s20, 3
  s_lshl_b32 s20, s20, 2
  s_and_b32 s22, s21, 3
  s_add_u32 s18, s20, s22
  s_lshr_b32 s19, s21, 2
  s_waitcnt lgkmcnt(0)
  s_mov_b32 s8, s6
  s_mov_b32 s9, s7
  s_mov_b32 s10, 0x10000000
  s_mov_b32 s11, 0x00020000
  s_mov_b32 s12, s4
  s_mov_b32 s13, s5
  s_mov_b32 s14, 3932160
  s_mov_b32 s15, 0x00020000
  s_mul_i32 s20, s17, 40
  s_mul_i32 s21, s19, 5
  s_add_u32 s20, s20, s21
  s_lshl_b32 s20, s20, 17
  s_lshl_b32 s22, s16, 15
  s_add_u32 s20, s20, s22
  s_add_u32 s20, s20, 25165824
  s_add_u32 s24, s20, 0
  s_add_u32 s25, s20, 131072
  s_add_u32 s26, s20, 262144
  s_add_u32 s27, s20, 393216
  s_add_u32 s28, s20, 524288
  s_mul_i32 s20, s17, 96
  s_mul_i32 s21, s18, 6
  s_add_u32 s20, s20, s21
  s_lshl_b32 s20, s20, 17
  s_add_u32 s20, s20, s22
  s_add_u32 s29, s20, 0
  s_add_u32 s30, s20, 131072
  s_add_u32 s31, s20, 262144
  s_add_u32 s32, s20, 393216
  s_add_u32 s33, s20, 524288
  s_add_u32 s34, s20, 655360
  buffer_load_dwordx4 v[8:11], v1, s[8:11], s24 offen offset:0
  buffer_load_dwordx4 v[12:15], v1, s[8:11], s25 offen offset:0
  buffer_load_dwordx4 v[16:19], v1, s[8:11], s26 offen offset:0
  buffer_load_dwordx4 v[20:23], v1, s[8:11], s27 offen offset:0
  buffer_load_dwordx4 v[24:27], v1, s[8:11], s28 offen offset:0
  buffer_load_dwordx4 v[28:31], v1, s[8:11], s29 offen offset:0
  buffer_load_dwordx4 v[32:35], v1, s[8:11], s30 offen offset:0
  buffer_load_dwordx4 v[36:39], v1, s[8:11], s31 offen offset:0
  buffer_load_dwordx4 v[40:43], v1, s[8:11], s32 offen offset:0
  buffer_load_dwordx4 v[44:47], v1, s[8:11], s33 offen offset:0
  buffer_load_dwordx4 v[48:51], v1, s[8:11], s34 offen offset:0
  buffer_load_dwordx4 v[52:55], v1, s[8:11], s24 offen offset:1024
  buffer_load_dwordx4 v[56:59], v1, s[8:11], s25 offen offset:1024
  buffer_load_dwordx4 v[60:63], v1, s[8:11], s26 offen offset:1024
  buffer_load_dwordx4 v[64:67], v1, s[8:11], s27 offen offset:1024
  buffer_load_dwordx4 v[68:71], v1, s[8:11], s28 offen offset:1024
  buffer_load_dwordx4 v[72:75], v1, s[8:11], s29 offen offset:1024
  buffer_load_dwordx4 v[76:79], v1, s[8:11], s30 offen offset:1024
  buffer_load_dwordx4 v[80:83], v1, s[8:11], s31 offen offset:1024
  buffer_load_dwordx4 v[84:87], v1, s[8:11], s32 offen offset:1024
  buffer_load_dwordx4 v[88:91], v1, s[8:11], s33 offen offset:1024
  buffer_load_dwordx4 v[92:95], v1, s[8:11], s34 offen offset:1024
  v_accvgpr_write_b32 a0, 0
  v_accvgpr_write_b32 a1, 0
  v_accvgpr_write_b32 a2, 0
  v_accvgpr_write_b32 a3, 0
  v_accvgpr_write_b32 a4, 0
  v_accvgpr_write_b32 a5, 0
  v_accvgpr_write_b32 a6, 0
  v_accvgpr_write_b32 a7, 0
  v_accvgpr_write_b32 a8, 0
  v_accvgpr_write_b32 a9, 0
  v_accvgpr_write_b32 a10, 0
  v_accvgpr_write_b32 a11, 0
  v_accvgpr_write_b32 a12, 0
  v_accvgpr_write_b32 a13, 0
  v_accvgpr_write_b32 a14, 0
  v_accvgpr_write_b32 a15, 0
  v_accvgpr_write_b32 a16, 0
  v_accvgpr_write_b32 a17, 0
  v_accvgpr_write_b32 a18, 0
  v_accvgpr_write_b32 a19, 0
  v_accvgpr_write_b32 a20, 0
  v_accvgpr_write_b32 a21, 0
  v_accvgpr_write_b32 a22, 0
  v_accvgpr_write_b32 a23, 0
  v_accvgpr_write_b32 a24, 0
  v_accvgpr_write_b32 a25, 0
  v_accvgpr_write_b32 a26, 0
  v_accvgpr_write_b32 a27, 0
  v_accvgpr_write_b32 a28, 0
  v_accvgpr_write_b32 a29, 0
  v_accvgpr_write_b32 a30, 0
  v_accvgpr_write_b32 a31, 0
  v_accvgpr_write_b32 a32, 0
  v_accvgpr_write_b32 a33, 0
  v_accvgpr_write_b32 a34, 0
  v_accvgpr_write_b32 a35, 0
  v_accvgpr_write_b32 a36, 0
  v_accvgpr_write_b32 a37, 0
  v_accvgpr_write_b32 a38, 0
  v_accvgpr_write_b32 a39, 0
  v_accvgpr_write_b32 a40, 0
  v_accvgpr_write_b32 a41, 0
  v_accvgpr_write_b32 a42, 0
  v_accvgpr_write_b32 a43, 0
  v_accvgpr_write_b32 a44, 0
  v_accvgpr_write_b32 a45, 0
  v_accvgpr_write_b32 a46, 0
  v_accvgpr_write_b32 a47, 0
  v_accvgpr_write_b32 a48, 0
  v_accvgpr_write_b32 a49, 0
  v_accvgpr_write_b32 a50, 0
  v_accvgpr_write_b32 a51, 0
  v_accvgpr_write_b32 a52, 0
  v_accvgpr_write_b32 a53, 0
  v_accvgpr_write_b32 a54, 0
  v_accvgpr_write_b32 a55, 0
  v_accvgpr_write_b32 a56, 0
  v_accvgpr_write_b32 a57, 0
  v_accvgpr_write_b32 a58, 0
  v_accvgpr_write_b32 a59, 0
  v_accvgpr_write_b32 a60, 0
  v_accvgpr_write_b32 a61, 0
  v_accvgpr_write_b32 a62, 0
  v_accvgpr_write_b32 a63, 0
  v_accvgpr_write_b32 a64, 0
  v_accvgpr_write_b32 a65, 0
  v_accvgpr_write_b32 a66, 0
  v_accvgpr_write_b32 a67, 0
  v_accvgpr_write_b32 a68, 0
  v_accvgpr_write_b32 a69, 0
  v_accvgpr_write_b32 a70, 0
  v_accvgpr_write_b32 a71, 0
  v_accvgpr_write_b32 a72, 0
  v_accvgpr_write_b32 a73, 0
  v_accvgpr_write_b32 a74, 0
  v_accvgpr_write_b32 a75, 0
  v_accvgpr_write_b32 a76, 0
  v_accvgpr_write_b32 a77, 0
  v_accvgpr_write_b32 a78, 0
  v_accvgpr_write_b32 a79, 0
  v_accvgpr_write_b32 a80, 0
  v_accvgpr_write_b32 a81, 0
  v_accvgpr_write_b32 a82, 0
  v_accvgpr_write_b32 a83, 0
  v_accvgpr_write_b32 a84, 0
  v_accvgpr_write_b32 a85, 0
  v_accvgpr_write_b32 a86, 0
  v_accvgpr_write_b32 a87, 0
  v_accvgpr_write_b32 a88, 0
  v_accvgpr_write_b32 a89, 0
  v_accvgpr_write_b32 a90, 0
  v_accvgpr_write_b32 a91, 0
  v_accvgpr_write_b32 a92, 0
  v_accvgpr_write_b32 a93, 0
  v_accvgpr_write_b32 a94, 0
  v_accvgpr_write_b32 a95, 0
  v_accvgpr_write_b32 a96, 0
  v_accvgpr_write_b32 a97, 0
  v_accvgpr_write_b32 a98, 0
  v_accvgpr_write_b32 a99, 0
  v_accvgpr_write_b32 a100, 0
  v_accvgpr_write_b32 a101, 0
  v_accvgpr_write_b32 a102, 0
  v_accvgpr_write_b32 a103, 0
  v_accvgpr_write_b32 a104, 0
  v_accvgpr_write_b32 a105, 0
  v_accvgpr_write_b32 a106, 0
  v_accvgpr_write_b32 a107, 0
  v_accvgpr_write_b32 a108, 0
  v_accvgpr_write_b32 a109, 0
  v_accvgpr_write_b32 a110, 0
  v_accvgpr_write_b32 a111, 0
  v_accvgpr_write_b32 a112, 0
  v_accvgpr_write_b32 a113, 0
  v_accvgpr_write_b32 a114, 0
  v_accvgpr_write_b32 a115, 0
  v_accvgpr_write_b32 a116, 0
  v_accvgpr_write_b32 a117, 0
  v_accvgpr_write_b32 a118, 0
  v_accvgpr_write_b32 a119, 0
  s_waitcnt vmcnt(11)
  v_mfma_f32_16x16x32_bf16 a[0:3], v[8:11], v[28:31], a[0:3]
  buffer_load_dwordx4 v[96:99], v1, s[8:11], s24 offen offset:2048
  v_mfma_f32_16x16x32_bf16 a[4:7], v[12:15], v[28:31], a[4:7]
  v_mfma_f32_16x16x32_bf16 a[8:11], v[16:19], v[28:31], a[8:11]
  buffer_load_dwordx4 v[100:103], v1, s[8:11], s25 offen offset:2048
  v_mfma_f32_16x16x32_bf16 a[12:15], v[20:23], v[28:31], a[12:15]
  v_mfma_f32_16x16x32_bf16 a[16:19], v[24:27], v[28:31], a[16:19]
  buffer_load_dwordx4 v[104:107], v1, s[8:11], s26 offen offset:2048
  v_mfma_f32_16x16x32_bf16 a[20:23], v[8:11], v[32:35], a[20:23]
  v_mfma_f32_16x16x32_bf16 a[24:27], v[12:15], v[32:35], a[24:27]
  buffer_load_dwordx4 v[108:111], v1, s[8:11], s27 offen offset:2048
  v_mfma_f32_16x16x32_bf16 a[28:31], v[16:19], v[32:35], a[28:31]
  v_mfma_f32_16x16x32_bf16 a[32:35], v[20:23], v[32:35], a[32:35]
  buffer_load_dwordx4 v[112:115], v1, s[8:11], s28 offen offset:2048
  v_mfma_f32_16x16x32_bf16 a[36:39], v[24:27], v[32:35], a[36:39]
  v_mfma_f32_16x16x32_bf16 a[40:43], v[8:11], v[36:39], a[40:43]
  buffer_load_dwordx4 v[116:119], v1, s[8:11], s29 offen offset:2048
  v_mfma_f32_16x16x32_bf16 a[44:47], v[12:15], v[36:39], a[44:47]
  v_mfma_f32_16x16x32_bf16 a[48:51], v[16:19], v[36:39], a[48:51]
  buffer_load_dwordx4 v[120:123], v1, s[8:11], s30 offen offset:2048
  v_mfma_f32_16x16x32_bf16 a[52:55], v[20:23], v[36:39], a[52:55]
  v_mfma_f32_16x16x32_bf16 a[56:59], v[24:27], v[36:39], a[56:59]
  buffer_load_dwordx4 v[124:127], v1, s[8:11], s31 offen offset:2048
  v_mfma_f32_16x16x32_bf16 a[60:63], v[8:11], v[40:43], a[60:63]
  v_mfma_f32_16x16x32_bf16 a[64:67], v[12:15], v[40:43], a[64:67]
  buffer_load_dwordx4 v[128:131], v1, s[8:11], s32 offen offset:2048
  v_mfma_f32_16x16x32_bf16 a[68:71], v[16:19], v[40:43], a[68:71]
  v_mfma_f32_16x16x32_bf16 a[72:75], v[20:23], v[40:43], a[72:75]
  buffer_load_dwordx4 v[132:135], v1, s[8:11], s33 offen offset:2048
  v_mfma_f32_16x16x32_bf16 a[76:79], v[24:27], v[40:43], a[76:79]
  v_mfma_f32_16x16x32_bf16 a[80:83], v[8:11], v[44:47], a[80:83]
  buffer_load_dwordx4 v[136:139], v1, s[8:11], s34 offen offset:2048
  v_mfma_f32_16x16x32_bf16 a[84:87], v[12:15], v[44:47], a[84:87]
  v_mfma_f32_16x16x32_bf16 a[88:91], v[16:19], v[44:47], a[88:91]
  v_mfma_f32_16x16x32_bf16 a[92:95], v[20:23], v[44:47], a[92:95]
  v_mfma_f32_16x16x32_bf16 a[96:99], v[24:27], v[44:47], a[96:99]
  v_mfma_f32_16x16x32_bf16 a[100:103], v[8:11], v[48:51], a[100:103]
  v_mfma_f32_16x16x32_bf16 a[104:107], v[12:15], v[48:51], a[104:107]
  v_mfma_f32_16x16x32_bf16 a[108:111], v[16:19], v[48:51], a[108:111]
  v_mfma_f32_16x16x32_bf16 a[112:115], v[20:23], v[48:51], a[112:115]
  v_mfma_f32_16x16x32_bf16 a[116:119], v[24:27], v[48:51], a[116:119]
  s_waitcnt vmcnt(11)
  v_mfma_f32_16x16x32_bf16 a[0:3], v[52:55], v[72:75], a[0:3]
  buffer_load_dwordx4 v[8:11], v1, s[8:11], s24 offen offset:3072
  v_mfma_f32_16x16x32_bf16 a[4:7], v[56:59], v[72:75], a[4:7]
  v_mfma_f32_16x16x32_bf16 a[8:11], v[60:63], v[72:75], a[8:11]
  buffer_load_dwordx4 v[12:15], v1, s[8:11], s25 offen offset:3072
  v_mfma_f32_16x16x32_bf16 a[12:15], v[64:67], v[72:75], a[12:15]
  v_mfma_f32_16x16x32_bf16 a[16:19], v[68:71], v[72:75], a[16:19]
  buffer_load_dwordx4 v[16:19], v1, s[8:11], s26 offen offset:3072
  v_mfma_f32_16x16x32_bf16 a[20:23], v[52:55], v[76:79], a[20:23]
  v_mfma_f32_16x16x32_bf16 a[24:27], v[56:59], v[76:79], a[24:27]
  buffer_load_dwordx4 v[20:23], v1, s[8:11], s27 offen offset:3072
  v_mfma_f32_16x16x32_bf16 a[28:31], v[60:63], v[76:79], a[28:31]
  v_mfma_f32_16x16x32_bf16 a[32:35], v[64:67], v[76:79], a[32:35]
  buffer_load_dwordx4 v[24:27], v1, s[8:11], s28 offen offset:3072
  v_mfma_f32_16x16x32_bf16 a[36:39], v[68:71], v[76:79], a[36:39]
  v_mfma_f32_16x16x32_bf16 a[40:43], v[52:55], v[80:83], a[40:43]
  buffer_load_dwordx4 v[28:31], v1, s[8:11], s29 offen offset:3072
  v_mfma_f32_16x16x32_bf16 a[44:47], v[56:59], v[80:83], a[44:47]
  v_mfma_f32_16x16x32_bf16 a[48:51], v[60:63], v[80:83], a[48:51]
  buffer_load_dwordx4 v[32:35], v1, s[8:11], s30 offen offset:3072
  v_mfma_f32_16x16x32_bf16 a[52:55], v[64:67], v[80:83], a[52:55]
  v_mfma_f32_16x16x32_bf16 a[56:59], v[68:71], v[80:83], a[56:59]
  buffer_load_dwordx4 v[36:39], v1, s[8:11], s31 offen offset:3072
  v_mfma_f32_16x16x32_bf16 a[60:63], v[52:55], v[84:87], a[60:63]
  v_mfma_f32_16x16x32_bf16 a[64:67], v[56:59], v[84:87], a[64:67]
  buffer_load_dwordx4 v[40:43], v1, s[8:11], s32 offen offset:3072
  v_mfma_f32_16x16x32_bf16 a[68:71], v[60:63], v[84:87], a[68:71]
  v_mfma_f32_16x16x32_bf16 a[72:75], v[64:67], v[84:87], a[72:75]
  buffer_load_dwordx4 v[44:47], v1, s[8:11], s33 offen offset:3072
  v_mfma_f32_16x16x32_bf16 a[76:79], v[68:71], v[84:87], a[76:79]
  v_mfma_f32_16x16x32_bf16 a[80:83], v[52:55], v[88:91], a[80:83]
  buffer_load_dwordx4 v[48:51], v1, s[8:11], s34 offen offset:3072
  v_mfma_f32_16x16x32_bf16 a[84:87], v[56:59], v[88:91], a[84:87]
  v_mfma_f32_16x16x32_bf16 a[88:91], v[60:63], v[88:91], a[88:91]
  v_mfma_f32_16x16x32_bf16 a[92:95], v[64:67], v[88:91], a[92:95]
  v_mfma_f32_16x16x32_bf16 a[96:99], v[68:71], v[88:91], a[96:99]
  v_mfma_f32_16x16x32_bf16 a[100:103], v[52:55], v[92:95], a[100:103]
  v_mfma_f32_16x16x32_bf16 a[104:107], v[56:59], v[92:95], a[104:107]
  v_mfma_f32_16x16x32_bf16 a[108:111], v[60:63], v[92:95], a[108:111]
  v_mfma_f32_16x16x32_bf16 a[112:115], v[64:67], v[92:95], a[112:115]
  v_mfma_f32_16x16x32_bf16 a[116:119], v[68:71], v[92:95], a[116:119]
  s_waitcnt vmcnt(11)
  v_mfma_f32_16x16x32_bf16 a[0:3], v[96:99], v[116:119], a[0:3]
  s_add_u32 s24, s24, 4096
  s_add_u32 s25, s25, 4096
  s_add_u32 s26, s26, 4096
  s_add_u32 s27, s27, 4096
  s_add_u32 s28, s28, 4096
  s_add_u32 s29, s29, 4096
  s_add_u32 s30, s30, 4096
  s_add_u32 s31, s31, 4096
  s_add_u32 s32, s32, 4096
  s_add_u32 s33, s33, 4096
  s_add_u32 s34, s34, 4096
  buffer_load_dwordx4 v[52:55], v1, s[8:11], s24 offen offset:0
  v_mfma_f32_16x16x32_bf16 a[4:7], v[100:103], v[116:119], a[4:7]
  v_mfma_f32_16x16x32_bf16 a[8:11], v[104:107], v[116:119], a[8:11]
  buffer_load_dwordx4 v[56:59], v1, s[8:11], s25 offen offset:0
  v_mfma_f32_16x16x32_bf16 a[12:15], v[108:111], v[116:119], a[12:15]
  v_mfma_f32_16x16x32_bf16 a[16:19], v[112:115], v[116:119], a[16:19]
  buffer_load_dwordx4 v[60:63], v1, s[8:11], s26 offen offset:0
  v_mfma_f32_16x16x32_bf16 a[20:23], v[96:99], v[120:123], a[20:23]
  v_mfma_f32_16x16x32_bf16 a[24:27], v[100:103], v[120:123], a[24:27]
  buffer_load_dwordx4 v[64:67], v1, s[8:11], s27 offen offset:0
  v_mfma_f32_16x16x32_bf16 a[28:31], v[104:107], v[120:123], a[28:31]
  v_mfma_f32_16x16x32_bf16 a[32:35], v[108:111], v[120:123], a[32:35]
  buffer_load_dwordx4 v[68:71], v1, s[8:11], s28 offen offset:0
  v_mfma_f32_16x16x32_bf16 a[36:39], v[112:115], v[120:123], a[36:39]
  v_mfma_f32_16x16x32_bf16 a[40:43], v[96:99], v[124:127], a[40:43]
  buffer_load_dwordx4 v[72:75], v1, s[8:11], s29 offen offset:0
  v_mfma_f32_16x16x32_bf16 a[44:47], v[100:103], v[124:127], a[44:47]
  v_mfma_f32_16x16x32_bf16 a[48:51], v[104:107], v[124:127], a[48:51]
  buffer_load_dwordx4 v[76:79], v1, s[8:11], s30 offen offset:0
  v_mfma_f32_16x16x32_bf16 a[52:55], v[108:111], v[124:127], a[52:55]
  v_mfma_f32_16x16x32_bf16 a[56:59], v[112:115], v[124:127], a[56:59]
  buffer_load_dwordx4 v[80:83], v1, s[8:11], s31 offen offset:0
  v_mfma_f32_16x16x32_bf16 a[60:63], v[96:99], v[128:131], a[60:63]
  v_mfma_f32_16x16x32_bf16 a[64:67], v[100:103], v[128:131], a[64:67]
  buffer_load_dwordx4 v[84:87], v1, s[8:11], s32 offen offset:0
  v_mfma_f32_16x16x32_bf16 a[68:71], v[104:107], v[128:131], a[68:71]
  v_mfma_f32_16x16x32_bf16 a[72:75], v[108:111], v[128:131], a[72:75]
  buffer_load_dwordx4 v[88:91], v1, s[8:11], s33 offen offset:0
  v_mfma_f32_16x16x32_bf16 a[76:79], v[112:115], v[128:131], a[76:79]
  v_mfma_f32_16x16x32_bf16 a[80:83], v[96:99], v[132:135], a[80:83]
  buffer_load_dwordx4 v[92:95], v1, s[8:11], s34 offen offset:0
  v_mfma_f32_16x16x32_bf16 a[84:87], v[100:103], v[132:135], a[84:87]
  v_mfma_f32_16x16x32_bf16 a[88:91], v[104:107], v[132:135], a[88:91]
  v_mfma_f32_16x16x32_bf16 a[92:95], v[108:111], v[132:135], a[92:95]
  v_mfma_f32_16x16x32_bf16 a[96:99], v[112:115], v[132:135], a[96:99]
  v_mfma_f32_16x16x32_bf16 a[100:103], v[96:99], v[136:139], a[100:103]
  v_mfma_f32_16x16x32_bf16 a[104:107], v[100:103], v[136:139], a[104:107]
  v_mfma_f32_16x16x32_bf16 a[108:111], v[104:107], v[136:139], a[108:111]
  v_mfma_f32_16x16x32_bf16 a[112:115], v[108:111], v[136:139], a[112:115]
  v_mfma_f32_16x16x32_bf16 a[116:119], v[112:115], v[136:139], a[116:119]
  s_waitcnt vmcnt(11)
  v_mfma_f32_16x16x32_bf16 a[0:3], v[8:11], v[28:31], a[0:3]
  buffer_load_dwordx4 v[96:99], v1, s[8:11], s24 offen offset:1024
  v_mfma_f32_16x16x32_bf16 a[4:7], v[12:15], v[28:31], a[4:7]
  v_mfma_f32_16x16x32_bf16 a[8:11], v[16:19], v[28:31], a[8:11]
  buffer_load_dwordx4 v[100:103], v1, s[8:11], s25 offen offset:1024
  v_mfma_f32_16x16x32_bf16 a[12:15], v[20:23], v[28:31], a[12:15]
  v_mfma_f32_16x16x32_bf16 a[16:19], v[24:27], v[28:31], a[16:19]
  buffer_load_dwordx4 v[104:107], v1, s[8:11], s26 offen offset:1024
  v_mfma_f32_16x16x32_bf16 a[20:23], v[8:11], v[32:35], a[20:23]
  v_mfma_f32_16x16x32_bf16 a[24:27], v[12:15], v[32:35], a[24:27]
  buffer_load_dwordx4 v[108:111], v1, s[8:11], s27 offen offset:1024
  v_mfma_f32_16x16x32_bf16 a[28:31], v[16:19], v[32:35], a[28:31]
  v_mfma_f32_16x16x32_bf16 a[32:35], v[20:23], v[32:35], a[32:35]
  buffer_load_dwordx4 v[112:115], v1, s[8:11], s28 offen offset:1024
  v_mfma_f32_16x16x32_bf16 a[36:39], v[24:27], v[32:35], a[36:39]
  v_mfma_f32_16x16x32_bf16 a[40:43], v[8:11], v[36:39], a[40:43]
  buffer_load_dwordx4 v[116:119], v1, s[8:11], s29 offen offset:1024
  v_mfma_f32_16x16x32_bf16 a[44:47], v[12:15], v[36:39], a[44:47]
  v_mfma_f32_16x16x32_bf16 a[48:51], v[16:19], v[36:39], a[48:51]
  buffer_load_dwordx4 v[120:123], v1, s[8:11], s30 offen offset:1024
  v_mfma_f32_16x16x32_bf16 a[52:55], v[20:23], v[36:39], a[52:55]
  v_mfma_f32_16x16x32_bf16 a[56:59], v[24:27], v[36:39], a[56:59]
  buffer_load_dwordx4 v[124:127], v1, s[8:11], s31 offen offset:1024
  v_mfma_f32_16x16x32_bf16 a[60:63], v[8:11], v[40:43], a[60:63]
  v_mfma_f32_16x16x32_bf16 a[64:67], v[12:15], v[40:43], a[64:67]
  buffer_load_dwordx4 v[128:131], v1, s[8:11], s32 offen offset:1024
  v_mfma_f32_16x16x32_bf16 a[68:71], v[16:19], v[40:43], a[68:71]
  v_mfma_f32_16x16x32_bf16 a[72:75], v[20:23], v[40:43], a[72:75]
  buffer_load_dwordx4 v[132:135], v1, s[8:11], s33 offen offset:1024
  v_mfma_f32_16x16x32_bf16 a[76:79], v[24:27], v[40:43], a[76:79]
  v_mfma_f32_16x16x32_bf16 a[80:83], v[8:11], v[44:47], a[80:83]
  buffer_load_dwordx4 v[136:139], v1, s[8:11], s34 offen offset:1024
  v_mfma_f32_16x16x32_bf16 a[84:87], v[12:15], v[44:47], a[84:87]
  v_mfma_f32_16x16x32_bf16 a[88:91], v[16:19], v[44:47], a[88:91]
  v_mfma_f32_16x16x32_bf16 a[92:95], v[20:23], v[44:47], a[92:95]
  v_mfma_f32_16x16x32_bf16 a[96:99], v[24:27], v[44:47], a[96:99]
  v_mfma_f32_16x16x32_bf16 a[100:103], v[8:11], v[48:51], a[100:103]
  v_mfma_f32_16x16x32_bf16 a[104:107], v[12:15], v[48:51], a[104:107]
  v_mfma_f32_16x16x32_bf16 a[108:111], v[16:19], v[48:51], a[108:111]
  v_mfma_f32_16x16x32_bf16 a[112:115], v[20:23], v[48:51], a[112:115]
  v_mfma_f32_16x16x32_bf16 a[116:119], v[24:27], v[48:51], a[116:119]
  s_waitcnt vmcnt(11)
  v_mfma_f32_16x16x32_bf16 a[0:3], v[52:55], v[72:75], a[0:3]
  buffer_load_dwordx4 v[8:11], v1, s[8:11], s24 offen offset:2048
  v_mfma_f32_16x16x32_bf16 a[4:7], v[56:59], v[72:75], a[4:7]
  v_mfma_f32_16x16x32_bf16 a[8:11], v[60:63], v[72:75], a[8:11]
  buffer_load_dwordx4 v[12:15], v1, s[8:11], s25 offen offset:2048
  v_mfma_f32_16x16x32_bf16 a[12:15], v[64:67], v[72:75], a[12:15]
  v_mfma_f32_16x16x32_bf16 a[16:19], v[68:71], v[72:75], a[16:19]
  buffer_load_dwordx4 v[16:19], v1, s[8:11], s26 offen offset:2048
  v_mfma_f32_16x16x32_bf16 a[20:23], v[52:55], v[76:79], a[20:23]
  v_mfma_f32_16x16x32_bf16 a[24:27], v[56:59], v[76:79], a[24:27]
  buffer_load_dwordx4 v[20:23], v1, s[8:11], s27 offen offset:2048
  v_mfma_f32_16x16x32_bf16 a[28:31], v[60:63], v[76:79], a[28:31]
  v_mfma_f32_16x16x32_bf16 a[32:35], v[64:67], v[76:79], a[32:35]
  buffer_load_dwordx4 v[24:27], v1, s[8:11], s28 offen offset:2048
  v_mfma_f32_16x16x32_bf16 a[36:39], v[68:71], v[76:79], a[36:39]
  v_mfma_f32_16x16x32_bf16 a[40:43], v[52:55], v[80:83], a[40:43]
  buffer_load_dwordx4 v[28:31], v1, s[8:11], s29 offen offset:2048
  v_mfma_f32_16x16x32_bf16 a[44:47], v[56:59], v[80:83], a[44:47]
  v_mfma_f32_16x16x32_bf16 a[48:51], v[60:63], v[80:83], a[48:51]
  buffer_load_dwordx4 v[32:35], v1, s[8:11], s30 offen offset:2048
  v_mfma_f32_16x16x32_bf16 a[52:55], v[64:67], v[80:83], a[52:55]
  v_mfma_f32_16x16x32_bf16 a[56:59], v[68:71], v[80:83], a[56:59]
  buffer_load_dwordx4 v[36:39], v1, s[8:11], s31 offen offset:2048
  v_mfma_f32_16x16x32_bf16 a[60:63], v[52:55], v[84:87], a[60:63]
  v_mfma_f32_16x16x32_bf16 a[64:67], v[56:59], v[84:87], a[64:67]
  buffer_load_dwordx4 v[40:43], v1, s[8:11], s32 offen offset:2048
  v_mfma_f32_16x16x32_bf16 a[68:71], v[60:63], v[84:87], a[68:71]
  v_mfma_f32_16x16x32_bf16 a[72:75], v[64:67], v[84:87], a[72:75]
  buffer_load_dwordx4 v[44:47], v1, s[8:11], s33 offen offset:2048
  v_mfma_f32_16x16x32_bf16 a[76:79], v[68:71], v[84:87], a[76:79]
  v_mfma_f32_16x16x32_bf16 a[80:83], v[52:55], v[88:91], a[80:83]
  buffer_load_dwordx4 v[48:51], v1, s[8:11], s34 offen offset:2048
  v_mfma_f32_16x16x32_bf16 a[84:87], v[56:59], v[88:91], a[84:87]
  v_mfma_f32_16x16x32_bf16 a[88:91], v[60:63], v[88:91], a[88:91]
  v_mfma_f32_16x16x32_bf16 a[92:95], v[64:67], v[88:91], a[92:95]
  v_mfma_f32_16x16x32_bf16 a[96:99], v[68:71], v[88:91], a[96:99]
  v_mfma_f32_16x16x32_bf16 a[100:103], v[52:55], v[92:95], a[100:103]
  v_mfma_f32_16x16x32_bf16 a[104:107], v[56:59], v[92:95], a[104:107]
  v_mfma_f32_16x16x32_bf16 a[108:111], v[60:63], v[92:95], a[108:111]
  v_mfma_f32_16x16x32_bf16 a[112:115], v[64:67], v[92:95], a[112:115]
  v_mfma_f32_16x16x32_bf16 a[116:119], v[68:71], v[92:95], a[116:119]
  s_waitcnt vmcnt(11)
  v_mfma_f32_16x16x32_bf16 a[0:3], v[96:99], v[116:119], a[0:3]
  buffer_load_dwordx4 v[52:55], v1, s[8:11], s24 offen offset:3072
  v_mfma_f32_16x16x32_bf16 a[4:7], v[100:103], v[116:119], a[4:7]
  v_mfma_f32_16x16x32_bf16 a[8:11], v[104:107], v[116:119], a[8:11]
  buffer_load_dwordx4 v[56:59], v1, s[8:11], s25 offen offset:3072
  v_mfma_f32_16x16x32_bf16 a[12:15], v[108:111], v[116:119], a[12:15]
  v_mfma_f32_16x16x32_bf16 a[16:19], v[112:115], v[116:119], a[16:19]
  buffer_load_dwordx4 v[60:63], v1, s[8:11], s26 offen offset:3072
  v_mfma_f32_16x16x32_bf16 a[20:23], v[96:99], v[120:123], a[20:23]
  v_mfma_f32_16x16x32_bf16 a[24:27], v[100:103], v[120:123], a[24:27]
  buffer_load_dwordx4 v[64:67], v1, s[8:11], s27 offen offset:3072
  v_mfma_f32_16x16x32_bf16 a[28:31], v[104:107], v[120:123], a[28:31]
  v_mfma_f32_16x16x32_bf16 a[32:35], v[108:111], v[120:123], a[32:35]
  buffer_load_dwordx4 v[68:71], v1, s[8:11], s28 offen offset:3072
  v_mfma_f32_16x16x32_bf16 a[36:39], v[112:115], v[120:123], a[36:39]
  v_mfma_f32_16x16x32_bf16 a[40:43], v[96:99], v[124:127], a[40:43]
  buffer_load_dwordx4 v[72:75], v1, s[8:11], s29 offen offset:3072
  v_mfma_f32_16x16x32_bf16 a[44:47], v[100:103], v[124:127], a[44:47]
  v_mfma_f32_16x16x32_bf16 a[48:51], v[104:107], v[124:127], a[48:51]
  buffer_load_dwordx4 v[76:79], v1, s[8:11], s30 offen offset:3072
  v_mfma_f32_16x16x32_bf16 a[52:55], v[108:111], v[124:127], a[52:55]
  v_mfma_f32_16x16x32_bf16 a[56:59], v[112:115], v[124:127], a[56:59]
  buffer_load_dwordx4 v[80:83], v1, s[8:11], s31 offen offset:3072
  v_mfma_f32_16x16x32_bf16 a[60:63], v[96:99], v[128:131], a[60:63]
  v_mfma_f32_16x16x32_bf16 a[64:67], v[100:103], v[128:131], a[64:67]
  buffer_load_dwordx4 v[84:87], v1, s[8:11], s32 offen offset:3072
  v_mfma_f32_16x16x32_bf16 a[68:71], v[104:107], v[128:131], a[68:71]
  v_mfma_f32_16x16x32_bf16 a[72:75], v[108:111], v[128:131], a[72:75]
  buffer_load_dwordx4 v[88:91], v1, s[8:11], s33 offen offset:3072
  v_mfma_f32_16x16x32_bf16 a[76:79], v[112:115], v[128:131], a[76:79]
  v_mfma_f32_16x16x32_bf16 a[80:83], v[96:99], v[132:135], a[80:83]
  buffer_load_dwordx4 v[92:95], v1, s[8:11], s34 offen offset:3072
  v_mfma_f32_16x16x32_bf16 a[84:87], v[100:103], v[132:135], a[84:87]
  v_mfma_f32_16x16x32_bf16 a[88:91], v[104:107], v[132:135], a[88:91]
  v_mfma_f32_16x16x32_bf16 a[92:95], v[108:111], v[132:135], a[92:95]
  v_mfma_f32_16x16x32_bf16 a[96:99], v[112:115], v[132:135], a[96:99]
  v_mfma_f32_16x16x32_bf16 a[100:103], v[96:99], v[136:139], a[100:103]
  v_mfma_f32_16x16x32_bf16 a[104:107], v[100:103], v[136:139], a[104:107]
  v_mfma_f32_16x16x32_bf16 a[108:111], v[104:107], v[136:139], a[108:111]
  v_mfma_f32_16x16x32_bf16 a[112:115], v[108:111], v[136:139], a[112:115]
  v_mfma_f32_16x16x32_bf16 a[116:119], v[112:115], v[136:139], a[116:119]
  s_waitcnt vmcnt(11)
  v_mfma_f32_16x16x32_bf16 a[0:3], v[8:11], v[28:31], a[0:3]
  s_add_u32 s24, s24, 4096
  s_add_u32 s25, s25, 4096
  s_add_u32 s26, s26, 4096
  s_add_u32 s27, s27, 4096
  s_add_u32 s28, s28, 4096
  s_add_u32 s29, s29, 4096
  s_add_u32 s30, s30, 4096
  s_add_u32 s31, s31, 4096
  s_add_u32 s32, s32, 4096
  s_add_u32 s33, s33, 4096
  s_add_u32 s34, s34, 4096
  buffer_load_dwordx4 v[96:99], v1, s[8:11], s24 offen offset:0
  v_mfma_f32_16x16x32_bf16 a[4:7], v[12:15], v[28:31], a[4:7]
  v_mfma_f32_16x16x32_bf16 a[8:11], v[16:19], v[28:31], a[8:11]
  buffer_load_dwordx4 v[100:103], v1, s[8:11], s25 offen offset:0
  v_mfma_f32_16x16x32_bf16 a[12:15], v[20:23], v[28:31], a[12:15]
  v_mfma_f32_16x16x32_bf16 a[16:19], v[24:27], v[28:31], a[16:19]
  buffer_load_dwordx4 v[104:107], v1, s[8:11], s26 offen offset:0
  v_mfma_f32_16x16x32_bf16 a[20:23], v[8:11], v[32:35], a[20:23]
  v_mfma_f32_16x16x32_bf16 a[24:27], v[12:15], v[32:35], a[24:27]
  buffer_load_dwordx4 v[108:111], v1, s[8:11], s27 offen offset:0
  v_mfma_f32_16x16x32_bf16 a[28:31], v[16:19], v[32:35], a[28:31]
  v_mfma_f32_16x16x32_bf16 a[32:35], v[20:23], v[32:35], a[32:35]
  buffer_load_dwordx4 v[112:115], v1, s[8:11], s28 offen offset:0
  v_mfma_f32_16x16x32_bf16 a[36:39], v[24:27], v[32:35], a[36:39]
  v_mfma_f32_16x16x32_bf16 a[40:43], v[8:11], v[36:39], a[40:43]
  buffer_load_dwordx4 v[116:119], v1, s[8:11], s29 offen offset:0
  v_mfma_f32_16x16x32_bf16 a[44:47], v[12:15], v[36:39], a[44:47]
  v_mfma_f32_16x16x32_bf16 a[48:51], v[16:19], v[36:39], a[48:51]
  buffer_load_dwordx4 v[120:123], v1, s[8:11], s30 offen offset:0
  v_mfma_f32_16x16x32_bf16 a[52:55], v[20:23], v[36:39], a[52:55]
  v_mfma_f32_16x16x32_bf16 a[56:59], v[24:27], v[36:39], a[56:59]
  buffer_load_dwordx4 v[124:127], v1, s[8:11], s31 offen offset:0
  v_mfma_f32_16x16x32_bf16 a[60:63], v[8:11], v[40:43], a[60:63]
  v_mfma_f32_16x16x32_bf16 a[64:67], v[12:15], v[40:43], a[64:67]
  buffer_load_dwordx4 v[128:131], v1, s[8:11], s32 offen offset:0
  v_mfma_f32_16x16x32_bf16 a[68:71], v[16:19], v[40:43], a[68:71]
  v_mfma_f32_16x16x32_bf16 a[72:75], v[20:23], v[40:43], a[72:75]
  buffer_load_dwordx4 v[132:135], v1, s[8:11], s33 offen offset:0
  v_mfma_f32_16x16x32_bf16 a[76:79], v[24:27], v[40:43], a[76:79]
  v_mfma_f32_16x16x32_bf16 a[80:83], v[8:11], v[44:47], a[80:83]
  buffer_load_dwordx4 v[136:139], v1, s[8:11], s34 offen offset:0
  v_mfma_f32_16x16x32_bf16 a[84:87], v[12:15], v[44:47], a[84:87]
  v_mfma_f32_16x16x32_bf16 a[88:91], v[16:19], v[44:47], a[88:91]
  v_mfma_f32_16x16x32_bf16 a[92:95], v[20:23], v[44:47], a[92:95]
  v_mfma_f32_16x16x32_bf16 a[96:99], v[24:27], v[44:47], a[96:99]
  v_mfma_f32_16x16x32_bf16 a[100:103], v[8:11], v[48:51], a[100:103]
  v_mfma_f32_16x16x32_bf16 a[104:107], v[12:15], v[48:51], a[104:107]
  v_mfma_f32_16x16x32_bf16 a[108:111], v[16:19], v[48:51], a[108:111]
  v_mfma_f32_16x16x32_bf16 a[112:115], v[20:23], v[48:51], a[112:115]
  v_mfma_f32_16x16x32_bf16 a[116:119], v[24:27], v[48:51], a[116:119]
  s_waitcnt vmcnt(11)
  v_mfma_f32_16x16x32_bf16 a[0:3], v[52:55], v[72:75], a[0:3]
  buffer_load_dwordx4 v[8:11], v1, s[8:11], s24 offen offset:1024
  v_mfma_f32_16x16x32_bf16 a[4:7], v[56:59], v[72:75], a[4:7]
  v_mfma_f32_16x16x32_bf16 a[8:11], v[60:63], v[72:75], a[8:11]
  buffer_load_dwordx4 v[12:15], v1, s[8:11], s25 offen offset:1024
  v_mfma_f32_16x16x32_bf16 a[12:15], v[64:67], v[72:75], a[12:15]
  v_mfma_f32_16x16x32_bf16 a[16:19], v[68:71], v[72:75], a[16:19]
  buffer_load_dwordx4 v[16:19], v1, s[8:11], s26 offen offset:1024
  v_mfma_f32_16x16x32_bf16 a[20:23], v[52:55], v[76:79], a[20:23]
  v_mfma_f32_16x16x32_bf16 a[24:27], v[56:59], v[76:79], a[24:27]
  buffer_load_dwordx4 v[20:23], v1, s[8:11], s27 offen offset:1024
  v_mfma_f32_16x16x32_bf16 a[28:31], v[60:63], v[76:79], a[28:31]
  v_mfma_f32_16x16x32_bf16 a[32:35], v[64:67], v[76:79], a[32:35]
  buffer_load_dwordx4 v[24:27], v1, s[8:11], s28 offen offset:1024
  v_mfma_f32_16x16x32_bf16 a[36:39], v[68:71], v[76:79], a[36:39]
  v_mfma_f32_16x16x32_bf16 a[40:43], v[52:55], v[80:83], a[40:43]
  buffer_load_dwordx4 v[28:31], v1, s[8:11], s29 offen offset:1024
  v_mfma_f32_16x16x32_bf16 a[44:47], v[56:59], v[80:83], a[44:47]
  v_mfma_f32_16x16x32_bf16 a[48:51], v[60:63], v[80:83], a[48:51]
  buffer_load_dwordx4 v[32:35], v1, s[8:11], s30 offen offset:1024
  v_mfma_f32_16x16x32_bf16 a[52:55], v[64:67], v[80:83], a[52:55]
  v_mfma_f32_16x16x32_bf16 a[56:59], v[68:71], v[80:83], a[56:59]
  buffer_load_dwordx4 v[36:39], v1, s[8:11], s31 offen offset:1024
  v_mfma_f32_16x16x32_bf16 a[60:63], v[52:55], v[84:87], a[60:63]
  v_mfma_f32_16x16x32_bf16 a[64:67], v[56:59], v[84:87], a[64:67]
  buffer_load_dwordx4 v[40:43], v1, s[8:11], s32 offen offset:1024
  v_mfma_f32_16x16x32_bf16 a[68:71], v[60:63], v[84:87], a[68:71]
  v_mfma_f32_16x16x32_bf16 a[72:75], v[64:67], v[84:87], a[72:75]
  buffer_load_dwordx4 v[44:47], v1, s[8:11], s33 offen offset:1024
  v_mfma_f32_16x16x32_bf16 a[76:79], v[68:71], v[84:87], a[76:79]
  v_mfma_f32_16x16x32_bf16 a[80:83], v[52:55], v[88:91], a[80:83]
  buffer_load_dwordx4 v[48:51], v1, s[8:11], s34 offen offset:1024
  v_mfma_f32_16x16x32_bf16 a[84:87], v[56:59], v[88:91], a[84:87]
  v_mfma_f32_16x16x32_bf16 a[88:91], v[60:63], v[88:91], a[88:91]
  v_mfma_f32_16x16x32_bf16 a[92:95], v[64:67], v[88:91], a[92:95]
  v_mfma_f32_16x16x32_bf16 a[96:99], v[68:71], v[88:91], a[96:99]
  v_mfma_f32_16x16x32_bf16 a[100:103], v[52:55], v[92:95], a[100:103]
  v_mfma_f32_16x16x32_bf16 a[104:107], v[56:59], v[92:95], a[104:107]
  v_mfma_f32_16x16x32_bf16 a[108:111], v[60:63], v[92:95], a[108:111]
  v_mfma_f32_16x16x32_bf16 a[112:115], v[64:67], v[92:95], a[112:115]
  v_mfma_f32_16x16x32_bf16 a[116:119], v[68:71], v[92:95], a[116:119]
  s_waitcnt vmcnt(11)
  v_mfma_f32_16x16x32_bf16 a[0:3], v[96:99], v[116:119], a[0:3]
  buffer_load_dwordx4 v[52:55], v1, s[8:11], s24 offen offset:2048
  v_mfma_f32_16x16x32_bf16 a[4:7], v[100:103], v[116:119], a[4:7]
  v_mfma_f32_16x16x32_bf16 a[8:11], v[104:107], v[116:119], a[8:11]
  buffer_load_dwordx4 v[56:59], v1, s[8:11], s25 offen offset:2048
  v_mfma_f32_16x16x32_bf16 a[12:15], v[108:111], v[116:119], a[12:15]
  v_mfma_f32_16x16x32_bf16 a[16:19], v[112:115], v[116:119], a[16:19]
  buffer_load_dwordx4 v[60:63], v1, s[8:11], s26 offen offset:2048
  v_mfma_f32_16x16x32_bf16 a[20:23], v[96:99], v[120:123], a[20:23]
  v_mfma_f32_16x16x32_bf16 a[24:27], v[100:103], v[120:123], a[24:27]
  buffer_load_dwordx4 v[64:67], v1, s[8:11], s27 offen offset:2048
  v_mfma_f32_16x16x32_bf16 a[28:31], v[104:107], v[120:123], a[28:31]
  v_mfma_f32_16x16x32_bf16 a[32:35], v[108:111], v[120:123], a[32:35]
  buffer_load_dwordx4 v[68:71], v1, s[8:11], s28 offen offset:2048
  v_mfma_f32_16x16x32_bf16 a[36:39], v[112:115], v[120:123], a[36:39]
  v_mfma_f32_16x16x32_bf16 a[40:43], v[96:99], v[124:127], a[40:43]
  buffer_load_dwordx4 v[72:75], v1, s[8:11], s29 offen offset:2048
  v_mfma_f32_16x16x32_bf16 a[44:47], v[100:103], v[124:127], a[44:47]
  v_mfma_f32_16x16x32_bf16 a[48:51], v[104:107], v[124:127], a[48:51]
  buffer_load_dwordx4 v[76:79], v1, s[8:11], s30 offen offset:2048
  v_mfma_f32_16x16x32_bf16 a[52:55], v[108:111], v[124:127], a[52:55]
  v_mfma_f32_16x16x32_bf16 a[56:59], v[112:115], v[124:127], a[56:59]
  buffer_load_dwordx4 v[80:83], v1, s[8:11], s31 offen offset:2048
  v_mfma_f32_16x16x32_bf16 a[60:63], v[96:99], v[128:131], a[60:63]
  v_mfma_f32_16x16x32_bf16 a[64:67], v[100:103], v[128:131], a[64:67]
  buffer_load_dwordx4 v[84:87], v1, s[8:11], s32 offen offset:2048
  v_mfma_f32_16x16x32_bf16 a[68:71], v[104:107], v[128:131], a[68:71]
  v_mfma_f32_16x16x32_bf16 a[72:75], v[108:111], v[128:131], a[72:75]
  buffer_load_dwordx4 v[88:91], v1, s[8:11], s33 offen offset:2048
  v_mfma_f32_16x16x32_bf16 a[76:79], v[112:115], v[128:131], a[76:79]
  v_mfma_f32_16x16x32_bf16 a[80:83], v[96:99], v[132:135], a[80:83]
  buffer_load_dwordx4 v[92:95], v1, s[8:11], s34 offen offset:2048
  v_mfma_f32_16x16x32_bf16 a[84:87], v[100:103], v[132:135], a[84:87]
  v_mfma_f32_16x16x32_bf16 a[88:91], v[104:107], v[132:135], a[88:91]
  v_mfma_f32_16x16x32_bf16 a[92:95], v[108:111], v[132:135], a[92:95]
  v_mfma_f32_16x16x32_bf16 a[96:99], v[112:115], v[132:135], a[96:99]
  v_mfma_f32_16x16x32_bf16 a[100:103], v[96:99], v[136:139], a[100:103]
  v_mfma_f32_16x16x32_bf16 a[104:107], v[100:103], v[136:139], a[104:107]
  v_mfma_f32_16x16x32_bf16 a[108:111], v[104:107], v[136:139], a[108:111]
  v_mfma_f32_16x16x32_bf16 a[112:115], v[108:111], v[136:139], a[112:115]
  v_mfma_f32_16x16x32_bf16 a[116:119], v[112:115], v[136:139], a[116:119]
  s_waitcnt vmcnt(11)
  v_mfma_f32_16x16x32_bf16 a[0:3], v[8:11], v[28:31], a[0:3]
  buffer_load_dwordx4 v[96:99], v1, s[8:11], s24 offen offset:3072
  v_mfma_f32_16x16x32_bf16 a[4:7], v[12:15], v[28:31], a[4:7]
  v_mfma_f32_16x16x32_bf16 a[8:11], v[16:19], v[28:31], a[8:11]
  buffer_load_dwordx4 v[100:103], v1, s[8:11], s25 offen offset:3072
  v_mfma_f32_16x16x32_bf16 a[12:15], v[20:23], v[28:31], a[12:15]
  v_mfma_f32_16x16x32_bf16 a[16:19], v[24:27], v[28:31], a[16:19]
  buffer_load_dwordx4 v[104:107], v1, s[8:11], s26 offen offset:3072
  v_mfma_f32_16x16x32_bf16 a[20:23], v[8:11], v[32:35], a[20:23]
  v_mfma_f32_16x16x32_bf16 a[24:27], v[12:15], v[32:35], a[24:27]
  buffer_load_dwordx4 v[108:111], v1, s[8:11], s27 offen offset:3072
  v_mfma_f32_16x16x32_bf16 a[28:31], v[16:19], v[32:35], a[28:31]
  v_mfma_f32_16x16x32_bf16 a[32:35], v[20:23], v[32:35], a[32:35]
  buffer_load_dwordx4 v[112:115], v1, s[8:11], s28 offen offset:3072
  v_mfma_f32_16x16x32_bf16 a[36:39], v[24:27], v[32:35], a[36:39]
  v_mfma_f32_16x16x32_bf16 a[40:43], v[8:11], v[36:39], a[40:43]
  buffer_load_dwordx4 v[116:119], v1, s[8:11], s29 offen offset:3072
  v_mfma_f32_16x16x32_bf16 a[44:47], v[12:15], v[36:39], a[44:47]
  v_mfma_f32_16x16x32_bf16 a[48:51], v[16:19], v[36:39], a[48:51]
  buffer_load_dwordx4 v[120:123], v1, s[8:11], s30 offen offset:3072
  v_mfma_f32_16x16x32_bf16 a[52:55], v[20:23], v[36:39], a[52:55]
  v_mfma_f32_16x16x32_bf16 a[56:59], v[24:27], v[36:39], a[56:59]
  buffer_load_dwordx4 v[124:127], v1, s[8:11], s31 offen offset:3072
  v_mfma_f32_16x16x32_bf16 a[60:63], v[8:11], v[40:43], a[60:63]
  v_mfma_f32_16x16x32_bf16 a[64:67], v[12:15], v[40:43], a[64:67]
  buffer_load_dwordx4 v[128:131], v1, s[8:11], s32 offen offset:3072
  v_mfma_f32_16x16x32_bf16 a[68:71], v[16:19], v[40:43], a[68:71]
  v_mfma_f32_16x16x32_bf16 a[72:75], v[20:23], v[40:43], a[72:75]
  buffer_load_dwordx4 v[132:135], v1, s[8:11], s33 offen offset:3072
  v_mfma_f32_16x16x32_bf16 a[76:79], v[24:27], v[40:43], a[76:79]
  v_mfma_f32_16x16x32_bf16 a[80:83], v[8:11], v[44:47], a[80:83]
  buffer_load_dwordx4 v[136:139], v1, s[8:11], s34 offen offset:3072
  v_mfma_f32_16x16x32_bf16 a[84:87], v[12:15], v[44:47], a[84:87]
  v_mfma_f32_16x16x32_bf16 a[88:91], v[16:19], v[44:47], a[88:91]
  v_mfma_f32_16x16x32_bf16 a[92:95], v[20:23], v[44:47], a[92:95]
  v_mfma_f32_16x16x32_bf16 a[96:99], v[24:27], v[44:47], a[96:99]
  v_mfma_f32_16x16x32_bf16 a[100:103], v[8:11], v[48:51], a[100:103]
  v_mfma_f32_16x16x32_bf16 a[104:107], v[12:15], v[48:51], a[104:107]
  v_mfma_f32_16x16x32_bf16 a[108:111], v[16:19], v[48:51], a[108:111]
  v_mfma_f32_16x16x32_bf16 a[112:115], v[20:23], v[48:51], a[112:115]
  v_mfma_f32_16x16x32_bf16 a[116:119], v[24:27], v[48:51], a[116:119]
  s_waitcnt vmcnt(11)
  v_mfma_f32_16x16x32_bf16 a[0:3], v[52:55], v[72:75], a[0:3]
  s_add_u32 s24, s24, 4096
  s_add_u32 s25, s25, 4096
  s_add_u32 s26, s26, 4096
  s_add_u32 s27, s27, 4096
  s_add_u32 s28, s28, 4096
  s_add_u32 s29, s29, 4096
  s_add_u32 s30, s30, 4096
  s_add_u32 s31, s31, 4096
  s_add_u32 s32, s32, 4096
  s_add_u32 s33, s33, 4096
  s_add_u32 s34, s34, 4096
  buffer_load_dwordx4 v[8:11], v1, s[8:11], s24 offen offset:0
  v_mfma_f32_16x16x32_bf16 a[4:7], v[56:59], v[72:75], a[4:7]
  v_mfma_f32_16x16x32_bf16 a[8:11], v[60:63], v[72:75], a[8:11]
  buffer_load_dwordx4 v[12:15], v1, s[8:11], s25 offen offset:0
  v_mfma_f32_16x16x32_bf16 a[12:15], v[64:67], v[72:75], a[12:15]
  v_mfma_f32_16x16x32_bf16 a[16:19], v[68:71], v[72:75], a[16:19]
  buffer_load_dwordx4 v[16:19], v1, s[8:11], s26 offen offset:0
  v_mfma_f32_16x16x32_bf16 a[20:23], v[52:55], v[76:79], a[20:23]
  v_mfma_f32_16x16x32_bf16 a[24:27], v[56:59], v[76:79], a[24:27]
  buffer_load_dwordx4 v[20:23], v1, s[8:11], s27 offen offset:0
  v_mfma_f32_16x16x32_bf16 a[28:31], v[60:63], v[76:79], a[28:31]
  v_mfma_f32_16x16x32_bf16 a[32:35], v[64:67], v[76:79], a[32:35]
  buffer_load_dwordx4 v[24:27], v1, s[8:11], s28 offen offset:0
  v_mfma_f32_16x16x32_bf16 a[36:39], v[68:71], v[76:79], a[36:39]
  v_mfma_f32_16x16x32_bf16 a[40:43], v[52:55], v[80:83], a[40:43]
  buffer_load_dwordx4 v[28:31], v1, s[8:11], s29 offen offset:0
  v_mfma_f32_16x16x32_bf16 a[44:47], v[56:59], v[80:83], a[44:47]
  v_mfma_f32_16x16x32_bf16 a[48:51], v[60:63], v[80:83], a[48:51]
  buffer_load_dwordx4 v[32:35], v1, s[8:11], s30 offen offset:0
  v_mfma_f32_16x16x32_bf16 a[52:55], v[64:67], v[80:83], a[52:55]
  v_mfma_f32_16x16x32_bf16 a[56:59], v[68:71], v[80:83], a[56:59]
  buffer_load_dwordx4 v[36:39], v1, s[8:11], s31 offen offset:0
  v_mfma_f32_16x16x32_bf16 a[60:63], v[52:55], v[84:87], a[60:63]
  v_mfma_f32_16x16x32_bf16 a[64:67], v[56:59], v[84:87], a[64:67]
  buffer_load_dwordx4 v[40:43], v1, s[8:11], s32 offen offset:0
  v_mfma_f32_16x16x32_bf16 a[68:71], v[60:63], v[84:87], a[68:71]
  v_mfma_f32_16x16x32_bf16 a[72:75], v[64:67], v[84:87], a[72:75]
  buffer_load_dwordx4 v[44:47], v1, s[8:11], s33 offen offset:0
  v_mfma_f32_16x16x32_bf16 a[76:79], v[68:71], v[84:87], a[76:79]
  v_mfma_f32_16x16x32_bf16 a[80:83], v[52:55], v[88:91], a[80:83]
  buffer_load_dwordx4 v[48:51], v1, s[8:11], s34 offen offset:0
  v_mfma_f32_16x16x32_bf16 a[84:87], v[56:59], v[88:91], a[84:87]
  v_mfma_f32_16x16x32_bf16 a[88:91], v[60:63], v[88:91], a[88:91]
  v_mfma_f32_16x16x32_bf16 a[92:95], v[64:67], v[88:91], a[92:95]
  v_mfma_f32_16x16x32_bf16 a[96:99], v[68:71], v[88:91], a[96:99]
  v_mfma_f32_16x16x32_bf16 a[100:103], v[52:55], v[92:95], a[100:103]
  v_mfma_f32_16x16x32_bf16 a[104:107], v[56:59], v[92:95], a[104:107]
  v_mfma_f32_16x16x32_bf16 a[108:111], v[60:63], v[92:95], a[108:111]
  v_mfma_f32_16x16x32_bf16 a[112:115], v[64:67], v[92:95], a[112:115]
  v_mfma_f32_16x16x32_bf16 a[116:119], v[68:71], v[92:95], a[116:119]
  s_waitcnt vmcnt(11)
  v_mfma_f32_16x16x32_bf16 a[0:3], v[96:99], v[116:119], a[0:3]
  buffer_load_dwordx4 v[52:55], v1, s[8:11], s24 offen offset:1024
  v_mfma_f32_16x16x32_bf16 a[4:7], v[100:103], v[116:119], a[4:7]
  v_mfma_f32_16x16x32_bf16 a[8:11], v[104:107], v[116:119], a[8:11]
  buffer_load_dwordx4 v[56:59], v1, s[8:11], s25 offen offset:1024
  v_mfma_f32_16x16x32_bf16 a[12:15], v[108:111], v[116:119], a[12:15]
  v_mfma_f32_16x16x32_bf16 a[16:19], v[112:115], v[116:119], a[16:19]
  buffer_load_dwordx4 v[60:63], v1, s[8:11], s26 offen offset:1024
  v_mfma_f32_16x16x32_bf16 a[20:23], v[96:99], v[120:123], a[20:23]
  v_mfma_f32_16x16x32_bf16 a[24:27], v[100:103], v[120:123], a[24:27]
  buffer_load_dwordx4 v[64:67], v1, s[8:11], s27 offen offset:1024
  v_mfma_f32_16x16x32_bf16 a[28:31], v[104:107], v[120:123], a[28:31]
  v_mfma_f32_16x16x32_bf16 a[32:35], v[108:111], v[120:123], a[32:35]
  buffer_load_dwordx4 v[68:71], v1, s[8:11], s28 offen offset:1024
  v_mfma_f32_16x16x32_bf16 a[36:39], v[112:115], v[120:123], a[36:39]
  v_mfma_f32_16x16x32_bf16 a[40:43], v[96:99], v[124:127], a[40:43]
  buffer_load_dwordx4 v[72:75], v1, s[8:11], s29 offen offset:1024
  v_mfma_f32_16x16x32_bf16 a[44:47], v[100:103], v[124:127], a[44:47]
  v_mfma_f32_16x16x32_bf16 a[48:51], v[104:107], v[124:127], a[48:51]
  buffer_load_dwordx4 v[76:79], v1, s[8:11], s30 offen offset:1024
  v_mfma_f32_16x16x32_bf16 a[52:55], v[108:111], v[124:127], a[52:55]
  v_mfma_f32_16x16x32_bf16 a[56:59], v[112:115], v[124:127], a[56:59]
  buffer_load_dwordx4 v[80:83], v1, s[8:11], s31 offen offset:1024
  v_mfma_f32_16x16x32_bf16 a[60:63], v[96:99], v[128:131], a[60:63]
  v_mfma_f32_16x16x32_bf16 a[64:67], v[100:103], v[128:131], a[64:67]
  buffer_load_dwordx4 v[84:87], v1, s[8:11], s32 offen offset:1024
  v_mfma_f32_16x16x32_bf16 a[68:71], v[104:107], v[128:131], a[68:71]
  v_mfma_f32_16x16x32_bf16 a[72:75], v[108:111], v[128:131], a[72:75]
  buffer_load_dwordx4 v[88:91], v1, s[8:11], s33 offen offset:1024
  v_mfma_f32_16x16x32_bf16 a[76:79], v[112:115], v[128:131], a[76:79]
  v_mfma_f32_16x16x32_bf16 a[80:83], v[96:99], v[132:135], a[80:83]
  buffer_load_dwordx4 v[92:95], v1, s[8:11], s34 offen offset:1024
  v_mfma_f32_16x16x32_bf16 a[84:87], v[100:103], v[132:135], a[84:87]
  v_mfma_f32_16x16x32_bf16 a[88:91], v[104:107], v[132:135], a[88:91]
  v_mfma_f32_16x16x32_bf16 a[92:95], v[108:111], v[132:135], a[92:95]
  v_mfma_f32_16x16x32_bf16 a[96:99], v[112:115], v[132:135], a[96:99]
  v_mfma_f32_16x16x32_bf16 a[100:103], v[96:99], v[136:139], a[100:103]
  v_mfma_f32_16x16x32_bf16 a[104:107], v[100:103], v[136:139], a[104:107]
  v_mfma_f32_16x16x32_bf16 a[108:111], v[104:107], v[136:139], a[108:111]
  v_mfma_f32_16x16x32_bf16 a[112:115], v[108:111], v[136:139], a[112:115]
  v_mfma_f32_16x16x32_bf16 a[116:119], v[112:115], v[136:139], a[116:119]
  s_waitcnt vmcnt(11)
  v_mfma_f32_16x16x32_bf16 a[0:3], v[8:11], v[28:31], a[0:3]
  buffer_load_dwordx4 v[96:99], v1, s[8:11], s24 offen offset:2048
  v_mfma_f32_16x16x32_bf16 a[4:7], v[12:15], v[28:31], a[4:7]
  v_mfma_f32_16x16x32_bf16 a[8:11], v[16:19], v[28:31], a[8:11]
  buffer_load_dwordx4 v[100:103], v1, s[8:11], s25 offen offset:2048
  v_mfma_f32_16x16x32_bf16 a[12:15], v[20:23], v[28:31], a[12:15]
  v_mfma_f32_16x16x32_bf16 a[16:19], v[24:27], v[28:31], a[16:19]
  buffer_load_dwordx4 v[104:107], v1, s[8:11], s26 offen offset:2048
  v_mfma_f32_16x16x32_bf16 a[20:23], v[8:11], v[32:35], a[20:23]
  v_mfma_f32_16x16x32_bf16 a[24:27], v[12:15], v[32:35], a[24:27]
  buffer_load_dwordx4 v[108:111], v1, s[8:11], s27 offen offset:2048
  v_mfma_f32_16x16x32_bf16 a[28:31], v[16:19], v[32:35], a[28:31]
  v_mfma_f32_16x16x32_bf16 a[32:35], v[20:23], v[32:35], a[32:35]
  buffer_load_dwordx4 v[112:115], v1, s[8:11], s28 offen offset:2048
  v_mfma_f32_16x16x32_bf16 a[36:39], v[24:27], v[32:35], a[36:39]
  v_mfma_f32_16x16x32_bf16 a[40:43], v[8:11], v[36:39], a[40:43]
  buffer_load_dwordx4 v[116:119], v1, s[8:11], s29 offen offset:2048
  v_mfma_f32_16x16x32_bf16 a[44:47], v[12:15], v[36:39], a[44:47]
  v_mfma_f32_16x16x32_bf16 a[48:51], v[16:19], v[36:39], a[48:51]
  buffer_load_dwordx4 v[120:123], v1, s[8:11], s30 offen offset:2048
  v_mfma_f32_16x16x32_bf16 a[52:55], v[20:23], v[36:39], a[52:55]
  v_mfma_f32_16x16x32_bf16 a[56:59], v[24:27], v[36:39], a[56:59]
  buffer_load_dwordx4 v[124:127], v1, s[8:11], s31 offen offset:2048
  v_mfma_f32_16x16x32_bf16 a[60:63], v[8:11], v[40:43], a[60:63]
  v_mfma_f32_16x16x32_bf16 a[64:67], v[12:15], v[40:43], a[64:67]
  buffer_load_dwordx4 v[128:131], v1, s[8:11], s32 offen offset:2048
  v_mfma_f32_16x16x32_bf16 a[68:71], v[16:19], v[40:43], a[68:71]
  v_mfma_f32_16x16x32_bf16 a[72:75], v[20:23], v[40:43], a[72:75]
  buffer_load_dwordx4 v[132:135], v1, s[8:11], s33 offen offset:2048
  v_mfma_f32_16x16x32_bf16 a[76:79], v[24:27], v[40:43], a[76:79]
  v_mfma_f32_16x16x32_bf16 a[80:83], v[8:11], v[44:47], a[80:83]
  buffer_load_dwordx4 v[136:139], v1, s[8:11], s34 offen offset:2048
  v_mfma_f32_16x16x32_bf16 a[84:87], v[12:15], v[44:47], a[84:87]
  v_mfma_f32_16x16x32_bf16 a[88:91], v[16:19], v[44:47], a[88:91]
  v_mfma_f32_16x16x32_bf16 a[92:95], v[20:23], v[44:47], a[92:95]
  v_mfma_f32_16x16x32_bf16 a[96:99], v[24:27], v[44:47], a[96:99]
  v_mfma_f32_16x16x32_bf16 a[100:103], v[8:11], v[48:51], a[100:103]
  v_mfma_f32_16x16x32_bf16 a[104:107], v[12:15], v[48:51], a[104:107]
  v_mfma_f32_16x16x32_bf16 a[108:111], v[16:19], v[48:51], a[108:111]
  v_mfma_f32_16x16x32_bf16 a[112:115], v[20:23], v[48:51], a[112:115]
  v_mfma_f32_16x16x32_bf16 a[116:119], v[24:27], v[48:51], a[116:119]
  s_waitcnt vmcnt(11)
  v_mfma_f32_16x16x32_bf16 a[0:3], v[52:55], v[72:75], a[0:3]
  buffer_load_dwordx4 v[8:11], v1, s[8:11], s24 offen offset:3072
  v_mfma_f32_16x16x32_bf16 a[4:7], v[56:59], v[72:75], a[4:7]
  v_mfma_f32_16x16x32_bf16 a[8:11], v[60:63], v[72:75], a[8:11]
  buffer_load_dwordx4 v[12:15], v1, s[8:11], s25 offen offset:3072
  v_mfma_f32_16x16x32_bf16 a[12:15], v[64:67], v[72:75], a[12:15]
  v_mfma_f32_16x16x32_bf16 a[16:19], v[68:71], v[72:75], a[16:19]
  buffer_load_dwordx4 v[16:19], v1, s[8:11], s26 offen offset:3072
  v_mfma_f32_16x16x32_bf16 a[20:23], v[52:55], v[76:79], a[20:23]
  v_mfma_f32_16x16x32_bf16 a[24:27], v[56:59], v[76:79], a[24:27]
  buffer_load_dwordx4 v[20:23], v1, s[8:11], s27 offen offset:3072
  v_mfma_f32_16x16x32_bf16 a[28:31], v[60:63], v[76:79], a[28:31]
  v_mfma_f32_16x16x32_bf16 a[32:35], v[64:67], v[76:79], a[32:35]
  buffer_load_dwordx4 v[24:27], v1, s[8:11], s28 offen offset:3072
  v_mfma_f32_16x16x32_bf16 a[36:39], v[68:71], v[76:79], a[36:39]
  v_mfma_f32_16x16x32_bf16 a[40:43], v[52:55], v[80:83], a[40:43]
  buffer_load_dwordx4 v[28:31], v1, s[8:11], s29 offen offset:3072
  v_mfma_f32_16x16x32_bf16 a[44:47], v[56:59], v[80:83], a[44:47]
  v_mfma_f32_16x16x32_bf16 a[48:51], v[60:63], v[80:83], a[48:51]
  buffer_load_dwordx4 v[32:35], v1, s[8:11], s30 offen offset:3072
  v_mfma_f32_16x16x32_bf16 a[52:55], v[64:67], v[80:83], a[52:55]
  v_mfma_f32_16x16x32_bf16 a[56:59], v[68:71], v[80:83], a[56:59]
  buffer_load_dwordx4 v[36:39], v1, s[8:11], s31 offen offset:3072
  v_mfma_f32_16x16x32_bf16 a[60:63], v[52:55], v[84:87], a[60:63]
  v_mfma_f32_16x16x32_bf16 a[64:67], v[56:59], v[84:87], a[64:67]
  buffer_load_dwordx4 v[40:43], v1, s[8:11], s32 offen offset:3072
  v_mfma_f32_16x16x32_bf16 a[68:71], v[60:63], v[84:87], a[68:71]
  v_mfma_f32_16x16x32_bf16 a[72:75], v[64:67], v[84:87], a[72:75]
  buffer_load_dwordx4 v[44:47], v1, s[8:11], s33 offen offset:3072
  v_mfma_f32_16x16x32_bf16 a[76:79], v[68:71], v[84:87], a[76:79]
  v_mfma_f32_16x16x32_bf16 a[80:83], v[52:55], v[88:91], a[80:83]
  buffer_load_dwordx4 v[48:51], v1, s[8:11], s34 offen offset:3072
  v_mfma_f32_16x16x32_bf16 a[84:87], v[56:59], v[88:91], a[84:87]
  v_mfma_f32_16x16x32_bf16 a[88:91], v[60:63], v[88:91], a[88:91]
  v_mfma_f32_16x16x32_bf16 a[92:95], v[64:67], v[88:91], a[92:95]
  v_mfma_f32_16x16x32_bf16 a[96:99], v[68:71], v[88:91], a[96:99]
  v_mfma_f32_16x16x32_bf16 a[100:103], v[52:55], v[92:95], a[100:103]
  v_mfma_f32_16x16x32_bf16 a[104:107], v[56:59], v[92:95], a[104:107]
  v_mfma_f32_16x16x32_bf16 a[108:111], v[60:63], v[92:95], a[108:111]
  v_mfma_f32_16x16x32_bf16 a[112:115], v[64:67], v[92:95], a[112:115]
  v_mfma_f32_16x16x32_bf16 a[116:119], v[68:71], v[92:95], a[116:119]
  s_waitcnt vmcnt(11)
  v_mfma_f32_16x16x32_bf16 a[0:3], v[96:99], v[116:119], a[0:3]
  s_add_u32 s24, s24, 4096
  s_add_u32 s25, s25, 4096
  s_add_u32 s26, s26, 4096
  s_add_u32 s27, s27, 4096
  s_add_u32 s28, s28, 4096
  s_add_u32 s29, s29, 4096
  s_add_u32 s30, s30, 4096
  s_add_u32 s31, s31, 4096
  s_add_u32 s32, s32, 4096
  s_add_u32 s33, s33, 4096
  s_add_u32 s34, s34, 4096
  buffer_load_dwordx4 v[52:55], v1, s[8:11], s24 offen offset:0
  v_mfma_f32_16x16x32_bf16 a[4:7], v[100:103], v[116:119], a[4:7]
  v_mfma_f32_16x16x32_bf16 a[8:11], v[104:107], v[116:119], a[8:11]
  buffer_load_dwordx4 v[56:59], v1, s[8:11], s25 offen offset:0
  v_mfma_f32_16x16x32_bf16 a[12:15], v[108:111], v[116:119], a[12:15]
  v_mfma_f32_16x16x32_bf16 a[16:19], v[112:115], v[116:119], a[16:19]
  buffer_load_dwordx4 v[60:63], v1, s[8:11], s26 offen offset:0
  v_mfma_f32_16x16x32_bf16 a[20:23], v[96:99], v[120:123], a[20:23]
  v_mfma_f32_16x16x32_bf16 a[24:27], v[100:103], v[120:123], a[24:27]
  buffer_load_dwordx4 v[64:67], v1, s[8:11], s27 offen offset:0
  v_mfma_f32_16x16x32_bf16 a[28:31], v[104:107], v[120:123], a[28:31]
  v_mfma_f32_16x16x32_bf16 a[32:35], v[108:111], v[120:123], a[32:35]
  buffer_load_dwordx4 v[68:71], v1, s[8:11], s28 offen offset:0
  v_mfma_f32_16x16x32_bf16 a[36:39], v[112:115], v[120:123], a[36:39]
  v_mfma_f32_16x16x32_bf16 a[40:43], v[96:99], v[124:127], a[40:43]
  buffer_load_dwordx4 v[72:75], v1, s[8:11], s29 offen offset:0
  v_mfma_f32_16x16x32_bf16 a[44:47], v[100:103], v[124:127], a[44:47]
  v_mfma_f32_16x16x32_bf16 a[48:51], v[104:107], v[124:127], a[48:51]
  buffer_load_dwordx4 v[76:79], v1, s[8:11], s30 offen offset:0
  v_mfma_f32_16x16x32_bf16 a[52:55], v[108:111], v[124:127], a[52:55]
  v_mfma_f32_16x16x32_bf16 a[56:59], v[112:115], v[124:127], a[56:59]
  buffer_load_dwordx4 v[80:83], v1, s[8:11], s31 offen offset:0
  v_mfma_f32_16x16x32_bf16 a[60:63], v[96:99], v[128:131], a[60:63]
  v_mfma_f32_16x16x32_bf16 a[64:67], v[100:103], v[128:131], a[64:67]
  buffer_load_dwordx4 v[84:87], v1, s[8:11], s32 offen offset:0
  v_mfma_f32_16x16x32_bf16 a[68:71], v[104:107], v[128:131], a[68:71]
  v_mfma_f32_16x16x32_bf16 a[72:75], v[108:111], v[128:131], a[72:75]
  buffer_load_dwordx4 v[88:91], v1, s[8:11], s33 offen offset:0
  v_mfma_f32_16x16x32_bf16 a[76:79], v[112:115], v[128:131], a[76:79]
  v_mfma_f32_16x16x32_bf16 a[80:83], v[96:99], v[132:135], a[80:83]
  buffer_load_dwordx4 v[92:95], v1, s[8:11], s34 offen offset:0
  v_mfma_f32_16x16x32_bf16 a[84:87], v[100:103], v[132:135], a[84:87]
  v_mfma_f32_16x16x32_bf16 a[88:91], v[104:107], v[132:135], a[88:91]
  v_mfma_f32_16x16x32_bf16 a[92:95], v[108:111], v[132:135], a[92:95]
  v_mfma_f32_16x16x32_bf16 a[96:99], v[112:115], v[132:135], a[96:99]
  v_mfma_f32_16x16x32_bf16 a[100:103], v[96:99], v[136:139], a[100:103]
  v_mfma_f32_16x16x32_bf16 a[104:107], v[100:103], v[136:139], a[104:107]
  v_mfma_f32_16x16x32_bf16 a[108:111], v[104:107], v[136:139], a[108:111]
  v_mfma_f32_16x16x32_bf16 a[112:115], v[108:111], v[136:139], a[112:115]
  v_mfma_f32_16x16x32_bf16 a[116:119], v[112:115], v[136:139], a[116:119]
  s_waitcnt vmcnt(11)
  v_mfma_f32_16x16x32_bf16 a[0:3], v[8:11], v[28:31], a[0:3]
  buffer_load_dwordx4 v[96:99], v1, s[8:11], s24 offen offset:1024
  v_mfma_f32_16x16x32_bf16 a[4:7], v[12:15], v[28:31], a[4:7]
  v_mfma_f32_16x16x32_bf16 a[8:11], v[16:19], v[28:31], a[8:11]
  buffer_load_dwordx4 v[100:103], v1, s[8:11], s25 offen offset:1024
  v_mfma_f32_16x16x32_bf16 a[12:15], v[20:23], v[28:31], a[12:15]
  v_mfma_f32_16x16x32_bf16 a[16:19], v[24:27], v[28:31], a[16:19]
  buffer_load_dwordx4 v[104:107], v1, s[8:11], s26 offen offset:1024
  v_mfma_f32_16x16x32_bf16 a[20:23], v[8:11], v[32:35], a[20:23]
  v_mfma_f32_16x16x32_bf16 a[24:27], v[12:15], v[32:35], a[24:27]
  buffer_load_dwordx4 v[108:111], v1, s[8:11], s27 offen offset:1024
  v_mfma_f32_16x16x32_bf16 a[28:31], v[16:19], v[32:35], a[28:31]
  v_mfma_f32_16x16x32_bf16 a[32:35], v[20:23], v[32:35], a[32:35]
  buffer_load_dwordx4 v[112:115], v1, s[8:11], s28 offen offset:1024
  v_mfma_f32_16x16x32_bf16 a[36:39], v[24:27], v[32:35], a[36:39]
  v_mfma_f32_16x16x32_bf16 a[40:43], v[8:11], v[36:39], a[40:43]
  buffer_load_dwordx4 v[116:119], v1, s[8:11], s29 offen offset:1024
  v_mfma_f32_16x16x32_bf16 a[44:47], v[12:15], v[36:39], a[44:47]
  v_mfma_f32_16x16x32_bf16 a[48:51], v[16:19], v[36:39], a[48:51]
  buffer_load_dwordx4 v[120:123], v1, s[8:11], s30 offen offset:1024
  v_mfma_f32_16x16x32_bf16 a[52:55], v[20:23], v[36:39], a[52:55]
  v_mfma_f32_16x16x32_bf16 a[56:59], v[24:27], v[36:39], a[56:59]
  buffer_load_dwordx4 v[124:127], v1, s[8:11], s31 offen offset:1024
  v_mfma_f32_16x16x32_bf16 a[60:63], v[8:11], v[40:43], a[60:63]
  v_mfma_f32_16x16x32_bf16 a[64:67], v[12:15], v[40:43], a[64:67]
  buffer_load_dwordx4 v[128:131], v1, s[8:11], s32 offen offset:1024
  v_mfma_f32_16x16x32_bf16 a[68:71], v[16:19], v[40:43], a[68:71]
  v_mfma_f32_16x16x32_bf16 a[72:75], v[20:23], v[40:43], a[72:75]
  buffer_load_dwordx4 v[132:135], v1, s[8:11], s33 offen offset:1024
  v_mfma_f32_16x16x32_bf16 a[76:79], v[24:27], v[40:43], a[76:79]
  v_mfma_f32_16x16x32_bf16 a[80:83], v[8:11], v[44:47], a[80:83]
  buffer_load_dwordx4 v[136:139], v1, s[8:11], s34 offen offset:1024
  v_mfma_f32_16x16x32_bf16 a[84:87], v[12:15], v[44:47], a[84:87]
  v_mfma_f32_16x16x32_bf16 a[88:91], v[16:19], v[44:47], a[88:91]
  v_mfma_f32_16x16x32_bf16 a[92:95], v[20:23], v[44:47], a[92:95]
  v_mfma_f32_16x16x32_bf16 a[96:99], v[24:27], v[44:47], a[96:99]
  v_mfma_f32_16x16x32_bf16 a[100:103], v[8:11], v[48:51], a[100:103]
  v_mfma_f32_16x16x32_bf16 a[104:107], v[12:15], v[48:51], a[104:107]
  v_mfma_f32_16x16x32_bf16 a[108:111], v[16:19], v[48:51], a[108:111]
  v_mfma_f32_16x16x32_bf16 a[112:115], v[20:23], v[48:51], a[112:115]
  v_mfma_f32_16x16x32_bf16 a[116:119], v[24:27], v[48:51], a[116:119]
  s_waitcnt vmcnt(11)
  v_mfma_f32_16x16x32_bf16 a[0:3], v[52:55], v[72:75], a[0:3]
  buffer_load_dwordx4 v[8:11], v1, s[8:11], s24 offen offset:2048
  v_mfma_f32_16x16x32_bf16 a[4:7], v[56:59], v[72:75], a[4:7]
  v_mfma_f32_16x16x32_bf16 a[8:11], v[60:63], v[72:75], a[8:11]
  buffer_load_dwordx4 v[12:15], v1, s[8:11], s25 offen offset:2048
  v_mfma_f32_16x16x32_bf16 a[12:15], v[64:67], v[72:75], a[12:15]
  v_mfma_f32_16x16x32_bf16 a[16:19], v[68:71], v[72:75], a[16:19]
  buffer_load_dwordx4 v[16:19], v1, s[8:11], s26 offen offset:2048
  v_mfma_f32_16x16x32_bf16 a[20:23], v[52:55], v[76:79], a[20:23]
  v_mfma_f32_16x16x32_bf16 a[24:27], v[56:59], v[76:79], a[24:27]
  buffer_load_dwordx4 v[20:23], v1, s[8:11], s27 offen offset:2048
  v_mfma_f32_16x16x32_bf16 a[28:31], v[60:63], v[76:79], a[28:31]
  v_mfma_f32_16x16x32_bf16 a[32:35], v[64:67], v[76:79], a[32:35]
  buffer_load_dwordx4 v[24:27], v1, s[8:11], s28 offen offset:2048
  v_mfma_f32_16x16x32_bf16 a[36:39], v[68:71], v[76:79], a[36:39]
  v_mfma_f32_16x16x32_bf16 a[40:43], v[52:55], v[80:83], a[40:43]
  buffer_load_dwordx4 v[28:31], v1, s[8:11], s29 offen offset:2048
  v_mfma_f32_16x16x32_bf16 a[44:47], v[56:59], v[80:83], a[44:47]
  v_mfma_f32_16x16x32_bf16 a[48:51], v[60:63], v[80:83], a[48:51]
  buffer_load_dwordx4 v[32:35], v1, s[8:11], s30 offen offset:2048
  v_mfma_f32_16x16x32_bf16 a[52:55], v[64:67], v[80:83], a[52:55]
  v_mfma_f32_16x16x32_bf16 a[56:59], v[68:71], v[80:83], a[56:59]
  buffer_load_dwordx4 v[36:39], v1, s[8:11], s31 offen offset:2048
  v_mfma_f32_16x16x32_bf16 a[60:63], v[52:55], v[84:87], a[60:63]
  v_mfma_f32_16x16x32_bf16 a[64:67], v[56:59], v[84:87], a[64:67]
  buffer_load_dwordx4 v[40:43], v1, s[8:11], s32 offen offset:2048
  v_mfma_f32_16x16x32_bf16 a[68:71], v[60:63], v[84:87], a[68:71]
  v_mfma_f32_16x16x32_bf16 a[72:75], v[64:67], v[84:87], a[72:75]
  buffer_load_dwordx4 v[44:47], v1, s[8:11], s33 offen offset:2048
  v_mfma_f32_16x16x32_bf16 a[76:79], v[68:71], v[84:87], a[76:79]
  v_mfma_f32_16x16x32_bf16 a[80:83], v[52:55], v[88:91], a[80:83]
  buffer_load_dwordx4 v[48:51], v1, s[8:11], s34 offen offset:2048
  v_mfma_f32_16x16x32_bf16 a[84:87], v[56:59], v[88:91], a[84:87]
  v_mfma_f32_16x16x32_bf16 a[88:91], v[60:63], v[88:91], a[88:91]
  v_mfma_f32_16x16x32_bf16 a[92:95], v[64:67], v[88:91], a[92:95]
  v_mfma_f32_16x16x32_bf16 a[96:99], v[68:71], v[88:91], a[96:99]
  v_mfma_f32_16x16x32_bf16 a[100:103], v[52:55], v[92:95], a[100:103]
  v_mfma_f32_16x16x32_bf16 a[104:107], v[56:59], v[92:95], a[104:107]
  v_mfma_f32_16x16x32_bf16 a[108:111], v[60:63], v[92:95], a[108:111]
  v_mfma_f32_16x16x32_bf16 a[112:115], v[64:67], v[92:95], a[112:115]
  v_mfma_f32_16x16x32_bf16 a[116:119], v[68:71], v[92:95], a[116:119]
  s_waitcnt vmcnt(11)
  v_mfma_f32_16x16x32_bf16 a[0:3], v[96:99], v[116:119], a[0:3]
  buffer_load_dwordx4 v[52:55], v1, s[8:11], s24 offen offset:3072
  v_mfma_f32_16x16x32_bf16 a[4:7], v[100:103], v[116:119], a[4:7]
  v_mfma_f32_16x16x32_bf16 a[8:11], v[104:107], v[116:119], a[8:11]
  buffer_load_dwordx4 v[56:59], v1, s[8:11], s25 offen offset:3072
  v_mfma_f32_16x16x32_bf16 a[12:15], v[108:111], v[116:119], a[12:15]
  v_mfma_f32_16x16x32_bf16 a[16:19], v[112:115], v[116:119], a[16:19]
  buffer_load_dwordx4 v[60:63], v1, s[8:11], s26 offen offset:3072
  v_mfma_f32_16x16x32_bf16 a[20:23], v[96:99], v[120:123], a[20:23]
  v_mfma_f32_16x16x32_bf16 a[24:27], v[100:103], v[120:123], a[24:27]
  buffer_load_dwordx4 v[64:67], v1, s[8:11], s27 offen offset:3072
  v_mfma_f32_16x16x32_bf16 a[28:31], v[104:107], v[120:123], a[28:31]
  v_mfma_f32_16x16x32_bf16 a[32:35], v[108:111], v[120:123], a[32:35]
  buffer_load_dwordx4 v[68:71], v1, s[8:11], s28 offen offset:3072
  v_mfma_f32_16x16x32_bf16 a[36:39], v[112:115], v[120:123], a[36:39]
  v_mfma_f32_16x16x32_bf16 a[40:43], v[96:99], v[124:127], a[40:43]
  buffer_load_dwordx4 v[72:75], v1, s[8:11], s29 offen offset:3072
  v_mfma_f32_16x16x32_bf16 a[44:47], v[100:103], v[124:127], a[44:47]
  v_mfma_f32_16x16x32_bf16 a[48:51], v[104:107], v[124:127], a[48:51]
  buffer_load_dwordx4 v[76:79], v1, s[8:11], s30 offen offset:3072
  v_mfma_f32_16x16x32_bf16 a[52:55], v[108:111], v[124:127], a[52:55]
  v_mfma_f32_16x16x32_bf16 a[56:59], v[112:115], v[124:127], a[56:59]
  buffer_load_dwordx4 v[80:83], v1, s[8:11], s31 offen offset:3072
  v_mfma_f32_16x16x32_bf16 a[60:63], v[96:99], v[128:131], a[60:63]
  v_mfma_f32_16x16x32_bf16 a[64:67], v[100:103], v[128:131], a[64:67]
  buffer_load_dwordx4 v[84:87], v1, s[8:11], s32 offen offset:3072
  v_mfma_f32_16x16x32_bf16 a[68:71], v[104:107], v[128:131], a[68:71]
  v_mfma_f32_16x16x32_bf16 a[72:75], v[108:111], v[128:131], a[72:75]
  buffer_load_dwordx4 v[88:91], v1, s[8:11], s33 offen offset:3072
  v_mfma_f32_16x16x32_bf16 a[76:79], v[112:115], v[128:131], a[76:79]
  v_mfma_f32_16x16x32_bf16 a[80:83], v[96:99], v[132:135], a[80:83]
  buffer_load_dwordx4 v[92:95], v1, s[8:11], s34 offen offset:3072
  v_mfma_f32_16x16x32_bf16 a[84:87], v[100:103], v[132:135], a[84:87]
  v_mfma_f32_16x16x32_bf16 a[88:91], v[104:107], v[132:135], a[88:91]
  v_mfma_f32_16x16x32_bf16 a[92:95], v[108:111], v[132:135], a[92:95]
  v_mfma_f32_16x16x32_bf16 a[96:99], v[112:115], v[132:135], a[96:99]
  v_mfma_f32_16x16x32_bf16 a[100:103], v[96:99], v[136:139], a[100:103]
  v_mfma_f32_16x16x32_bf16 a[104:107], v[100:103], v[136:139], a[104:107]
  v_mfma_f32_16x16x32_bf16 a[108:111], v[104:107], v[136:139], a[108:111]
  v_mfma_f32_16x16x32_bf16 a[112:115], v[108:111], v[136:139], a[112:115]
  v_mfma_f32_16x16x32_bf16 a[116:119], v[112:115], v[136:139], a[116:119]
  s_waitcnt vmcnt(11)
  v_mfma_f32_16x16x32_bf16 a[0:3], v[8:11], v[28:31], a[0:3]
  s_add_u32 s24, s24, 4096
  s_add_u32 s25, s25, 4096
  s_add_u32 s26, s26, 4096
  s_add_u32 s27, s27, 4096
  s_add_u32 s28, s28, 4096
  s_add_u32 s29, s29, 4096
  s_add_u32 s30, s30, 4096
  s_add_u32 s31, s31, 4096
  s_add_u32 s32, s32, 4096
  s_add_u32 s33, s33, 4096
  s_add_u32 s34, s34, 4096
  buffer_load_dwordx4 v[96:99], v1, s[8:11], s24 offen offset:0
  v_mfma_f32_16x16x32_bf16 a[4:7], v[12:15], v[28:31], a[4:7]
  v_mfma_f32_16x16x32_bf16 a[8:11], v[16:19], v[28:31], a[8:11]
  buffer_load_dwordx4 v[100:103], v1, s[8:11], s25 offen offset:0
  v_mfma_f32_16x16x32_bf16 a[12:15], v[20:23], v[28:31], a[12:15]
  v_mfma_f32_16x16x32_bf16 a[16:19], v[24:27], v[28:31], a[16:19]
  buffer_load_dwordx4 v[104:107], v1, s[8:11], s26 offen offset:0
  v_mfma_f32_16x16x32_bf16 a[20:23], v[8:11], v[32:35], a[20:23]
  v_mfma_f32_16x16x32_bf16 a[24:27], v[12:15], v[32:35], a[24:27]
  buffer_load_dwordx4 v[108:111], v1, s[8:11], s27 offen offset:0
  v_mfma_f32_16x16x32_bf16 a[28:31], v[16:19], v[32:35], a[28:31]
  v_mfma_f32_16x16x32_bf16 a[32:35], v[20:23], v[32:35], a[32:35]
  buffer_load_dwordx4 v[112:115], v1, s[8:11], s28 offen offset:0
  v_mfma_f32_16x16x32_bf16 a[36:39], v[24:27], v[32:35], a[36:39]
  v_mfma_f32_16x16x32_bf16 a[40:43], v[8:11], v[36:39], a[40:43]
  buffer_load_dwordx4 v[116:119], v1, s[8:11], s29 offen offset:0
  v_mfma_f32_16x16x32_bf16 a[44:47], v[12:15], v[36:39], a[44:47]
  v_mfma_f32_16x16x32_bf16 a[48:51], v[16:19], v[36:39], a[48:51]
  buffer_load_dwordx4 v[120:123], v1, s[8:11], s30 offen offset:0
  v_mfma_f32_16x16x32_bf16 a[52:55], v[20:23], v[36:39], a[52:55]
  v_mfma_f32_16x16x32_bf16 a[56:59], v[24:27], v[36:39], a[56:59]
  buffer_load_dwordx4 v[124:127], v1, s[8:11], s31 offen offset:0
  v_mfma_f32_16x16x32_bf16 a[60:63], v[8:11], v[40:43], a[60:63]
  v_mfma_f32_16x16x32_bf16 a[64:67], v[12:15], v[40:43], a[64:67]
  buffer_load_dwordx4 v[128:131], v1, s[8:11], s32 offen offset:0
  v_mfma_f32_16x16x32_bf16 a[68:71], v[16:19], v[40:43], a[68:71]
  v_mfma_f32_16x16x32_bf16 a[72:75], v[20:23], v[40:43], a[72:75]
  buffer_load_dwordx4 v[132:135], v1, s[8:11], s33 offen offset:0
  v_mfma_f32_16x16x32_bf16 a[76:79], v[24:27], v[40:43], a[76:79]
  v_mfma_f32_16x16x32_bf16 a[80:83], v[8:11], v[44:47], a[80:83]
  buffer_load_dwordx4 v[136:139], v1, s[8:11], s34 offen offset:0
  v_mfma_f32_16x16x32_bf16 a[84:87], v[12:15], v[44:47], a[84:87]
  v_mfma_f32_16x16x32_bf16 a[88:91], v[16:19], v[44:47], a[88:91]
  v_mfma_f32_16x16x32_bf16 a[92:95], v[20:23], v[44:47], a[92:95]
  v_mfma_f32_16x16x32_bf16 a[96:99], v[24:27], v[44:47], a[96:99]
  v_mfma_f32_16x16x32_bf16 a[100:103], v[8:11], v[48:51], a[100:103]
  v_mfma_f32_16x16x32_bf16 a[104:107], v[12:15], v[48:51], a[104:107]
  v_mfma_f32_16x16x32_bf16 a[108:111], v[16:19], v[48:51], a[108:111]
  v_mfma_f32_16x16x32_bf16 a[112:115], v[20:23], v[48:51], a[112:115]
  v_mfma_f32_16x16x32_bf16 a[116:119], v[24:27], v[48:51], a[116:119]
  s_waitcnt vmcnt(11)
  v_mfma_f32_16x16x32_bf16 a[0:3], v[52:55], v[72:75], a[0:3]
  buffer_load_dwordx4 v[8:11], v1, s[8:11], s24 offen offset:1024
  v_mfma_f32_16x16x32_bf16 a[4:7], v[56:59], v[72:75], a[4:7]
  v_mfma_f32_16x16x32_bf16 a[8:11], v[60:63], v[72:75], a[8:11]
  buffer_load_dwordx4 v[12:15], v1, s[8:11], s25 offen offset:1024
  v_mfma_f32_16x16x32_bf16 a[12:15], v[64:67], v[72:75], a[12:15]
  v_mfma_f32_16x16x32_bf16 a[16:19], v[68:71], v[72:75], a[16:19]
  buffer_load_dwordx4 v[16:19], v1, s[8:11], s26 offen offset:1024
  v_mfma_f32_16x16x32_bf16 a[20:23], v[52:55], v[76:79], a[20:23]
  v_mfma_f32_16x16x32_bf16 a[24:27], v[56:59], v[76:79], a[24:27]
  buffer_load_dwordx4 v[20:23], v1, s[8:11], s27 offen offset:1024
  v_mfma_f32_16x16x32_bf16 a[28:31], v[60:63], v[76:79], a[28:31]
  v_mfma_f32_16x16x32_bf16 a[32:35], v[64:67], v[76:79], a[32:35]
  buffer_load_dwordx4 v[24:27], v1, s[8:11], s28 offen offset:1024
  v_mfma_f32_16x16x32_bf16 a[36:39], v[68:71], v[76:79], a[36:39]
  v_mfma_f32_16x16x32_bf16 a[40:43], v[52:55], v[80:83], a[40:43]
  buffer_load_dwordx4 v[28:31], v1, s[8:11], s29 offen offset:1024
  v_mfma_f32_16x16x32_bf16 a[44:47], v[56:59], v[80:83], a[44:47]
  v_mfma_f32_16x16x32_bf16 a[48:51], v[60:63], v[80:83], a[48:51]
  buffer_load_dwordx4 v[32:35], v1, s[8:11], s30 offen offset:1024
  v_mfma_f32_16x16x32_bf16 a[52:55], v[64:67], v[80:83], a[52:55]
  v_mfma_f32_16x16x32_bf16 a[56:59], v[68:71], v[80:83], a[56:59]
  buffer_load_dwordx4 v[36:39], v1, s[8:11], s31 offen offset:1024
  v_mfma_f32_16x16x32_bf16 a[60:63], v[52:55], v[84:87], a[60:63]
  v_mfma_f32_16x16x32_bf16 a[64:67], v[56:59], v[84:87], a[64:67]
  buffer_load_dwordx4 v[40:43], v1, s[8:11], s32 offen offset:1024
  v_mfma_f32_16x16x32_bf16 a[68:71], v[60:63], v[84:87], a[68:71]
  v_mfma_f32_16x16x32_bf16 a[72:75], v[64:67], v[84:87], a[72:75]
  buffer_load_dwordx4 v[44:47], v1, s[8:11], s33 offen offset:1024
  v_mfma_f32_16x16x32_bf16 a[76:79], v[68:71], v[84:87], a[76:79]
  v_mfma_f32_16x16x32_bf16 a[80:83], v[52:55], v[88:91], a[80:83]
  buffer_load_dwordx4 v[48:51], v1, s[8:11], s34 offen offset:1024
  v_mfma_f32_16x16x32_bf16 a[84:87], v[56:59], v[88:91], a[84:87]
  v_mfma_f32_16x16x32_bf16 a[88:91], v[60:63], v[88:91], a[88:91]
  v_mfma_f32_16x16x32_bf16 a[92:95], v[64:67], v[88:91], a[92:95]
  v_mfma_f32_16x16x32_bf16 a[96:99], v[68:71], v[88:91], a[96:99]
  v_mfma_f32_16x16x32_bf16 a[100:103], v[52:55], v[92:95], a[100:103]
  v_mfma_f32_16x16x32_bf16 a[104:107], v[56:59], v[92:95], a[104:107]
  v_mfma_f32_16x16x32_bf16 a[108:111], v[60:63], v[92:95], a[108:111]
  v_mfma_f32_16x16x32_bf16 a[112:115], v[64:67], v[92:95], a[112:115]
  v_mfma_f32_16x16x32_bf16 a[116:119], v[68:71], v[92:95], a[116:119]
  s_waitcnt vmcnt(11)
  v_mfma_f32_16x16x32_bf16 a[0:3], v[96:99], v[116:119], a[0:3]
  buffer_load_dwordx4 v[52:55], v1, s[8:11], s24 offen offset:2048
  v_mfma_f32_16x16x32_bf16 a[4:7], v[100:103], v[116:119], a[4:7]
  v_mfma_f32_16x16x32_bf16 a[8:11], v[104:107], v[116:119], a[8:11]
  buffer_load_dwordx4 v[56:59], v1, s[8:11], s25 offen offset:2048
  v_mfma_f32_16x16x32_bf16 a[12:15], v[108:111], v[116:119], a[12:15]
  v_mfma_f32_16x16x32_bf16 a[16:19], v[112:115], v[116:119], a[16:19]
  buffer_load_dwordx4 v[60:63], v1, s[8:11], s26 offen offset:2048
  v_mfma_f32_16x16x32_bf16 a[20:23], v[96:99], v[120:123], a[20:23]
  v_mfma_f32_16x16x32_bf16 a[24:27], v[100:103], v[120:123], a[24:27]
  buffer_load_dwordx4 v[64:67], v1, s[8:11], s27 offen offset:2048
  v_mfma_f32_16x16x32_bf16 a[28:31], v[104:107], v[120:123], a[28:31]
  v_mfma_f32_16x16x32_bf16 a[32:35], v[108:111], v[120:123], a[32:35]
  buffer_load_dwordx4 v[68:71], v1, s[8:11], s28 offen offset:2048
  v_mfma_f32_16x16x32_bf16 a[36:39], v[112:115], v[120:123], a[36:39]
  v_mfma_f32_16x16x32_bf16 a[40:43], v[96:99], v[124:127], a[40:43]
  buffer_load_dwordx4 v[72:75], v1, s[8:11], s29 offen offset:2048
  v_mfma_f32_16x16x32_bf16 a[44:47], v[100:103], v[124:127], a[44:47]
  v_mfma_f32_16x16x32_bf16 a[48:51], v[104:107], v[124:127], a[48:51]
  buffer_load_dwordx4 v[76:79], v1, s[8:11], s30 offen offset:2048
  v_mfma_f32_16x16x32_bf16 a[52:55], v[108:111], v[124:127], a[52:55]
  v_mfma_f32_16x16x32_bf16 a[56:59], v[112:115], v[124:127], a[56:59]
  buffer_load_dwordx4 v[80:83], v1, s[8:11], s31 offen offset:2048
  v_mfma_f32_16x16x32_bf16 a[60:63], v[96:99], v[128:131], a[60:63]
  v_mfma_f32_16x16x32_bf16 a[64:67], v[100:103], v[128:131], a[64:67]
  buffer_load_dwordx4 v[84:87], v1, s[8:11], s32 offen offset:2048
  v_mfma_f32_16x16x32_bf16 a[68:71], v[104:107], v[128:131], a[68:71]
  v_mfma_f32_16x16x32_bf16 a[72:75], v[108:111], v[128:131], a[72:75]
  buffer_load_dwordx4 v[88:91], v1, s[8:11], s33 offen offset:2048
  v_mfma_f32_16x16x32_bf16 a[76:79], v[112:115], v[128:131], a[76:79]
  v_mfma_f32_16x16x32_bf16 a[80:83], v[96:99], v[132:135], a[80:83]
  buffer_load_dwordx4 v[92:95], v1, s[8:11], s34 offen offset:2048
  v_mfma_f32_16x16x32_bf16 a[84:87], v[100:103], v[132:135], a[84:87]
  v_mfma_f32_16x16x32_bf16 a[88:91], v[104:107], v[132:135], a[88:91]
  v_mfma_f32_16x16x32_bf16 a[92:95], v[108:111], v[132:135], a[92:95]
  v_mfma_f32_16x16x32_bf16 a[96:99], v[112:115], v[132:135], a[96:99]
  v_mfma_f32_16x16x32_bf16 a[100:103], v[96:99], v[136:139], a[100:103]
  v_mfma_f32_16x16x32_bf16 a[104:107], v[100:103], v[136:139], a[104:107]
  v_mfma_f32_16x16x32_bf16 a[108:111], v[104:107], v[136:139], a[108:111]
  v_mfma_f32_16x16x32_bf16 a[112:115], v[108:111], v[136:139], a[112:115]
  v_mfma_f32_16x16x32_bf16 a[116:119], v[112:115], v[136:139], a[116:119]
  s_waitcnt vmcnt(11)
  v_mfma_f32_16x16x32_bf16 a[0:3], v[8:11], v[28:31], a[0:3]
  buffer_load_dwordx4 v[96:99], v1, s[8:11], s24 offen offset:3072
  v_mfma_f32_16x16x32_bf16 a[4:7], v[12:15], v[28:31], a[4:7]
  v_mfma_f32_16x16x32_bf16 a[8:11], v[16:19], v[28:31], a[8:11]
  buffer_load_dwordx4 v[100:103], v1, s[8:11], s25 offen offset:3072
  v_mfma_f32_16x16x32_bf16 a[12:15], v[20:23], v[28:31], a[12:15]
  v_mfma_f32_16x16x32_bf16 a[16:19], v[24:27], v[28:31], a[16:19]
  buffer_load_dwordx4 v[104:107], v1, s[8:11], s26 offen offset:3072
  v_mfma_f32_16x16x32_bf16 a[20:23], v[8:11], v[32:35], a[20:23]
  v_mfma_f32_16x16x32_bf16 a[24:27], v[12:15], v[32:35], a[24:27]
  buffer_load_dwordx4 v[108:111], v1, s[8:11], s27 offen offset:3072
  v_mfma_f32_16x16x32_bf16 a[28:31], v[16:19], v[32:35], a[28:31]
  v_mfma_f32_16x16x32_bf16 a[32:35], v[20:23], v[32:35], a[32:35]
  buffer_load_dwordx4 v[112:115], v1, s[8:11], s28 offen offset:3072
  v_mfma_f32_16x16x32_bf16 a[36:39], v[24:27], v[32:35], a[36:39]
  v_mfma_f32_16x16x32_bf16 a[40:43], v[8:11], v[36:39], a[40:43]
  buffer_load_dwordx4 v[116:119], v1, s[8:11], s29 offen offset:3072
  v_mfma_f32_16x16x32_bf16 a[44:47], v[12:15], v[36:39], a[44:47]
  v_mfma_f32_16x16x32_bf16 a[48:51], v[16:19], v[36:39], a[48:51]
  buffer_load_dwordx4 v[120:123], v1, s[8:11], s30 offen offset:3072
  v_mfma_f32_16x16x32_bf16 a[52:55], v[20:23], v[36:39], a[52:55]
  v_mfma_f32_16x16x32_bf16 a[56:59], v[24:27], v[36:39], a[56:59]
  buffer_load_dwordx4 v[124:127], v1, s[8:11], s31 offen offset:3072
  v_mfma_f32_16x16x32_bf16 a[60:63], v[8:11], v[40:43], a[60:63]
  v_mfma_f32_16x16x32_bf16 a[64:67], v[12:15], v[40:43], a[64:67]
  buffer_load_dwordx4 v[128:131], v1, s[8:11], s32 offen offset:3072
  v_mfma_f32_16x16x32_bf16 a[68:71], v[16:19], v[40:43], a[68:71]
  v_mfma_f32_16x16x32_bf16 a[72:75], v[20:23], v[40:43], a[72:75]
  buffer_load_dwordx4 v[132:135], v1, s[8:11], s33 offen offset:3072
  v_mfma_f32_16x16x32_bf16 a[76:79], v[24:27], v[40:43], a[76:79]
  v_mfma_f32_16x16x32_bf16 a[80:83], v[8:11], v[44:47], a[80:83]
  buffer_load_dwordx4 v[136:139], v1, s[8:11], s34 offen offset:3072
  v_mfma_f32_16x16x32_bf16 a[84:87], v[12:15], v[44:47], a[84:87]
  v_mfma_f32_16x16x32_bf16 a[88:91], v[16:19], v[44:47], a[88:91]
  v_mfma_f32_16x16x32_bf16 a[92:95], v[20:23], v[44:47], a[92:95]
  v_mfma_f32_16x16x32_bf16 a[96:99], v[24:27], v[44:47], a[96:99]
  v_mfma_f32_16x16x32_bf16 a[100:103], v[8:11], v[48:51], a[100:103]
  v_mfma_f32_16x16x32_bf16 a[104:107], v[12:15], v[48:51], a[104:107]
  v_mfma_f32_16x16x32_bf16 a[108:111], v[16:19], v[48:51], a[108:111]
  v_mfma_f32_16x16x32_bf16 a[112:115], v[20:23], v[48:51], a[112:115]
  v_mfma_f32_16x16x32_bf16 a[116:119], v[24:27], v[48:51], a[116:119]
  s_waitcnt vmcnt(11)
  v_mfma_f32_16x16x32_bf16 a[0:3], v[52:55], v[72:75], a[0:3]
  s_add_u32 s24, s24, 4096
  s_add_u32 s25, s25, 4096
  s_add_u32 s26, s26, 4096
  s_add_u32 s27, s27, 4096
  s_add_u32 s28, s28, 4096
  s_add_u32 s29, s29, 4096
  s_add_u32 s30, s30, 4096
  s_add_u32 s31, s31, 4096
  s_add_u32 s32, s32, 4096
  s_add_u32 s33, s33, 4096
  s_add_u32 s34, s34, 4096
  buffer_load_dwordx4 v[8:11], v1, s[8:11], s24 offen offset:0
  v_mfma_f32_16x16x32_bf16 a[4:7], v[56:59], v[72:75], a[4:7]
  v_mfma_f32_16x16x32_bf16 a[8:11], v[60:63], v[72:75], a[8:11]
  buffer_load_dwordx4 v[12:15], v1, s[8:11], s25 offen offset:0
  v_mfma_f32_16x16x32_bf16 a[12:15], v[64:67], v[72:75], a[12:15]
  v_mfma_f32_16x16x32_bf16 a[16:19], v[68:71], v[72:75], a[16:19]
  buffer_load_dwordx4 v[16:19], v1, s[8:11], s26 offen offset:0
  v_mfma_f32_16x16x32_bf16 a[20:23], v[52:55], v[76:79], a[20:23]
  v_mfma_f32_16x16x32_bf16 a[24:27], v[56:59], v[76:79], a[24:27]
  buffer_load_dwordx4 v[20:23], v1, s[8:11], s27 offen offset:0
  v_mfma_f32_16x16x32_bf16 a[28:31], v[60:63], v[76:79], a[28:31]
  v_mfma_f32_16x16x32_bf16 a[32:35], v[64:67], v[76:79], a[32:35]
  buffer_load_dwordx4 v[24:27], v1, s[8:11], s28 offen offset:0
  v_mfma_f32_16x16x32_bf16 a[36:39], v[68:71], v[76:79], a[36:39]
  v_mfma_f32_16x16x32_bf16 a[40:43], v[52:55], v[80:83], a[40:43]
  buffer_load_dwordx4 v[28:31], v1, s[8:11], s29 offen offset:0
  v_mfma_f32_16x16x32_bf16 a[44:47], v[56:59], v[80:83], a[44:47]
  v_mfma_f32_16x16x32_bf16 a[48:51], v[60:63], v[80:83], a[48:51]
  buffer_load_dwordx4 v[32:35], v1, s[8:11], s30 offen offset:0
  v_mfma_f32_16x16x32_bf16 a[52:55], v[64:67], v[80:83], a[52:55]
  v_mfma_f32_16x16x32_bf16 a[56:59], v[68:71], v[80:83], a[56:59]
  buffer_load_dwordx4 v[36:39], v1, s[8:11], s31 offen offset:0
  v_mfma_f32_16x16x32_bf16 a[60:63], v[52:55], v[84:87], a[60:63]
  v_mfma_f32_16x16x32_bf16 a[64:67], v[56:59], v[84:87], a[64:67]
  buffer_load_dwordx4 v[40:43], v1, s[8:11], s32 offen offset:0
  v_mfma_f32_16x16x32_bf16 a[68:71], v[60:63], v[84:87], a[68:71]
  v_mfma_f32_16x16x32_bf16 a[72:75], v[64:67], v[84:87], a[72:75]
  buffer_load_dwordx4 v[44:47], v1, s[8:11], s33 offen offset:0
  v_mfma_f32_16x16x32_bf16 a[76:79], v[68:71], v[84:87], a[76:79]
  v_mfma_f32_16x16x32_bf16 a[80:83], v[52:55], v[88:91], a[80:83]
  buffer_load_dwordx4 v[48:51], v1, s[8:11], s34 offen offset:0
  v_mfma_f32_16x16x32_bf16 a[84:87], v[56:59], v[88:91], a[84:87]
  v_mfma_f32_16x16x32_bf16 a[88:91], v[60:63], v[88:91], a[88:91]
  v_mfma_f32_16x16x32_bf16 a[92:95], v[64:67], v[88:91], a[92:95]
  v_mfma_f32_16x16x32_bf16 a[96:99], v[68:71], v[88:91], a[96:99]
  v_mfma_f32_16x16x32_bf16 a[100:103], v[52:55], v[92:95], a[100:103]
  v_mfma_f32_16x16x32_bf16 a[104:107], v[56:59], v[92:95], a[104:107]
  v_mfma_f32_16x16x32_bf16 a[108:111], v[60:63], v[92:95], a[108:111]
  v_mfma_f32_16x16x32_bf16 a[112:115], v[64:67], v[92:95], a[112:115]
  v_mfma_f32_16x16x32_bf16 a[116:119], v[68:71], v[92:95], a[116:119]
  s_waitcnt vmcnt(11)
  v_mfma_f32_16x16x32_bf16 a[0:3], v[96:99], v[116:119], a[0:3]
  buffer_load_dwordx4 v[52:55], v1, s[8:11], s24 offen offset:1024
  v_mfma_f32_16x16x32_bf16 a[4:7], v[100:103], v[116:119], a[4:7]
  v_mfma_f32_16x16x32_bf16 a[8:11], v[104:107], v[116:119], a[8:11]
  buffer_load_dwordx4 v[56:59], v1, s[8:11], s25 offen offset:1024
  v_mfma_f32_16x16x32_bf16 a[12:15], v[108:111], v[116:119], a[12:15]
  v_mfma_f32_16x16x32_bf16 a[16:19], v[112:115], v[116:119], a[16:19]
  buffer_load_dwordx4 v[60:63], v1, s[8:11], s26 offen offset:1024
  v_mfma_f32_16x16x32_bf16 a[20:23], v[96:99], v[120:123], a[20:23]
  v_mfma_f32_16x16x32_bf16 a[24:27], v[100:103], v[120:123], a[24:27]
  buffer_load_dwordx4 v[64:67], v1, s[8:11], s27 offen offset:1024
  v_mfma_f32_16x16x32_bf16 a[28:31], v[104:107], v[120:123], a[28:31]
  v_mfma_f32_16x16x32_bf16 a[32:35], v[108:111], v[120:123], a[32:35]
  buffer_load_dwordx4 v[68:71], v1, s[8:11], s28 offen offset:1024
  v_mfma_f32_16x16x32_bf16 a[36:39], v[112:115], v[120:123], a[36:39]
  v_mfma_f32_16x16x32_bf16 a[40:43], v[96:99], v[124:127], a[40:43]
  buffer_load_dwordx4 v[72:75], v1, s[8:11], s29 offen offset:1024
  v_mfma_f32_16x16x32_bf16 a[44:47], v[100:103], v[124:127], a[44:47]
  v_mfma_f32_16x16x32_bf16 a[48:51], v[104:107], v[124:127], a[48:51]
  buffer_load_dwordx4 v[76:79], v1, s[8:11], s30 offen offset:1024
  v_mfma_f32_16x16x32_bf16 a[52:55], v[108:111], v[124:127], a[52:55]
  v_mfma_f32_16x16x32_bf16 a[56:59], v[112:115], v[124:127], a[56:59]
  buffer_load_dwordx4 v[80:83], v1, s[8:11], s31 offen offset:1024
  v_mfma_f32_16x16x32_bf16 a[60:63], v[96:99], v[128:131], a[60:63]
  v_mfma_f32_16x16x32_bf16 a[64:67], v[100:103], v[128:131], a[64:67]
  buffer_load_dwordx4 v[84:87], v1, s[8:11], s32 offen offset:1024
  v_mfma_f32_16x16x32_bf16 a[68:71], v[104:107], v[128:131], a[68:71]
  v_mfma_f32_16x16x32_bf16 a[72:75], v[108:111], v[128:131], a[72:75]
  buffer_load_dwordx4 v[88:91], v1, s[8:11], s33 offen offset:1024
  v_mfma_f32_16x16x32_bf16 a[76:79], v[112:115], v[128:131], a[76:79]
  v_mfma_f32_16x16x32_bf16 a[80:83], v[96:99], v[132:135], a[80:83]
  buffer_load_dwordx4 v[92:95], v1, s[8:11], s34 offen offset:1024
  v_mfma_f32_16x16x32_bf16 a[84:87], v[100:103], v[132:135], a[84:87]
  v_mfma_f32_16x16x32_bf16 a[88:91], v[104:107], v[132:135], a[88:91]
  v_mfma_f32_16x16x32_bf16 a[92:95], v[108:111], v[132:135], a[92:95]
  v_mfma_f32_16x16x32_bf16 a[96:99], v[112:115], v[132:135], a[96:99]
  v_mfma_f32_16x16x32_bf16 a[100:103], v[96:99], v[136:139], a[100:103]
  v_mfma_f32_16x16x32_bf16 a[104:107], v[100:103], v[136:139], a[104:107]
  v_mfma_f32_16x16x32_bf16 a[108:111], v[104:107], v[136:139], a[108:111]
  v_mfma_f32_16x16x32_bf16 a[112:115], v[108:111], v[136:139], a[112:115]
  v_mfma_f32_16x16x32_bf16 a[116:119], v[112:115], v[136:139], a[116:119]
  s_waitcnt vmcnt(11)
  v_mfma_f32_16x16x32_bf16 a[0:3], v[8:11], v[28:31], a[0:3]
  buffer_load_dwordx4 v[96:99], v1, s[8:11], s24 offen offset:2048
  v_mfma_f32_16x16x32_bf16 a[4:7], v[12:15], v[28:31], a[4:7]
  v_mfma_f32_16x16x32_bf16 a[8:11], v[16:19], v[28:31], a[8:11]
  buffer_load_dwordx4 v[100:103], v1, s[8:11], s25 offen offset:2048
  v_mfma_f32_16x16x32_bf16 a[12:15], v[20:23], v[28:31], a[12:15]
  v_mfma_f32_16x16x32_bf16 a[16:19], v[24:27], v[28:31], a[16:19]
  buffer_load_dwordx4 v[104:107], v1, s[8:11], s26 offen offset:2048
  v_mfma_f32_16x16x32_bf16 a[20:23], v[8:11], v[32:35], a[20:23]
  v_mfma_f32_16x16x32_bf16 a[24:27], v[12:15], v[32:35], a[24:27]
  buffer_load_dwordx4 v[108:111], v1, s[8:11], s27 offen offset:2048
  v_mfma_f32_16x16x32_bf16 a[28:31], v[16:19], v[32:35], a[28:31]
  v_mfma_f32_16x16x32_bf16 a[32:35], v[20:23], v[32:35], a[32:35]
  buffer_load_dwordx4 v[112:115], v1, s[8:11], s28 offen offset:2048
  v_mfma_f32_16x16x32_bf16 a[36:39], v[24:27], v[32:35], a[36:39]
  v_mfma_f32_16x16x32_bf16 a[40:43], v[8:11], v[36:39], a[40:43]
  buffer_load_dwordx4 v[116:119], v1, s[8:11], s29 offen offset:2048
  v_mfma_f32_16x16x32_bf16 a[44:47], v[12:15], v[36:39], a[44:47]
  v_mfma_f32_16x16x32_bf16 a[48:51], v[16:19], v[36:39], a[48:51]
  buffer_load_dwordx4 v[120:123], v1, s[8:11], s30 offen offset:2048
  v_mfma_f32_16x16x32_bf16 a[52:55], v[20:23], v[36:39], a[52:55]
  v_mfma_f32_16x16x32_bf16 a[56:59], v[24:27], v[36:39], a[56:59]
  buffer_load_dwordx4 v[124:127], v1, s[8:11], s31 offen offset:2048
  v_mfma_f32_16x16x32_bf16 a[60:63], v[8:11], v[40:43], a[60:63]
  v_mfma_f32_16x16x32_bf16 a[64:67], v[12:15], v[40:43], a[64:67]
  buffer_load_dwordx4 v[128:131], v1, s[8:11], s32 offen offset:2048
  v_mfma_f32_16x16x32_bf16 a[68:71], v[16:19], v[40:43], a[68:71]
  v_mfma_f32_16x16x32_bf16 a[72:75], v[20:23], v[40:43], a[72:75]
  buffer_load_dwordx4 v[132:135], v1, s[8:11], s33 offen offset:2048
  v_mfma_f32_16x16x32_bf16 a[76:79], v[24:27], v[40:43], a[76:79]
  v_mfma_f32_16x16x32_bf16 a[80:83], v[8:11], v[44:47], a[80:83]
  buffer_load_dwordx4 v[136:139], v1, s[8:11], s34 offen offset:2048
  v_mfma_f32_16x16x32_bf16 a[84:87], v[12:15], v[44:47], a[84:87]
  v_mfma_f32_16x16x32_bf16 a[88:91], v[16:19], v[44:47], a[88:91]
  v_mfma_f32_16x16x32_bf16 a[92:95], v[20:23], v[44:47], a[92:95]
  v_mfma_f32_16x16x32_bf16 a[96:99], v[24:27], v[44:47], a[96:99]
  v_mfma_f32_16x16x32_bf16 a[100:103], v[8:11], v[48:51], a[100:103]
  v_mfma_f32_16x16x32_bf16 a[104:107], v[12:15], v[48:51], a[104:107]
  v_mfma_f32_16x16x32_bf16 a[108:111], v[16:19], v[48:51], a[108:111]
  v_mfma_f32_16x16x32_bf16 a[112:115], v[20:23], v[48:51], a[112:115]
  v_mfma_f32_16x16x32_bf16 a[116:119], v[24:27], v[48:51], a[116:119]
  s_waitcnt vmcnt(11)
  v_mfma_f32_16x16x32_bf16 a[0:3], v[52:55], v[72:75], a[0:3]
  buffer_load_dwordx4 v[8:11], v1, s[8:11], s24 offen offset:3072
  v_mfma_f32_16x16x32_bf16 a[4:7], v[56:59], v[72:75], a[4:7]
  v_mfma_f32_16x16x32_bf16 a[8:11], v[60:63], v[72:75], a[8:11]
  buffer_load_dwordx4 v[12:15], v1, s[8:11], s25 offen offset:3072
  v_mfma_f32_16x16x32_bf16 a[12:15], v[64:67], v[72:75], a[12:15]
  v_mfma_f32_16x16x32_bf16 a[16:19], v[68:71], v[72:75], a[16:19]
  buffer_load_dwordx4 v[16:19], v1, s[8:11], s26 offen offset:3072
  v_mfma_f32_16x16x32_bf16 a[20:23], v[52:55], v[76:79], a[20:23]
  v_mfma_f32_16x16x32_bf16 a[24:27], v[56:59], v[76:79], a[24:27]
  buffer_load_dwordx4 v[20:23], v1, s[8:11], s27 offen offset:3072
  v_mfma_f32_16x16x32_bf16 a[28:31], v[60:63], v[76:79], a[28:31]
  v_mfma_f32_16x16x32_bf16 a[32:35], v[64:67], v[76:79], a[32:35]
  buffer_load_dwordx4 v[24:27], v1, s[8:11], s28 offen offset:3072
  v_mfma_f32_16x16x32_bf16 a[36:39], v[68:71], v[76:79], a[36:39]
  v_mfma_f32_16x16x32_bf16 a[40:43], v[52:55], v[80:83], a[40:43]
  buffer_load_dwordx4 v[28:31], v1, s[8:11], s29 offen offset:3072
  v_mfma_f32_16x16x32_bf16 a[44:47], v[56:59], v[80:83], a[44:47]
  v_mfma_f32_16x16x32_bf16 a[48:51], v[60:63], v[80:83], a[48:51]
  buffer_load_dwordx4 v[32:35], v1, s[8:11], s30 offen offset:3072
  v_mfma_f32_16x16x32_bf16 a[52:55], v[64:67], v[80:83], a[52:55]
  v_mfma_f32_16x16x32_bf16 a[56:59], v[68:71], v[80:83], a[56:59]
  buffer_load_dwordx4 v[36:39], v1, s[8:11], s31 offen offset:3072
  v_mfma_f32_16x16x32_bf16 a[60:63], v[52:55], v[84:87], a[60:63]
  v_mfma_f32_16x16x32_bf16 a[64:67], v[56:59], v[84:87], a[64:67]
  buffer_load_dwordx4 v[40:43], v1, s[8:11], s32 offen offset:3072
  v_mfma_f32_16x16x32_bf16 a[68:71], v[60:63], v[84:87], a[68:71]
  v_mfma_f32_16x16x32_bf16 a[72:75], v[64:67], v[84:87], a[72:75]
  buffer_load_dwordx4 v[44:47], v1, s[8:11], s33 offen offset:3072
  v_mfma_f32_16x16x32_bf16 a[76:79], v[68:71], v[84:87], a[76:79]
  v_mfma_f32_16x16x32_bf16 a[80:83], v[52:55], v[88:91], a[80:83]
  buffer_load_dwordx4 v[48:51], v1, s[8:11], s34 offen offset:3072
  v_mfma_f32_16x16x32_bf16 a[84:87], v[56:59], v[88:91], a[84:87]
  v_mfma_f32_16x16x32_bf16 a[88:91], v[60:63], v[88:91], a[88:91]
  v_mfma_f32_16x16x32_bf16 a[92:95], v[64:67], v[88:91], a[92:95]
  v_mfma_f32_16x16x32_bf16 a[96:99], v[68:71], v[88:91], a[96:99]
  v_mfma_f32_16x16x32_bf16 a[100:103], v[52:55], v[92:95], a[100:103]
  v_mfma_f32_16x16x32_bf16 a[104:107], v[56:59], v[92:95], a[104:107]
  v_mfma_f32_16x16x32_bf16 a[108:111], v[60:63], v[92:95], a[108:111]
  v_mfma_f32_16x16x32_bf16 a[112:115], v[64:67], v[92:95], a[112:115]
  v_mfma_f32_16x16x32_bf16 a[116:119], v[68:71], v[92:95], a[116:119]
  s_waitcnt vmcnt(11)
  v_mfma_f32_16x16x32_bf16 a[0:3], v[96:99], v[116:119], a[0:3]
  s_add_u32 s24, s24, 4096
  s_add_u32 s25, s25, 4096
  s_add_u32 s26, s26, 4096
  s_add_u32 s27, s27, 4096
  s_add_u32 s28, s28, 4096
  s_add_u32 s29, s29, 4096
  s_add_u32 s30, s30, 4096
  s_add_u32 s31, s31, 4096
  s_add_u32 s32, s32, 4096
  s_add_u32 s33, s33, 4096
  s_add_u32 s34, s34, 4096
  buffer_load_dwordx4 v[52:55], v1, s[8:11], s24 offen offset:0
  v_mfma_f32_16x16x32_bf16 a[4:7], v[100:103], v[116:119], a[4:7]
  v_mfma_f32_16x16x32_bf16 a[8:11], v[104:107], v[116:119], a[8:11]
  buffer_load_dwordx4 v[56:59], v1, s[8:11], s25 offen offset:0
  v_mfma_f32_16x16x32_bf16 a[12:15], v[108:111], v[116:119], a[12:15]
  v_mfma_f32_16x16x32_bf16 a[16:19], v[112:115], v[116:119], a[16:19]
  buffer_load_dwordx4 v[60:63], v1, s[8:11], s26 offen offset:0
  v_mfma_f32_16x16x32_bf16 a[20:23], v[96:99], v[120:123], a[20:23]
  v_mfma_f32_16x16x32_bf16 a[24:27], v[100:103], v[120:123], a[24:27]
  buffer_load_dwordx4 v[64:67], v1, s[8:11], s27 offen offset:0
  v_mfma_f32_16x16x32_bf16 a[28:31], v[104:107], v[120:123], a[28:31]
  v_mfma_f32_16x16x32_bf16 a[32:35], v[108:111], v[120:123], a[32:35]
  buffer_load_dwordx4 v[68:71], v1, s[8:11], s28 offen offset:0
  v_mfma_f32_16x16x32_bf16 a[36:39], v[112:115], v[120:123], a[36:39]
  v_mfma_f32_16x16x32_bf16 a[40:43], v[96:99], v[124:127], a[40:43]
  buffer_load_dwordx4 v[72:75], v1, s[8:11], s29 offen offset:0
  v_mfma_f32_16x16x32_bf16 a[44:47], v[100:103], v[124:127], a[44:47]
  v_mfma_f32_16x16x32_bf16 a[48:51], v[104:107], v[124:127], a[48:51]
  buffer_load_dwordx4 v[76:79], v1, s[8:11], s30 offen offset:0
  v_mfma_f32_16x16x32_bf16 a[52:55], v[108:111], v[124:127], a[52:55]
  v_mfma_f32_16x16x32_bf16 a[56:59], v[112:115], v[124:127], a[56:59]
  buffer_load_dwordx4 v[80:83], v1, s[8:11], s31 offen offset:0
  v_mfma_f32_16x16x32_bf16 a[60:63], v[96:99], v[128:131], a[60:63]
  v_mfma_f32_16x16x32_bf16 a[64:67], v[100:103], v[128:131], a[64:67]
  buffer_load_dwordx4 v[84:87], v1, s[8:11], s32 offen offset:0
  v_mfma_f32_16x16x32_bf16 a[68:71], v[104:107], v[128:131], a[68:71]
  v_mfma_f32_16x16x32_bf16 a[72:75], v[108:111], v[128:131], a[72:75]
  buffer_load_dwordx4 v[88:91], v1, s[8:11], s33 offen offset:0
  v_mfma_f32_16x16x32_bf16 a[76:79], v[112:115], v[128:131], a[76:79]
  v_mfma_f32_16x16x32_bf16 a[80:83], v[96:99], v[132:135], a[80:83]
  buffer_load_dwordx4 v[92:95], v1, s[8:11], s34 offen offset:0
  v_mfma_f32_16x16x32_bf16 a[84:87], v[100:103], v[132:135], a[84:87]
  v_mfma_f32_16x16x32_bf16 a[88:91], v[104:107], v[132:135], a[88:91]
  v_mfma_f32_16x16x32_bf16 a[92:95], v[108:111], v[132:135], a[92:95]
  v_mfma_f32_16x16x32_bf16 a[96:99], v[112:115], v[132:135], a[96:99]
  v_mfma_f32_16x16x32_bf16 a[100:103], v[96:99], v[136:139], a[100:103]
  v_mfma_f32_16x16x32_bf16 a[104:107], v[100:103], v[136:139], a[104:107]
  v_mfma_f32_16x16x32_bf16 a[108:111], v[104:107], v[136:139], a[108:111]
  v_mfma_f32_16x16x32_bf16 a[112:115], v[108:111], v[136:139], a[112:115]
  v_mfma_f32_16x16x32_bf16 a[116:119], v[112:115], v[136:139], a[116:119]
  s_waitcnt vmcnt(11)
  v_mfma_f32_16x16x32_bf16 a[0:3], v[8:11], v[28:31], a[0:3]
  buffer_load_dwordx4 v[96:99], v1, s[8:11], s24 offen offset:1024
  v_mfma_f32_16x16x32_bf16 a[4:7], v[12:15], v[28:31], a[4:7]
  v_mfma_f32_16x16x32_bf16 a[8:11], v[16:19], v[28:31], a[8:11]
  buffer_load_dwordx4 v[100:103], v1, s[8:11], s25 offen offset:1024
  v_mfma_f32_16x16x32_bf16 a[12:15], v[20:23], v[28:31], a[12:15]
  v_mfma_f32_16x16x32_bf16 a[16:19], v[24:27], v[28:31], a[16:19]
  buffer_load_dwordx4 v[104:107], v1, s[8:11], s26 offen offset:1024
  v_mfma_f32_16x16x32_bf16 a[20:23], v[8:11], v[32:35], a[20:23]
  v_mfma_f32_16x16x32_bf16 a[24:27], v[12:15], v[32:35], a[24:27]
  buffer_load_dwordx4 v[108:111], v1, s[8:11], s27 offen offset:1024
  v_mfma_f32_16x16x32_bf16 a[28:31], v[16:19], v[32:35], a[28:31]
  v_mfma_f32_16x16x32_bf16 a[32:35], v[20:23], v[32:35], a[32:35]
  buffer_load_dwordx4 v[112:115], v1, s[8:11], s28 offen offset:1024
  v_mfma_f32_16x16x32_bf16 a[36:39], v[24:27], v[32:35], a[36:39]
  v_mfma_f32_16x16x32_bf16 a[40:43], v[8:11], v[36:39], a[40:43]
  buffer_load_dwordx4 v[116:119], v1, s[8:11], s29 offen offset:1024
  v_mfma_f32_16x16x32_bf16 a[44:47], v[12:15], v[36:39], a[44:47]
  v_mfma_f32_16x16x32_bf16 a[48:51], v[16:19], v[36:39], a[48:51]
  buffer_load_dwordx4 v[120:123], v1, s[8:11], s30 offen offset:1024
  v_mfma_f32_16x16x32_bf16 a[52:55], v[20:23], v[36:39], a[52:55]
  v_mfma_f32_16x16x32_bf16 a[56:59], v[24:27], v[36:39], a[56:59]
  buffer_load_dwordx4 v[124:127], v1, s[8:11], s31 offen offset:1024
  v_mfma_f32_16x16x32_bf16 a[60:63], v[8:11], v[40:43], a[60:63]
  v_mfma_f32_16x16x32_bf16 a[64:67], v[12:15], v[40:43], a[64:67]
  buffer_load_dwordx4 v[128:131], v1, s[8:11], s32 offen offset:1024
  v_mfma_f32_16x16x32_bf16 a[68:71], v[16:19], v[40:43], a[68:71]
  v_mfma_f32_16x16x32_bf16 a[72:75], v[20:23], v[40:43], a[72:75]
  buffer_load_dwordx4 v[132:135], v1, s[8:11], s33 offen offset:1024
  v_mfma_f32_16x16x32_bf16 a[76:79], v[24:27], v[40:43], a[76:79]
  v_mfma_f32_16x16x32_bf16 a[80:83], v[8:11], v[44:47], a[80:83]
  buffer_load_dwordx4 v[136:139], v1, s[8:11], s34 offen offset:1024
  v_mfma_f32_16x16x32_bf16 a[84:87], v[12:15], v[44:47], a[84:87]
  v_mfma_f32_16x16x32_bf16 a[88:91], v[16:19], v[44:47], a[88:91]
  v_mfma_f32_16x16x32_bf16 a[92:95], v[20:23], v[44:47], a[92:95]
  v_mfma_f32_16x16x32_bf16 a[96:99], v[24:27], v[44:47], a[96:99]
  v_mfma_f32_16x16x32_bf16 a[100:103], v[8:11], v[48:51], a[100:103]
  v_mfma_f32_16x16x32_bf16 a[104:107], v[12:15], v[48:51], a[104:107]
  v_mfma_f32_16x16x32_bf16 a[108:111], v[16:19], v[48:51], a[108:111]
  v_mfma_f32_16x16x32_bf16 a[112:115], v[20:23], v[48:51], a[112:115]
  v_mfma_f32_16x16x32_bf16 a[116:119], v[24:27], v[48:51], a[116:119]
  s_waitcnt vmcnt(11)
  v_mfma_f32_16x16x32_bf16 a[0:3], v[52:55], v[72:75], a[0:3]
  buffer_load_dwordx4 v[8:11], v1, s[8:11], s24 offen offset:2048
  v_mfma_f32_16x16x32_bf16 a[4:7], v[56:59], v[72:75], a[4:7]
  v_mfma_f32_16x16x32_bf16 a[8:11], v[60:63], v[72:75], a[8:11]
  buffer_load_dwordx4 v[12:15], v1, s[8:11], s25 offen offset:2048
  v_mfma_f32_16x16x32_bf16 a[12:15], v[64:67], v[72:75], a[12:15]
  v_mfma_f32_16x16x32_bf16 a[16:19], v[68:71], v[72:75], a[16:19]
  buffer_load_dwordx4 v[16:19], v1, s[8:11], s26 offen offset:2048
  v_mfma_f32_16x16x32_bf16 a[20:23], v[52:55], v[76:79], a[20:23]
  v_mfma_f32_16x16x32_bf16 a[24:27], v[56:59], v[76:79], a[24:27]
  buffer_load_dwordx4 v[20:23], v1, s[8:11], s27 offen offset:2048
  v_mfma_f32_16x16x32_bf16 a[28:31], v[60:63], v[76:79], a[28:31]
  v_mfma_f32_16x16x32_bf16 a[32:35], v[64:67], v[76:79], a[32:35]
  buffer_load_dwordx4 v[24:27], v1, s[8:11], s28 offen offset:2048
  v_mfma_f32_16x16x32_bf16 a[36:39], v[68:71], v[76:79], a[36:39]
  v_mfma_f32_16x16x32_bf16 a[40:43], v[52:55], v[80:83], a[40:43]
  buffer_load_dwordx4 v[28:31], v1, s[8:11], s29 offen offset:2048
  v_mfma_f32_16x16x32_bf16 a[44:47], v[56:59], v[80:83], a[44:47]
  v_mfma_f32_16x16x32_bf16 a[48:51], v[60:63], v[80:83], a[48:51]
  buffer_load_dwordx4 v[32:35], v1, s[8:11], s30 offen offset:2048
  v_mfma_f32_16x16x32_bf16 a[52:55], v[64:67], v[80:83], a[52:55]
  v_mfma_f32_16x16x32_bf16 a[56:59], v[68:71], v[80:83], a[56:59]
  buffer_load_dwordx4 v[36:39], v1, s[8:11], s31 offen offset:2048
  v_mfma_f32_16x16x32_bf16 a[60:63], v[52:55], v[84:87], a[60:63]
  v_mfma_f32_16x16x32_bf16 a[64:67], v[56:59], v[84:87], a[64:67]
  buffer_load_dwordx4 v[40:43], v1, s[8:11], s32 offen offset:2048
  v_mfma_f32_16x16x32_bf16 a[68:71], v[60:63], v[84:87], a[68:71]
  v_mfma_f32_16x16x32_bf16 a[72:75], v[64:67], v[84:87], a[72:75]
  buffer_load_dwordx4 v[44:47], v1, s[8:11], s33 offen offset:2048
  v_mfma_f32_16x16x32_bf16 a[76:79], v[68:71], v[84:87], a[76:79]
  v_mfma_f32_16x16x32_bf16 a[80:83], v[52:55], v[88:91], a[80:83]
  buffer_load_dwordx4 v[48:51], v1, s[8:11], s34 offen offset:2048
  v_mfma_f32_16x16x32_bf16 a[84:87], v[56:59], v[88:91], a[84:87]
  v_mfma_f32_16x16x32_bf16 a[88:91], v[60:63], v[88:91], a[88:91]
  v_mfma_f32_16x16x32_bf16 a[92:95], v[64:67], v[88:91], a[92:95]
  v_mfma_f32_16x16x32_bf16 a[96:99], v[68:71], v[88:91], a[96:99]
  v_mfma_f32_16x16x32_bf16 a[100:103], v[52:55], v[92:95], a[100:103]
  v_mfma_f32_16x16x32_bf16 a[104:107], v[56:59], v[92:95], a[104:107]
  v_mfma_f32_16x16x32_bf16 a[108:111], v[60:63], v[92:95], a[108:111]
  v_mfma_f32_16x16x32_bf16 a[112:115], v[64:67], v[92:95], a[112:115]
  v_mfma_f32_16x16x32_bf16 a[116:119], v[68:71], v[92:95], a[116:119]
  s_waitcnt vmcnt(11)
  v_mfma_f32_16x16x32_bf16 a[0:3], v[96:99], v[116:119], a[0:3]
  buffer_load_dwordx4 v[52:55], v1, s[8:11], s24 offen offset:3072
  v_mfma_f32_16x16x32_bf16 a[4:7], v[100:103], v[116:119], a[4:7]
  v_mfma_f32_16x16x32_bf16 a[8:11], v[104:107], v[116:119], a[8:11]
  buffer_load_dwordx4 v[56:59], v1, s[8:11], s25 offen offset:3072
  v_mfma_f32_16x16x32_bf16 a[12:15], v[108:111], v[116:119], a[12:15]
  v_mfma_f32_16x16x32_bf16 a[16:19], v[112:115], v[116:119], a[16:19]
  buffer_load_dwordx4 v[60:63], v1, s[8:11], s26 offen offset:3072
  v_mfma_f32_16x16x32_bf16 a[20:23], v[96:99], v[120:123], a[20:23]
  v_mfma_f32_16x16x32_bf16 a[24:27], v[100:103], v[120:123], a[24:27]
  buffer_load_dwordx4 v[64:67], v1, s[8:11], s27 offen offset:3072
  v_mfma_f32_16x16x32_bf16 a[28:31], v[104:107], v[120:123], a[28:31]
  v_mfma_f32_16x16x32_bf16 a[32:35], v[108:111], v[120:123], a[32:35]
  buffer_load_dwordx4 v[68:71], v1, s[8:11], s28 offen offset:3072
  v_mfma_f32_16x16x32_bf16 a[36:39], v[112:115], v[120:123], a[36:39]
  v_mfma_f32_16x16x32_bf16 a[40:43], v[96:99], v[124:127], a[40:43]
  buffer_load_dwordx4 v[72:75], v1, s[8:11], s29 offen offset:3072
  v_mfma_f32_16x16x32_bf16 a[44:47], v[100:103], v[124:127], a[44:47]
  v_mfma_f32_16x16x32_bf16 a[48:51], v[104:107], v[124:127], a[48:51]
  buffer_load_dwordx4 v[76:79], v1, s[8:11], s30 offen offset:3072
  v_mfma_f32_16x16x32_bf16 a[52:55], v[108:111], v[124:127], a[52:55]
  v_mfma_f32_16x16x32_bf16 a[56:59], v[112:115], v[124:127], a[56:59]
  buffer_load_dwordx4 v[80:83], v1, s[8:11], s31 offen offset:3072
  v_mfma_f32_16x16x32_bf16 a[60:63], v[96:99], v[128:131], a[60:63]
  v_mfma_f32_16x16x32_bf16 a[64:67], v[100:103], v[128:131], a[64:67]
  buffer_load_dwordx4 v[84:87], v1, s[8:11], s32 offen offset:3072
  v_mfma_f32_16x16x32_bf16 a[68:71], v[104:107], v[128:131], a[68:71]
  v_mfma_f32_16x16x32_bf16 a[72:75], v[108:111], v[128:131], a[72:75]
  buffer_load_dwordx4 v[88:91], v1, s[8:11], s33 offen offset:3072
  v_mfma_f32_16x16x32_bf16 a[76:79], v[112:115], v[128:131], a[76:79]
  v_mfma_f32_16x16x32_bf16 a[80:83], v[96:99], v[132:135], a[80:83]
  buffer_load_dwordx4 v[92:95], v1, s[8:11], s34 offen offset:3072
  v_mfma_f32_16x16x32_bf16 a[84:87], v[100:103], v[132:135], a[84:87]
  v_mfma_f32_16x16x32_bf16 a[88:91], v[104:107], v[132:135], a[88:91]
  v_mfma_f32_16x16x32_bf16 a[92:95], v[108:111], v[132:135], a[92:95]
  v_mfma_f32_16x16x32_bf16 a[96:99], v[112:115], v[132:135], a[96:99]
  v_mfma_f32_16x16x32_bf16 a[100:103], v[96:99], v[136:139], a[100:103]
  v_mfma_f32_16x16x32_bf16 a[104:107], v[100:103], v[136:139], a[104:107]
  v_mfma_f32_16x16x32_bf16 a[108:111], v[104:107], v[136:139], a[108:111]
  v_mfma_f32_16x16x32_bf16 a[112:115], v[108:111], v[136:139], a[112:115]
  v_mfma_f32_16x16x32_bf16 a[116:119], v[112:115], v[136:139], a[116:119]
  s_waitcnt vmcnt(11)
  v_mfma_f32_16x16x32_bf16 a[0:3], v[8:11], v[28:31], a[0:3]
  v_mfma_f32_16x16x32_bf16 a[4:7], v[12:15], v[28:31], a[4:7]
  v_mfma_f32_16x16x32_bf16 a[8:11], v[16:19], v[28:31], a[8:11]
  v_mfma_f32_16x16x32_bf16 a[12:15], v[20:23], v[28:31], a[12:15]
  v_mfma_f32_16x16x32_bf16 a[16:19], v[24:27], v[28:31], a[16:19]
  v_mfma_f32_16x16x32_bf16 a[20:23], v[8:11], v[32:35], a[20:23]
  v_mfma_f32_16x16x32_bf16 a[24:27], v[12:15], v[32:35], a[24:27]
  v_mfma_f32_16x16x32_bf16 a[28:31], v[16:19], v[32:35], a[28:31]
  v_mfma_f32_16x16x32_bf16 a[32:35], v[20:23], v[32:35], a[32:35]
  v_mfma_f32_16x16x32_bf16 a[36:39], v[24:27], v[32:35], a[36:39]
  v_mfma_f32_16x16x32_bf16 a[40:43], v[8:11], v[36:39], a[40:43]
  v_mfma_f32_16x16x32_bf16 a[44:47], v[12:15], v[36:39], a[44:47]
  v_mfma_f32_16x16x32_bf16 a[48:51], v[16:19], v[36:39], a[48:51]
  v_mfma_f32_16x16x32_bf16 a[52:55], v[20:23], v[36:39], a[52:55]
  v_mfma_f32_16x16x32_bf16 a[56:59], v[24:27], v[36:39], a[56:59]
  v_mfma_f32_16x16x32_bf16 a[60:63], v[8:11], v[40:43], a[60:63]
  v_mfma_f32_16x16x32_bf16 a[64:67], v[12:15], v[40:43], a[64:67]
  v_mfma_f32_16x16x32_bf16 a[68:71], v[16:19], v[40:43], a[68:71]
  v_mfma_f32_16x16x32_bf16 a[72:75], v[20:23], v[40:43], a[72:75]
  v_mfma_f32_16x16x32_bf16 a[76:79], v[24:27], v[40:43], a[76:79]
  v_mfma_f32_16x16x32_bf16 a[80:83], v[8:11], v[44:47], a[80:83]
  v_mfma_f32_16x16x32_bf16 a[84:87], v[12:15], v[44:47], a[84:87]
  v_mfma_f32_16x16x32_bf16 a[88:91], v[16:19], v[44:47], a[88:91]
  v_mfma_f32_16x16x32_bf16 a[92:95], v[20:23], v[44:47], a[92:95]
  v_mfma_f32_16x16x32_bf16 a[96:99], v[24:27], v[44:47], a[96:99]
  v_mfma_f32_16x16x32_bf16 a[100:103], v[8:11], v[48:51], a[100:103]
  v_mfma_f32_16x16x32_bf16 a[104:107], v[12:15], v[48:51], a[104:107]
  v_mfma_f32_16x16x32_bf16 a[108:111], v[16:19], v[48:51], a[108:111]
  v_mfma_f32_16x16x32_bf16 a[112:115], v[20:23], v[48:51], a[112:115]
  v_mfma_f32_16x16x32_bf16 a[116:119], v[24:27], v[48:51], a[116:119]
  s_waitcnt vmcnt(0)
  v_mfma_f32_16x16x32_bf16 a[0:3], v[52:55], v[72:75], a[0:3]
  v_mfma_f32_16x16x32_bf16 a[4:7], v[56:59], v[72:75], a[4:7]
  v_mfma_f32_16x16x32_bf16 a[8:11], v[60:63], v[72:75], a[8:11]
  v_mfma_f32_16x16x32_bf16 a[12:15], v[64:67], v[72:75], a[12:15]
  v_mfma_f32_16x16x32_bf16 a[16:19], v[68:71], v[72:75], a[16:19]
  v_mfma_f32_16x16x32_bf16 a[20:23], v[52:55], v[76:79], a[20:23]
  v_mfma_f32_16x16x32_bf16 a[24:27], v[56:59], v[76:79], a[24:27]
  v_mfma_f32_16x16x32_bf16 a[28:31], v[60:63], v[76:79], a[28:31]
  v_mfma_f32_16x16x32_bf16 a[32:35], v[64:67], v[76:79], a[32:35]
  v_mfma_f32_16x16x32_bf16 a[36:39], v[68:71], v[76:79], a[36:39]
  v_mfma_f32_16x16x32_bf16 a[40:43], v[52:55], v[80:83], a[40:43]
  v_mfma_f32_16x16x32_bf16 a[44:47], v[56:59], v[80:83], a[44:47]
  v_mfma_f32_16x16x32_bf16 a[48:51], v[60:63], v[80:83], a[48:51]
  v_mfma_f32_16x16x32_bf16 a[52:55], v[64:67], v[80:83], a[52:55]
  v_mfma_f32_16x16x32_bf16 a[56:59], v[68:71], v[80:83], a[56:59]
  v_mfma_f32_16x16x32_bf16 a[60:63], v[52:55], v[84:87], a[60:63]
  v_mfma_f32_16x16x32_bf16 a[64:67], v[56:59], v[84:87], a[64:67]
  v_mfma_f32_16x16x32_bf16 a[68:71], v[60:63], v[84:87], a[68:71]
  v_mfma_f32_16x16x32_bf16 a[72:75], v[64:67], v[84:87], a[72:75]
  v_mfma_f32_16x16x32_bf16 a[76:79], v[68:71], v[84:87], a[76:79]
  v_mfma_f32_16x16x32_bf16 a[80:83], v[52:55], v[88:91], a[80:83]
  v_mfma_f32_16x16x32_bf16 a[84:87], v[56:59], v[88:91], a[84:87]
  v_mfma_f32_16x16x32_bf16 a[88:91], v[60:63], v[88:91], a[88:91]
  v_mfma_f32_16x16x32_bf16 a[92:95], v[64:67], v[88:91], a[92:95]
  v_mfma_f32_16x16x32_bf16 a[96:99], v[68:71], v[88:91], a[96:99]
  v_mfma_f32_16x16x32_bf16 a[100:103], v[52:55], v[92:95], a[100:103]
  v_mfma_f32_16x16x32_bf16 a[104:107], v[56:59], v[92:95], a[104:107]
  v_mfma_f32_16x16x32_bf16 a[108:111], v[60:63], v[92:95], a[108:111]
  v_mfma_f32_16x16x32_bf16 a[112:115], v[64:67], v[92:95], a[112:115]
  v_mfma_f32_16x16x32_bf16 a[116:119], v[68:71], v[92:95], a[116:119]
  s_mul_i32 s20, s16, 30720
  v_add_u32 v3, s20, v1
  s_nop 7
  ds_write_b128 v3, a[0:3] offset:0
  ds_write_b128 v3, a[4:7] offset:1024
  ds_write_b128 v3, a[8:11] offset:2048
  ds_write_b128 v3, a[12:15] offset:3072
  ds_write_b128 v3, a[16:19] offset:4096
  ds_write_b128 v3, a[20:23] offset:5120
  ds_write_b128 v3, a[24:27] offset:6144
  ds_write_b128 v3, a[28:31] offset:7168
  ds_write_b128 v3, a[32:35] offset:8192
  ds_write_b128 v3, a[36:39] offset:9216
  ds_write_b128 v3, a[40:43] offset:10240
  ds_write_b128 v3, a[44:47] offset:11264
  ds_write_b128 v3, a[48:51] offset:12288
  ds_write_b128 v3, a[52:55] offset:13312
  ds_write_b128 v3, a[56:59] offset:14336
  ds_write_b128 v3, a[60:63] offset:15360
  ds_write_b128 v3, a[64:67] offset:16384
  ds_write_b128 v3, a[68:71] offset:17408
  ds_write_b128 v3, a[72:75] offset:18432
  ds_write_b128 v3, a[76:79] offset:19456
  ds_write_b128 v3, a[80:83] offset:20480
  ds_write_b128 v3, a[84:87] offset:21504
  ds_write_b128 v3, a[88:91] offset:22528
  ds_write_b128 v3, a[92:95] offset:23552
  ds_write_b128 v3, a[96:99] offset:24576
  ds_write_b128 v3, a[100:103] offset:25600
  ds_write_b128 v3, a[104:107] offset:26624
  ds_write_b128 v3, a[108:111] offset:27648
  ds_write_b128 v3, a[112:115] offset:28672
  ds_write_b128 v3, a[116:119] offset:29696
  s_waitcnt lgkmcnt(0)
  s_barrier
  v_and_b32 v4, 15, v2
  v_mul_u32_u24 v4, 2560, v4
  v_lshrrev_b32 v5, 4, v2
  v_lshl_add_u32 v4, v5, 3, v4
  s_mul_i32 s20, s18, 245760
  s_mul_i32 s21, s17, 1280
  s_add_u32 s20, s20, s21
  s_mul_i32 s21, s19, 160
  s_add_u32 s20, s20, s21
  s_lshl_b32 s22, s16, 10
  v_add_u32 v3, s22, v1
  ds_read_b128 v[16:19], v3 offset:0
  ds_read_b128 v[20:23], v3 offset:30720
  ds_read_b128 v[24:27], v3 offset:61440
  v_add_u32 v6, 92160, v3
  ds_read_b128 v[28:31], v6
  s_add_u32 s21, s16, 0
  s_mul_i32 s22, s21, 52
  s_lshr_b32 s22, s22, 8
  s_mul_i32 s30, s22, 5
  s_sub_u32 s30, s21, s30
  s_mul_i32 s22, s22, 40960
  s_lshl_b32 s30, s30, 5
  s_add_u32 s22, s22, s30
  s_add_u32 s22, s22, s20
  s_waitcnt lgkmcnt(0)
  v_add_f32 v16, v16, v20
  v_add_f32 v17, v17, v21
  v_add_f32 v18, v18, v22
  v_add_f32 v19, v19, v23
  v_add_f32 v24, v24, v28
  v_add_f32 v25, v25, v29
  v_add_f32 v26, v26, v30
  v_add_f32 v27, v27, v31
  v_add_f32 v16, v16, v24
  v_add_f32 v17, v17, v25
  v_add_f32 v18, v18, v26
  v_add_f32 v19, v19, v27
  v_cvt_pk_bf16_f32 v32, v16, v17
  v_cvt_pk_bf16_f32 v33, v18, v19
  buffer_store_dwordx2 v[32:33], v4, s[12:15], s22 offen
  ds_read_b128 v[16:19], v3 offset:4096
  ds_read_b128 v[20:23], v3 offset:34816
  v_add_u32 v6, 65536, v3
  ds_read_b128 v[24:27], v6
  v_add_u32 v6, 96256, v3
  ds_read_b128 v[28:31], v6
  s_add_u32 s21, s16, 4
  s_mul_i32 s22, s21, 52
  s_lshr_b32 s22, s22, 8
  s_mul_i32 s30, s22, 5
  s_sub_u32 s30, s21, s30
  s_mul_i32 s22, s22, 40960
  s_lshl_b32 s30, s30, 5
  s_add_u32 s22, s22, s30
  s_add_u32 s22, s22, s20
  s_waitcnt lgkmcnt(0)
  v_add_f32 v16, v16, v20
  v_add_f32 v17, v17, v21
  v_add_f32 v18, v18, v22
  v_add_f32 v19, v19, v23
  v_add_f32 v24, v24, v28
  v_add_f32 v25, v25, v29
  v_add_f32 v26, v26, v30
  v_add_f32 v27, v27, v31
  v_add_f32 v16, v16, v24
  v_add_f32 v17, v17, v25
  v_add_f32 v18, v18, v26
  v_add_f32 v19, v19, v27
  v_cvt_pk_bf16_f32 v32, v16, v17
  v_cvt_pk_bf16_f32 v33, v18, v19
  buffer_store_dwordx2 v[32:33], v4, s[12:15], s22 offen
  ds_read_b128 v[16:19], v3 offset:8192
  ds_read_b128 v[20:23], v3 offset:38912
  v_add_u32 v6, 69632, v3
  ds_read_b128 v[24:27], v6
  v_add_u32 v6, 100352, v3
  ds_read_b128 v[28:31], v6
  s_add_u32 s21, s16, 8
  s_mul_i32 s22, s21, 52
  s_lshr_b32 s22, s22, 8
  s_mul_i32 s30, s22, 5
  s_sub_u32 s30, s21, s30
  s_mul_i32 s22, s22, 40960
  s_lshl_b32 s30, s30, 5
  s_add_u32 s22, s22, s30
  s_add_u32 s22, s22, s20
  s_waitcnt lgkmcnt(0)
  v_add_f32 v16, v16, v20
  v_add_f32 v17, v17, v21
  v_add_f32 v18, v18, v22
  v_add_f32 v19, v19, v23
  v_add_f32 v24, v24, v28
  v_add_f32 v25, v25, v29
  v_add_f32 v26, v26, v30
  v_add_f32 v27, v27, v31
  v_add_f32 v16, v16, v24
  v_add_f32 v17, v17, v25
  v_add_f32 v18, v18, v26
  v_add_f32 v19, v19, v27
  v_cvt_pk_bf16_f32 v32, v16, v17
  v_cvt_pk_bf16_f32 v33, v18, v19
  buffer_store_dwordx2 v[32:33], v4, s[12:15], s22 offen
  ds_read_b128 v[16:19], v3 offset:12288
  ds_read_b128 v[20:23], v3 offset:43008
  v_add_u32 v6, 73728, v3
  ds_read_b128 v[24:27], v6
  v_add_u32 v6, 104448, v3
  ds_read_b128 v[28:31], v6
  s_add_u32 s21, s16, 12
  s_mul_i32 s22, s21, 52
  s_lshr_b32 s22, s22, 8
  s_mul_i32 s30, s22, 5
  s_sub_u32 s30, s21, s30
  s_mul_i32 s22, s22, 40960
  s_lshl_b32 s30, s30, 5
  s_add_u32 s22, s22, s30
  s_add_u32 s22, s22, s20
  s_waitcnt lgkmcnt(0)
  v_add_f32 v16, v16, v20
  v_add_f32 v17, v17, v21
  v_add_f32 v18, v18, v22
  v_add_f32 v19, v19, v23
  v_add_f32 v24, v24, v28
  v_add_f32 v25, v25, v29
  v_add_f32 v26, v26, v30
  v_add_f32 v27, v27, v31
  v_add_f32 v16, v16, v24
  v_add_f32 v17, v17, v25
  v_add_f32 v18, v18, v26
  v_add_f32 v19, v19, v27
  v_cvt_pk_bf16_f32 v32, v16, v17
  v_cvt_pk_bf16_f32 v33, v18, v19
  buffer_store_dwordx2 v[32:33], v4, s[12:15], s22 offen
  ds_read_b128 v[16:19], v3 offset:16384
  ds_read_b128 v[20:23], v3 offset:47104
  v_add_u32 v6, 77824, v3
  ds_read_b128 v[24:27], v6
  v_add_u32 v6, 108544, v3
  ds_read_b128 v[28:31], v6
  s_add_u32 s21, s16, 16
  s_mul_i32 s22, s21, 52
  s_lshr_b32 s22, s22, 8
  s_mul_i32 s30, s22, 5
  s_sub_u32 s30, s21, s30
  s_mul_i32 s22, s22, 40960
  s_lshl_b32 s30, s30, 5
  s_add_u32 s22, s22, s30
  s_add_u32 s22, s22, s20
  s_waitcnt lgkmcnt(0)
  v_add_f32 v16, v16, v20
  v_add_f32 v17, v17, v21
  v_add_f32 v18, v18, v22
  v_add_f32 v19, v19, v23
  v_add_f32 v24, v24, v28
  v_add_f32 v25, v25, v29
  v_add_f32 v26, v26, v30
  v_add_f32 v27, v27, v31
  v_add_f32 v16, v16, v24
  v_add_f32 v17, v17, v25
  v_add_f32 v18, v18, v26
  v_add_f32 v19, v19, v27
  v_cvt_pk_bf16_f32 v32, v16, v17
  v_cvt_pk_bf16_f32 v33, v18, v19
  buffer_store_dwordx2 v[32:33], v4, s[12:15], s22 offen
  ds_read_b128 v[16:19], v3 offset:20480
  ds_read_b128 v[20:23], v3 offset:51200
  v_add_u32 v6, 81920, v3
  ds_read_b128 v[24:27], v6
  v_add_u32 v6, 112640, v3
  ds_read_b128 v[28:31], v6
  s_add_u32 s21, s16, 20
  s_mul_i32 s22, s21, 52
  s_lshr_b32 s22, s22, 8
  s_mul_i32 s30, s22, 5
  s_sub_u32 s30, s21, s30
  s_mul_i32 s22, s22, 40960
  s_lshl_b32 s30, s30, 5
  s_add_u32 s22, s22, s30
  s_add_u32 s22, s22, s20
  s_waitcnt lgkmcnt(0)
  v_add_f32 v16, v16, v20
  v_add_f32 v17, v17, v21
  v_add_f32 v18, v18, v22
  v_add_f32 v19, v19, v23
  v_add_f32 v24, v24, v28
  v_add_f32 v25, v25, v29
  v_add_f32 v26, v26, v30
  v_add_f32 v27, v27, v31
  v_add_f32 v16, v16, v24
  v_add_f32 v17, v17, v25
  v_add_f32 v18, v18, v26
  v_add_f32 v19, v19, v27
  v_cvt_pk_bf16_f32 v32, v16, v17
  v_cvt_pk_bf16_f32 v33, v18, v19
  buffer_store_dwordx2 v[32:33], v4, s[12:15], s22 offen
  ds_read_b128 v[16:19], v3 offset:24576
  ds_read_b128 v[20:23], v3 offset:55296
  v_add_u32 v6, 86016, v3
  ds_read_b128 v[24:27], v6
  v_add_u32 v6, 116736, v3
  ds_read_b128 v[28:31], v6
  s_add_u32 s21, s16, 24
  s_mul_i32 s22, s21, 52
  s_lshr_b32 s22, s22, 8
  s_mul_i32 s30, s22, 5
  s_sub_u32 s30, s21, s30
  s_mul_i32 s22, s22, 40960
  s_lshl_b32 s30, s30, 5
  s_add_u32 s22, s22, s30
  s_add_u32 s22, s22, s20
  s_waitcnt lgkmcnt(0)
  v_add_f32 v16, v16, v20
  v_add_f32 v17, v17, v21
  v_add_f32 v18, v18, v22
  v_add_f32 v19, v19, v23
  v_add_f32 v24, v24, v28
  v_add_f32 v25, v25, v29
  v_add_f32 v26, v26, v30
  v_add_f32 v27, v27, v31
  v_add_f32 v16, v16, v24
  v_add_f32 v17, v17, v25
  v_add_f32 v18, v18, v26
  v_add_f32 v19, v19, v27
  v_cvt_pk_bf16_f32 v32, v16, v17
  v_cvt_pk_bf16_f32 v33, v18, v19
  buffer_store_dwordx2 v[32:33], v4, s[12:15], s22 offen
  s_cmp_ge_u32 s16, 2
  s_cbranch_scc1 K2_END
  ds_read_b128 v[16:19], v3 offset:28672
  ds_read_b128 v[20:23], v3 offset:59392
  v_add_u32 v6, 90112, v3
  ds_read_b128 v[24:27], v6
  v_add_u32 v6, 120832, v3
  ds_read_b128 v[28:31], v6
  s_add_u32 s21, s16, 28
  s_mul_i32 s22, s21, 52
  s_lshr_b32 s22, s22, 8
  s_mul_i32 s30, s22, 5
  s_sub_u32 s30, s21, s30
  s_mul_i32 s22, s22, 40960
  s_lshl_b32 s30, s30, 5
  s_add_u32 s22, s22, s30
  s_add_u32 s22, s22, s20
  s_waitcnt lgkmcnt(0)
  v_add_f32 v16, v16, v20
  v_add_f32 v17, v17, v21
  v_add_f32 v18, v18, v22
  v_add_f32 v19, v19, v23
  v_add_f32 v24, v24, v28
  v_add_f32 v25, v25, v29
  v_add_f32 v26, v26, v30
  v_add_f32 v27, v27, v31
  v_add_f32 v16, v16, v24
  v_add_f32 v17, v17, v25
  v_add_f32 v18, v18, v26
  v_add_f32 v19, v19, v27
  v_cvt_pk_bf16_f32 v32, v16, v17
  v_cvt_pk_bf16_f32 v33, v18, v19
  buffer_store_dwordx2 v[32:33], v4, s[12:15], s22 offen
K2_END:
  s_endpgm
CODE_END:

.section .rodata,"a"
.p2align 6
.amdhsa_kernel concat_heads__gqa_block_cached__mha_block_cached__near_ridge_kernel
  .amdhsa_next_free_vgpr 168
  .amdhsa_next_free_sgpr 100
  .amdhsa_accum_offset 168
  .amdhsa_group_segment_fixed_size 0
  .amdhsa_kernarg_size 104
  .amdhsa_user_sgpr_count 2
  .amdhsa_user_sgpr_kernarg_segment_ptr 1
  .amdhsa_system_sgpr_workgroup_id_x 1
.end_amdhsa_kernel

.section .rodata,"a"
.p2align 6
.amdhsa_kernel outproj_kernel
  .amdhsa_next_free_vgpr 376
  .amdhsa_next_free_sgpr 100
  .amdhsa_accum_offset 256
  .amdhsa_group_segment_fixed_size 0
  .amdhsa_kernarg_size 104
  .amdhsa_user_sgpr_count 2
  .amdhsa_user_sgpr_kernarg_segment_ptr 1
  .amdhsa_system_sgpr_workgroup_id_x 1
.end_amdhsa_kernel
```
